```python
import torch

def _softmax(x, axis=-1):
    return torch.softmax(x, dim=axis)

def _gelu(x):
    return torch.nn.functional.gelu(x, approximate='tanh')

def _silu(x):
    return torch.nn.functional.silu(x)

def _sigmoid(x):
    return torch.sigmoid(x)

def _layernorm(x, axis=-1, eps=1e-05):
    m = x.mean(dim=axis, keepdim=True)
    v = x.var(dim=axis, keepdim=True, unbiased=False)
    return (x - m) / torch.sqrt(v + eps)

def _scatter_add(tgt, idx, src, axis=0):
    return tgt.clone().index_add_(axis, idx, src)

def _segment_sum(src, seg, n):
    out = torch.zeros((n,) + src.shape[1:], dtype=src.dtype)
    return out.index_add_(0, seg, src)

def _pad(x, pw):
    flat = tuple((v for pair in reversed(pw) for v in pair))
    return torch.nn.functional.pad(x, flat)
kernel_name = 'adaLN_cond__memory_aug_recurrent_mem_tr__dense_activation_silu__prompt'

def setup_inputs():

    _w = lambda a: (lambda t: t.to(torch.bfloat16) if t.is_floating_point() else t)(torch.as_tensor(a))

    def _A_setup():
        B, S, Dm = (1, 2048, 512)
        H, Dh = (32, 128)
        M, seg = (8, 32)
        seg = min(seg, S)
        S = S // seg * seg
        return {'x': _w((lambda *s: torch.randn(*s, dtype=torch.bfloat16) * 0.05)(B, S, Dm)), 'mem0': _w((lambda *s: torch.randn(*s, dtype=torch.bfloat16) * 0.8)(B, M, Dm)), 'Wq': _w((lambda *s: torch.randn(*s, dtype=torch.bfloat16) * 0.8)(Dm, H, Dh) * Dm ** (-0.5)), 'Wk': _w((lambda *s: torch.randn(*s, dtype=torch.bfloat16) * 0.8)(Dm, H, Dh) * Dm ** (-0.5)), 'Wv': _w((lambda *s: torch.randn(*s, dtype=torch.bfloat16) * 0.8)(Dm, H, Dh) * Dm ** (-0.5)), 'Wo': _w((lambda *s: torch.randn(*s, dtype=torch.bfloat16) * 0.8)(H, Dh, Dm) * (H * Dh) ** (-0.5)), 'seg_len': seg}
    _A_in = _A_setup()

    def _B_setup():
        B, S, D, F = (1, 2048, 512, 1376)
        return {'x': _w((lambda *s: torch.randn(*s, dtype=torch.bfloat16) * 0.05)(B, S, D)), 'w1': _w((lambda *s: torch.randn(*s, dtype=torch.bfloat16) * 3.2)(D, F) * D ** (-0.5)), 'w2': _w((lambda *s: torch.randn(*s, dtype=torch.bfloat16) * 0.2)(F, D) * F ** (-0.5))}
    _B_in = _B_setup()
    return {'A_x': _A_in['x'], 'A_mem0': _A_in['mem0'], 'A_Wq': _A_in['Wq'], 'A_Wk': _A_in['Wk'], 'A_Wv': _A_in['Wv'], 'A_Wo': _A_in['Wo'], 'A_seg_len': _A_in['seg_len'], 'B_x': _B_in['x'], 'B_w1': _B_in['w1'], 'B_w2': _B_in['w2'], 'c': _w((lambda *s: torch.randn(*s, dtype=torch.bfloat16) * 0.2)(1, 512) * 8.0), 'w_mod': _w((lambda *s: torch.randn(*s, dtype=torch.bfloat16) * 0.2)(512, 6 * 512) * 512 ** (-0.5) * 8.0)}

def reference(A_x, A_mem0, A_Wq, A_Wk, A_Wv, A_Wo, A_seg_len, B_x, B_w1, B_w2, c, w_mod):

    def _A_ref(x, mem0, Wq, Wk, Wv, Wo, seg_len):
        B, S, Dm = x.shape
        H, Dh = (Wq.shape[1], Wq.shape[2])
        M = mem0.shape[1]
        scale = Dh ** (-0.5)
        n_seg = S // seg_len
        L = M + seg_len
        idx = torch.arange(L)
        mask = (idx[:, None] < M) | (idx[:, None] >= idx[None, :])
        mem = mem0
        outs = []
        for s in range(n_seg):
            xs = x[:, s * seg_len:(s + 1) * seg_len, :].clone()
            h = torch.concatenate([mem, xs], axis=1)
            q = torch.einsum('btd,dhe->bhte', h, Wq)
            k = torch.einsum('btd,dhe->bhte', h, Wk)
            v = torch.einsum('btd,dhe->bhte', h, Wv)
            scores = torch.einsum('bhqe,bhke->bhqk', q, k) * scale
            scores = torch.where(mask[None, None], scores, -1000000000.0)
            p = _softmax(scores, axis=-1)
            o = torch.einsum('bhqk,bhke->bhqe', p, v)
            o = torch.einsum('bhte,hed->btd', o, Wo)
            mem = o[:, :M, :].clone()
            outs.append(o[:, M:, :])
        return torch.concatenate(outs, axis=1)

    def _B_ref(x, w1, w2):
        h = torch.einsum('bsd,df->bsf', x, w1)
        h = _silu(h)
        out = torch.einsum('bsf,fd->bsd', h, w2)
        return out
    x = A_x
    mod = (_silu(c) @ w_mod).reshape(c.shape[0], 6, 1, -1)
    sa, ca, ga, sb, cb, gb = (mod[:, 0].clone(), mod[:, 1].clone(), mod[:, 2].clone(), mod[:, 3].clone(), mod[:, 4].clone(), mod[:, 5].clone())
    h = _layernorm(x, axis=-1) * (1 + ca) + sa
    x = x + ga * _A_ref(h, A_mem0, A_Wq, A_Wk, A_Wv, A_Wo, A_seg_len)
    h = _layernorm(x, axis=-1) * (1 + cb) + sb
    x = x + gb * _B_ref(h, B_w1, B_w2)
    return x
```

```asm
; @launch grid=(256,1,1) block=(256,1,1) lds=163840
.amdgcn_target "amdgcn-amd-amdhsa--gfx950"
.text
.globl adaLN_cond__memory_aug_recurrent_mem_tr__dense_activation_silu__prompt_kernel
.p2align 8
.type adaLN_cond__memory_aug_recurrent_mem_tr__dense_activation_silu__prompt_kernel,@function
adaLN_cond__memory_aug_recurrent_mem_tr__dense_activation_silu__prompt_kernel:
  s_cmp_ge_u32 s2, 256
  s_cbranch_scc1 KEND
  s_load_dwordx4 s[24:27], s[0:1], 104
  s_getreg_b32 s19, hwreg(HW_REG_XCC_ID, 0, 4)
  v_lshrrev_b32 v1, 6, v0
  s_and_b32 s19, s19, 7
  v_readfirstlane_b32 s17, v1
  s_lshl_b32 s20, s19, 2
  s_and_b32 s21, s2, 0xc0
  s_add_u32 s20, s20, s21
  s_lshr_b32 s21, s21, 3
  v_mov_b32 v3, 1
  v_mov_b32 v4, s20
  v_mov_b32 v5, 0
  s_mov_b32 s18, 1
  s_mov_b32 s3, 32
  s_waitcnt lgkmcnt(0)
  s_mov_b32 s8, s24
  s_mov_b32 s9, s25
  s_mov_b32 s10, 0x100
  s_mov_b32 s11, 0x00020000
  s_mov_b32 s4, s26
  s_mov_b32 s5, s27
  s_mov_b32 s6, 0x10000000
  s_mov_b32 s7, 0x00020000
  s_cmp_lg_u32 s17, 0
  s_cbranch_scc1 E_SK
  s_mov_b64 exec, 1
  buffer_atomic_add v3, v4, s[8:11], 0 offen sc0 sc1
  s_waitcnt vmcnt(0)
  ds_write_b32 v5, v3
  s_waitcnt lgkmcnt(0)
  s_mov_b64 exec, -1
E_SK:
  s_barrier
  ds_read_b32 v3, v5
  s_waitcnt lgkmcnt(0)
  v_readfirstlane_b32 s20, v3
  s_barrier
  s_add_u32 s16, s20, s21
  s_cmp_lt_u32 s20, 8
  s_cbranch_scc1 DISP
  v_mov_b32 v3, 0x10000
  s_mov_b64 exec, 1
  buffer_atomic_add v3, v5, s[8:11], 0 offen offset:108 sc1
  s_mov_b64 exec, -1
FALLBACK:
  s_waitcnt vmcnt(0) lgkmcnt(0)
  s_barrier
  s_lshr_b32 s19, s2, 5
  s_and_b32 s16, s2, 31
  s_mov_b32 s18, 0
  s_mov_b32 s3, 48
  v_mbcnt_lo_u32_b32 v0, -1, 0
  v_mbcnt_hi_u32_b32 v0, -1, v0
  s_lshl_b32 s20, s17, 6
  v_add_u32 v0, s20, v0
DISP:
  s_cmp_ge_u32 s19, 4
  s_cbranch_scc1 XR
  s_cmp_lg_u32 s19, 0
  s_cbranch_scc1 QKV
CH:
  s_load_dwordx4 s[20:23], s[0:1], 16
  s_load_dwordx4 s[28:31], s[0:1], 32
  s_load_dwordx2 s[12:13], s[0:1], 8
  v_and_b32 v40, 63, v0
  v_and_b32 v41, 15, v0
  v_bfe_u32 v42, v0, 4, 2
  v_lshrrev_b32 v45, 2, v41
  v_lshlrev_b32 v43, 13, v45
  v_lshl_add_u32 v43, v42, 11, v43
  v_and_b32 v44, 3, v40
  v_lshl_add_u32 v43, v44, 4, v43
  s_lshl_b32 s36, s17, 16
  s_lshl_b32 s37, s16, 6
  v_lshl_add_u32 v44, v42, 2, v45
  v_lshlrev_b32 v44, 31, v44
  v_and_b32 v44, 0x780, v44
  v_xor_b32 v44, s37, v44
  v_add_u32 v43, v43, v44
  s_add_u32 s36, s36, 70254592
  v_add_u32 v6, s36, v43
  v_and_b32 v43, 1, v41
  v_lshlrev_b32 v43, 5, v43
  v_lshl_add_u32 v43, v45, 4, v43
  v_lshl_add_u32 v43, v42, 2, v43
  s_lshl_b32 s36, s16, 8
  s_lshl_b32 s37, s17, 6
  s_add_u32 s36, s36, s37
  s_add_u32 s36, s36, 70516736
  v_add_u32 v43, s36, v43
  v_and_b32 v44, 10, v41
  v_cmp_eq_u32 vcc, 0, v44
  v_mov_b32 v44, 0x80000000
  s_nop 0
  v_cndmask_b32 v8, v44, v43, vcc
  s_lshl_b32 s36, s16, 7
  s_lshl_b32 s37, s17, 2
  s_add_u32 s36, s36, s37
  s_add_u32 s36, s36, 70582272
  v_lshlrev_b32 v43, 12, v40
  v_sub_u32 v43, s36, v43
  v_cmp_gt_u32 vcc, 2, v40
  s_nop 1
  v_cndmask_b32 v30, v44, v43, vcc
  v_mov_b32 v112, 0
  v_mov_b32 v113, 0
  v_mov_b32 v114, 0
  v_mov_b32 v115, 0
  s_mov_b32 s42, 32768
  buffer_store_dwordx4 v[112:115], v6, s[4:7], 0 offen sc1
  buffer_store_dwordx4 v[112:115], v6, s[4:7], s42 offen sc1
  buffer_store_dword v112, v8, s[4:7], 0 offen sc1
  buffer_store_dword v112, v30, s[4:7], 0 offen sc1
  s_waitcnt lgkmcnt(0)
  s_mov_b32 s24, s22
  s_mov_b32 s25, s23
  s_mov_b32 s32, s30
  s_mov_b32 s33, s31
  s_mov_b32 s22, 0x400000
  s_mov_b32 s23, 0x00020000
  s_mov_b32 s26, 0x400000
  s_mov_b32 s27, 0x00020000
  s_mov_b32 s30, 0x400000
  s_mov_b32 s31, 0x00020000
  s_mov_b32 s34, 0x400000
  s_mov_b32 s35, 0x00020000
  s_mov_b32 s14, 8192
  s_mov_b32 s15, 0x00020000
  s_lshl_b32 s36, s17, 1
  v_lshrrev_b32 v43, 5, v40
  v_add_u32 v43, s36, v43
  v_lshrrev_b32 v44, 1, v41
  v_xor_b32 v43, v43, v44
  v_and_b32 v44, 4, v43
  v_lshlrev_b32 v43, 5, v43
  v_lshl_add_u32 v43, v44, 19, v43
  v_and_b32 v44, 1, v40
  v_lshl_add_u32 v43, v44, 4, v43
  v_lshl_add_u32 v43, v42, 13, v43
  s_lshl_b32 s36, s17, 15
  s_lshl_b32 s37, s16, 8
  s_add_u32 s36, s36, s37
  v_add_u32 v124, s36, v43
  v_xor_b32 v125, 0x100000, v124
  v_xor_b32 v126, 0x200000, v124
  v_xor_b32 v127, 0x300000, v124
  s_and_b32 s36, s17, 1
  s_lshl_b32 s36, s36, 15
  s_lshr_b32 s37, s17, 1
  s_lshl_b32 s37, s37, 12
  s_add_u32 s36, s36, s37
  s_lshl_b32 s37, s16, 17
  s_add_u32 s36, s36, s37
  v_lshlrev_b32 v43, 4, v40
  v_add_u32 v97, s36, v43
  v_xor_b32 v98, 16, v97
  v_xor_b32 v99, 0x80, v97
  v_add_u32 v99, 14336, v99
  v_xor_b32 v100, 16, v99
  s_lshl_b32 s38, s17, 10
  s_lshl_b32 s39, s17, 12
  s_add_u32 m0, s39, 32768
  s_mov_b32 s40, 0
  buffer_load_dwordx4 v97, s[32:35], s40 offen offset:0  lds
  buffer_load_dwordx4 v98, s[32:35], s40 offen offset:1024  lds
  buffer_load_dwordx4 v99, s[32:35], s40 offen offset:2048  lds
  buffer_load_dwordx4 v100, s[32:35], s40 offen offset:3072  lds
  s_add_u32 m0, s39, 49152
  s_mov_b32 s40, 2048
  buffer_load_dwordx4 v97, s[32:35], s40 offen offset:0  lds
  buffer_load_dwordx4 v98, s[32:35], s40 offen offset:1024  lds
  buffer_load_dwordx4 v99, s[32:35], s40 offen offset:2048  lds
  buffer_load_dwordx4 v100, s[32:35], s40 offen offset:3072  lds
  s_add_u32 m0, s39, 65536
  s_mov_b32 s40, 8192
  buffer_load_dwordx4 v97, s[32:35], s40 offen offset:0  lds
  buffer_load_dwordx4 v98, s[32:35], s40 offen offset:1024  lds
  buffer_load_dwordx4 v99, s[32:35], s40 offen offset:2048  lds
  buffer_load_dwordx4 v100, s[32:35], s40 offen offset:3072  lds
  s_add_u32 m0, s39, 81920
  s_mov_b32 s40, 10240
  buffer_load_dwordx4 v97, s[32:35], s40 offen offset:0  lds
  buffer_load_dwordx4 v98, s[32:35], s40 offen offset:1024  lds
  buffer_load_dwordx4 v99, s[32:35], s40 offen offset:2048  lds
  buffer_load_dwordx4 v100, s[32:35], s40 offen offset:3072  lds
  s_add_u32 m0, s39, 98304
  s_mov_b32 s40, 65536
  buffer_load_dwordx4 v97, s[32:35], s40 offen offset:0  lds
  buffer_load_dwordx4 v98, s[32:35], s40 offen offset:1024  lds
  buffer_load_dwordx4 v99, s[32:35], s40 offen offset:2048  lds
  buffer_load_dwordx4 v100, s[32:35], s40 offen offset:3072  lds
  s_add_u32 m0, s39, 114688
  s_mov_b32 s40, 67584
  buffer_load_dwordx4 v97, s[32:35], s40 offen offset:0  lds
  buffer_load_dwordx4 v98, s[32:35], s40 offen offset:1024  lds
  buffer_load_dwordx4 v99, s[32:35], s40 offen offset:2048  lds
  buffer_load_dwordx4 v100, s[32:35], s40 offen offset:3072  lds
  s_add_u32 m0, s39, 131072
  s_mov_b32 s40, 73728
  buffer_load_dwordx4 v97, s[32:35], s40 offen offset:0  lds
  buffer_load_dwordx4 v98, s[32:35], s40 offen offset:1024  lds
  buffer_load_dwordx4 v99, s[32:35], s40 offen offset:2048  lds
  buffer_load_dwordx4 v100, s[32:35], s40 offen offset:3072  lds
  s_add_u32 m0, s39, 147456
  s_mov_b32 s40, 75776
  buffer_load_dwordx4 v97, s[32:35], s40 offen offset:0  lds
  buffer_load_dwordx4 v98, s[32:35], s40 offen offset:1024  lds
  buffer_load_dwordx4 v99, s[32:35], s40 offen offset:2048  lds
  buffer_load_dwordx4 v100, s[32:35], s40 offen offset:3072  lds
  s_add_u32 m0, s38, 0
  s_mov_b32 s40, 0
  buffer_load_dwordx4 v126, s[20:23], s40 offen  lds
  s_add_u32 m0, s38, 4096
  s_mov_b32 s40, 131072
  buffer_load_dwordx4 v126, s[20:23], s40 offen  lds
  s_add_u32 m0, s38, 8192
  s_mov_b32 s40, 262144
  buffer_load_dwordx4 v126, s[20:23], s40 offen  lds
  s_add_u32 m0, s38, 12288
  s_mov_b32 s40, 393216
  buffer_load_dwordx4 v126, s[20:23], s40 offen  lds
  v_lshlrev_b32 v1, 4, v40
  s_lshl_b32 s36, s17, 11
  v_add_u32 v0, s36, v1
  v_add_u32 v4, 0x10000, v0
  v_add_u32 v5, 0x20000, v0
  s_lshl_b32 s36, s17, 2
  v_add_u32 v2, s36, v1
  s_lshr_b32 s36, s17, 1
  s_lshl_b32 s36, s36, 10
  s_and_b32 s37, s17, 1
  s_lshl_b32 s37, s37, 3
  s_add_u32 s36, s36, s37
  v_add_u32 v3, s36, v1
  v_and_b32 v44, 3, v40
  v_lshl_add_u32 v43, v42, 2, v44
  v_lshlrev_b32 v43, 6, v43
  v_lshrrev_b32 v45, 2, v41
  v_lshl_add_u32 v43, v45, 4, v43
  s_lshl_b32 s36, s16, 13
  s_lshl_b32 s37, s17, 11
  s_add_u32 s36, s36, s37
  s_add_u32 s36, s36, 70254592
  v_add_u32 v7, s36, v43
  v_and_b32 v43, 1, v41
  v_sub_u32 v11, 0, v43
  v_not_b32 v10, v11
  v_and_b32 v9, 0xaaaa, v11
  v_add_u32 v9, 0x4444, v9
  s_mov_b32 s44, 0xaaaaaaaa
  s_mov_b32 s45, 0xaaaaaaaa
  v_lshrrev_b32 v43, 2, v41
  v_cmp_eq_u32 vcc, v43, v42
  v_bfe_u32 v43, v41, 1, 1
  v_lshlrev_b32 v43, 4, v43
  v_mov_b32 v44, 0x3f80
  v_lshlrev_b32 v43, v43, v44
  v_cndmask_b32 v12, 0, v43, vcc
  v_mov_b32 v13, 0
  v_mov_b32 v14, 0
  v_mov_b32 v15, v12
  v_and_b32 v43, 1, v41
  v_lshlrev_b32 v43, 4, v43
  v_lshlrev_b32 v43, v43, v44
  v_bfe_u32 v45, v41, 1, 2
  v_cmp_eq_u32 vcc, 0, v45
  s_nop 1
  v_cndmask_b32 v16, 0, v43, vcc
  v_cmp_eq_u32 vcc, 1, v45
  s_nop 1
  v_cndmask_b32 v17, 0, v43, vcc
  v_cmp_eq_u32 vcc, 2, v45
  s_nop 1
  v_cndmask_b32 v18, 0, v43, vcc
  v_cmp_eq_u32 vcc, 3, v45
  s_nop 1
  v_cndmask_b32 v19, 0, v43, vcc
  v_lshrrev_b32 v43, 2, v41
  v_and_b32 v44, 3, v41
  v_and_b32 v45, 1, v42
  v_lshrrev_b32 v46, 1, v42
  v_lshl_add_u32 v47, v43, 1, v45
  v_lshlrev_b32 v48, 9, v47
  v_lshl_add_u32 v48, v46, 12, v48
  s_lshl_b32 s36, s17, 1
  v_xor_b32 v47, s36, v47
  v_lshl_add_u32 v48, v47, 5, v48
  v_lshl_add_u32 v101, v44, 3, v48
  s_and_b32 s36, s17, 1
  s_lshl_b32 s36, s36, 14
  v_add_u32 v101, s36, v101
  v_xor_b32 v102, 32, v101
  v_xor_b32 v96, 0x4000, v101
  v_xor_b32 v97, 0x4000, v102
  v_lshl_add_u32 v47, v42, 2, v43
  v_lshlrev_b32 v47, 10, v47
  v_lshl_add_u32 v47, v44, 5, v47
  s_lshl_b32 s36, s17, 8
  v_add_u32 v47, s36, v47
  v_and_b32 v48, 1, v43
  v_lshl_add_u32 v47, v48, 4, v47
  v_lshrrev_b32 v48, 1, v43
  v_lshl_add_u32 v104, v48, 7, v47
  v_xor_b32 v105, 16, v104
  v_xor_b32 v106, 0x80, v104
  v_xor_b32 v107, 0x90, v104
  v_lshrrev_b32 v43, 1, v41
  v_lshlrev_b32 v43, 10, v43
  v_lshl_add_u32 v43, v42, 5, v43
  v_and_b32 v44, 1, v41
  v_lshl_add_u32 v43, v44, 4, v43
  s_lshl_b32 s36, s17, 8
  v_add_u32 v103, s36, v43
  s_waitcnt vmcnt(36)
  s_barrier
  s_cmp_lg_u32 s17, 0
  s_cbranch_scc1 CH_AR
  v_mov_b32 v112, 1
  s_mov_b64 exec, 1
  v_mov_b32 v113, s3
  buffer_atomic_add v112, v113, s[8:11], 0 offen offset:76 sc1
  s_mov_b64 exec, -1
CH_AR:
  s_waitcnt vmcnt(32)
  s_waitcnt lgkmcnt(0)
  s_barrier
  s_add_u32 m0, s38, 16384
  s_mov_b32 s40, 0
  buffer_load_dwordx4 v127, s[20:23], s40 offen  lds
  s_add_u32 m0, s38, 20480
  s_mov_b32 s40, 131072
  buffer_load_dwordx4 v127, s[20:23], s40 offen  lds
  s_add_u32 m0, s38, 24576
  s_mov_b32 s40, 262144
  buffer_load_dwordx4 v127, s[20:23], s40 offen  lds
  s_add_u32 m0, s38, 28672
  s_mov_b32 s40, 393216
  buffer_load_dwordx4 v127, s[20:23], s40 offen  lds
  ds_read_b64_tr_b16 v[32:33], v104 offset:32768
  ds_read_b64_tr_b16 v[40:41], v104 offset:32776
  ds_read_b64_tr_b16 v[160:161], v105 offset:32768
  ds_read_b64_tr_b16 v[168:169], v105 offset:32776
  ds_read_b64_tr_b16 v[176:177], v106 offset:32768
  ds_read_b64_tr_b16 v[184:185], v106 offset:32776
  ds_read_b64_tr_b16 v[48:49], v107 offset:32768
  ds_read_b64_tr_b16 v[56:57], v107 offset:32776
  s_waitcnt vmcnt(32)
  s_waitcnt lgkmcnt(0)
  s_barrier
  s_add_u32 m0, s38, 32768
  s_mov_b32 s40, 0
  buffer_load_dwordx4 v124, s[24:27], s40 offen  lds
  s_add_u32 m0, s38, 36864
  s_mov_b32 s40, 131072
  buffer_load_dwordx4 v124, s[24:27], s40 offen  lds
  s_add_u32 m0, s38, 40960
  s_mov_b32 s40, 262144
  buffer_load_dwordx4 v124, s[24:27], s40 offen  lds
  s_add_u32 m0, s38, 45056
  s_mov_b32 s40, 393216
  buffer_load_dwordx4 v124, s[24:27], s40 offen  lds
  ds_read_b64_tr_b16 v[34:35], v104 offset:49152
  ds_read_b64_tr_b16 v[42:43], v104 offset:49160
  ds_read_b64_tr_b16 v[162:163], v105 offset:49152
  ds_read_b64_tr_b16 v[170:171], v105 offset:49160
  ds_read_b64_tr_b16 v[178:179], v106 offset:49152
  ds_read_b64_tr_b16 v[186:187], v106 offset:49160
  ds_read_b64_tr_b16 v[50:51], v107 offset:49152
  ds_read_b64_tr_b16 v[58:59], v107 offset:49160
  s_waitcnt vmcnt(32)
  s_waitcnt lgkmcnt(0)
  s_barrier
  s_add_u32 m0, s38, 49152
  s_mov_b32 s40, 0
  buffer_load_dwordx4 v125, s[24:27], s40 offen  lds
  s_add_u32 m0, s38, 53248
  s_mov_b32 s40, 131072
  buffer_load_dwordx4 v125, s[24:27], s40 offen  lds
  s_add_u32 m0, s38, 57344
  s_mov_b32 s40, 262144
  buffer_load_dwordx4 v125, s[24:27], s40 offen  lds
  s_add_u32 m0, s38, 61440
  s_mov_b32 s40, 393216
  buffer_load_dwordx4 v125, s[24:27], s40 offen  lds
  v_add_u32 v108, 65536, v104
  v_add_u32 v109, 65536, v105
  v_add_u32 v110, 65536, v106
  v_add_u32 v111, 65536, v107
  ds_read_b64_tr_b16 v[36:37], v108 offset:0
  ds_read_b64_tr_b16 v[44:45], v108 offset:8
  ds_read_b64_tr_b16 v[164:165], v109 offset:0
  ds_read_b64_tr_b16 v[172:173], v109 offset:8
  ds_read_b64_tr_b16 v[180:181], v110 offset:0
  ds_read_b64_tr_b16 v[188:189], v110 offset:8
  ds_read_b64_tr_b16 v[52:53], v111 offset:0
  ds_read_b64_tr_b16 v[60:61], v111 offset:8
  s_waitcnt vmcnt(32)
  s_waitcnt lgkmcnt(0)
  s_barrier
  s_add_u32 m0, s38, 65536
  s_mov_b32 s40, 524288
  buffer_load_dwordx4 v124, s[24:27], s40 offen  lds
  s_add_u32 m0, s38, 69632
  s_mov_b32 s40, 655360
  buffer_load_dwordx4 v124, s[24:27], s40 offen  lds
  s_add_u32 m0, s38, 73728
  s_mov_b32 s40, 786432
  buffer_load_dwordx4 v124, s[24:27], s40 offen  lds
  s_add_u32 m0, s38, 77824
  s_mov_b32 s40, 917504
  buffer_load_dwordx4 v124, s[24:27], s40 offen  lds
  v_add_u32 v108, 65536, v104
  v_add_u32 v109, 65536, v105
  v_add_u32 v110, 65536, v106
  v_add_u32 v111, 65536, v107
  ds_read_b64_tr_b16 v[38:39], v108 offset:16384
  ds_read_b64_tr_b16 v[46:47], v108 offset:16392
  ds_read_b64_tr_b16 v[166:167], v109 offset:16384
  ds_read_b64_tr_b16 v[174:175], v109 offset:16392
  ds_read_b64_tr_b16 v[182:183], v110 offset:16384
  ds_read_b64_tr_b16 v[190:191], v110 offset:16392
  ds_read_b64_tr_b16 v[54:55], v111 offset:16384
  ds_read_b64_tr_b16 v[62:63], v111 offset:16392
  s_waitcnt vmcnt(32)
  s_waitcnt lgkmcnt(0)
  s_barrier
  s_add_u32 m0, s38, 81920
  s_mov_b32 s40, 524288
  buffer_load_dwordx4 v125, s[24:27], s40 offen  lds
  s_add_u32 m0, s38, 86016
  s_mov_b32 s40, 655360
  buffer_load_dwordx4 v125, s[24:27], s40 offen  lds
  s_add_u32 m0, s38, 90112
  s_mov_b32 s40, 786432
  buffer_load_dwordx4 v125, s[24:27], s40 offen  lds
  s_add_u32 m0, s38, 94208
  s_mov_b32 s40, 917504
  buffer_load_dwordx4 v125, s[24:27], s40 offen  lds
  v_add_u32 v108, 65536, v104
  v_add_u32 v109, 65536, v105
  v_add_u32 v110, 65536, v106
  v_add_u32 v111, 65536, v107
  ds_read_b64_tr_b16 v[192:193], v108 offset:32768
  ds_read_b64_tr_b16 v[200:201], v108 offset:32776
  ds_read_b64_tr_b16 v[208:209], v109 offset:32768
  ds_read_b64_tr_b16 v[216:217], v109 offset:32776
  ds_read_b64_tr_b16 v[224:225], v110 offset:32768
  ds_read_b64_tr_b16 v[232:233], v110 offset:32776
  ds_read_b64_tr_b16 v[240:241], v111 offset:32768
  ds_read_b64_tr_b16 v[248:249], v111 offset:32776
  s_waitcnt vmcnt(32)
  s_waitcnt lgkmcnt(0)
  s_barrier
  s_add_u32 m0, s38, 98304
  s_mov_b32 s40, 524288
  buffer_load_dwordx4 v126, s[24:27], s40 offen  lds
  s_add_u32 m0, s38, 102400
  s_mov_b32 s40, 655360
  buffer_load_dwordx4 v126, s[24:27], s40 offen  lds
  s_add_u32 m0, s38, 106496
  s_mov_b32 s40, 786432
  buffer_load_dwordx4 v126, s[24:27], s40 offen  lds
  s_add_u32 m0, s38, 110592
  s_mov_b32 s40, 917504
  buffer_load_dwordx4 v126, s[24:27], s40 offen  lds
  v_add_u32 v108, 65536, v104
  v_add_u32 v109, 65536, v105
  v_add_u32 v110, 65536, v106
  v_add_u32 v111, 65536, v107
  ds_read_b64_tr_b16 v[194:195], v108 offset:49152
  ds_read_b64_tr_b16 v[202:203], v108 offset:49160
  ds_read_b64_tr_b16 v[210:211], v109 offset:49152
  ds_read_b64_tr_b16 v[218:219], v109 offset:49160
  ds_read_b64_tr_b16 v[226:227], v110 offset:49152
  ds_read_b64_tr_b16 v[234:235], v110 offset:49160
  ds_read_b64_tr_b16 v[242:243], v111 offset:49152
  ds_read_b64_tr_b16 v[250:251], v111 offset:49160
  s_waitcnt vmcnt(32)
  s_waitcnt lgkmcnt(0)
  s_barrier
  s_add_u32 m0, s38, 114688
  s_mov_b32 s40, 524288
  buffer_load_dwordx4 v127, s[24:27], s40 offen  lds
  s_add_u32 m0, s38, 118784
  s_mov_b32 s40, 655360
  buffer_load_dwordx4 v127, s[24:27], s40 offen  lds
  s_add_u32 m0, s38, 122880
  s_mov_b32 s40, 786432
  buffer_load_dwordx4 v127, s[24:27], s40 offen  lds
  s_add_u32 m0, s38, 126976
  s_mov_b32 s40, 917504
  buffer_load_dwordx4 v127, s[24:27], s40 offen  lds
  v_add_u32 v108, 131072, v104
  v_add_u32 v109, 131072, v105
  v_add_u32 v110, 131072, v106
  v_add_u32 v111, 131072, v107
  ds_read_b64_tr_b16 v[196:197], v108 offset:0
  ds_read_b64_tr_b16 v[204:205], v108 offset:8
  ds_read_b64_tr_b16 v[212:213], v109 offset:0
  ds_read_b64_tr_b16 v[220:221], v109 offset:8
  ds_read_b64_tr_b16 v[228:229], v110 offset:0
  ds_read_b64_tr_b16 v[236:237], v110 offset:8
  ds_read_b64_tr_b16 v[244:245], v111 offset:0
  ds_read_b64_tr_b16 v[252:253], v111 offset:8
  s_waitcnt vmcnt(32)
  s_waitcnt lgkmcnt(0)
  s_barrier
  s_add_u32 m0, s38, 131072
  s_mov_b32 s40, 524288
  buffer_load_dwordx4 v124, s[28:31], s40 offen  lds
  s_add_u32 m0, s38, 135168
  s_mov_b32 s40, 655360
  buffer_load_dwordx4 v124, s[28:31], s40 offen  lds
  s_add_u32 m0, s38, 139264
  s_mov_b32 s40, 786432
  buffer_load_dwordx4 v124, s[28:31], s40 offen  lds
  s_add_u32 m0, s38, 143360
  s_mov_b32 s40, 917504
  buffer_load_dwordx4 v124, s[28:31], s40 offen  lds
  v_add_u32 v108, 131072, v104
  v_add_u32 v109, 131072, v105
  v_add_u32 v110, 131072, v106
  v_add_u32 v111, 131072, v107
  ds_read_b64_tr_b16 v[198:199], v108 offset:16384
  ds_read_b64_tr_b16 v[206:207], v108 offset:16392
  ds_read_b64_tr_b16 v[214:215], v109 offset:16384
  ds_read_b64_tr_b16 v[222:223], v109 offset:16392
  ds_read_b64_tr_b16 v[230:231], v110 offset:16384
  ds_read_b64_tr_b16 v[238:239], v110 offset:16392
  ds_read_b64_tr_b16 v[246:247], v111 offset:16384
  ds_read_b64_tr_b16 v[254:255], v111 offset:16392
  s_waitcnt vmcnt(28)
  s_waitcnt lgkmcnt(0)
  s_barrier
  s_add_u32 m0, s38, 147456
  s_mov_b32 s40, 524288
  buffer_load_dwordx4 v125, s[28:31], s40 offen  lds
  s_add_u32 m0, s38, 151552
  s_mov_b32 s40, 655360
  buffer_load_dwordx4 v125, s[28:31], s40 offen  lds
  s_add_u32 m0, s38, 155648
  s_mov_b32 s40, 786432
  buffer_load_dwordx4 v125, s[28:31], s40 offen  lds
  s_add_u32 m0, s38, 159744
  s_mov_b32 s40, 917504
  buffer_load_dwordx4 v125, s[28:31], s40 offen  lds
  ds_read_b64_tr_b16 a[32:33], v101 offset:0
  ds_read_b64_tr_b16 a[34:35], v101 offset:256
  ds_read_b64_tr_b16 a[36:37], v101 offset:8192
  ds_read_b64_tr_b16 a[38:39], v101 offset:8448
  ds_read_b64_tr_b16 a[40:41], v102 offset:0
  ds_read_b64_tr_b16 a[42:43], v102 offset:256
  ds_read_b64_tr_b16 a[44:45], v102 offset:8192
  ds_read_b64_tr_b16 a[46:47], v102 offset:8448
  ds_read_b64_tr_b16 a[48:49], v96 offset:0
  ds_read_b64_tr_b16 a[50:51], v96 offset:256
  ds_read_b64_tr_b16 a[52:53], v96 offset:8192
  ds_read_b64_tr_b16 a[54:55], v96 offset:8448
  ds_read_b64_tr_b16 a[56:57], v97 offset:0
  ds_read_b64_tr_b16 a[58:59], v97 offset:256
  ds_read_b64_tr_b16 a[60:61], v97 offset:8192
  ds_read_b64_tr_b16 a[62:63], v97 offset:8448
  s_waitcnt vmcnt(24)
  s_waitcnt lgkmcnt(0)
  s_barrier
  s_add_u32 m0, s38, 0
  s_mov_b32 s40, 0
  buffer_load_dwordx4 v126, s[28:31], s40 offen  lds
  s_add_u32 m0, s38, 4096
  s_mov_b32 s40, 131072
  buffer_load_dwordx4 v126, s[28:31], s40 offen  lds
  s_add_u32 m0, s38, 8192
  s_mov_b32 s40, 262144
  buffer_load_dwordx4 v126, s[28:31], s40 offen  lds
  s_add_u32 m0, s38, 12288
  s_mov_b32 s40, 393216
  buffer_load_dwordx4 v126, s[28:31], s40 offen  lds
  s_add_u32 m0, s38, 16384
  s_mov_b32 s40, 0
  buffer_load_dwordx4 v127, s[28:31], s40 offen  lds
  s_add_u32 m0, s38, 20480
  s_mov_b32 s40, 131072
  buffer_load_dwordx4 v127, s[28:31], s40 offen  lds
  s_add_u32 m0, s38, 24576
  s_mov_b32 s40, 262144
  buffer_load_dwordx4 v127, s[28:31], s40 offen  lds
  s_add_u32 m0, s38, 28672
  s_mov_b32 s40, 393216
  buffer_load_dwordx4 v127, s[28:31], s40 offen  lds
  ds_read_b64_tr_b16 a[80:81], v101 offset:32768
  ds_read_b64_tr_b16 a[82:83], v101 offset:33024
  ds_read_b64_tr_b16 a[84:85], v101 offset:40960
  ds_read_b64_tr_b16 a[86:87], v101 offset:41216
  ds_read_b64_tr_b16 a[88:89], v102 offset:32768
  ds_read_b64_tr_b16 a[90:91], v102 offset:33024
  ds_read_b64_tr_b16 a[92:93], v102 offset:40960
  ds_read_b64_tr_b16 a[94:95], v102 offset:41216
  ds_read_b64_tr_b16 a[112:113], v96 offset:32768
  ds_read_b64_tr_b16 a[114:115], v96 offset:33024
  ds_read_b64_tr_b16 a[116:117], v96 offset:40960
  ds_read_b64_tr_b16 a[118:119], v96 offset:41216
  ds_read_b64_tr_b16 a[120:121], v97 offset:32768
  ds_read_b64_tr_b16 a[122:123], v97 offset:33024
  ds_read_b64_tr_b16 a[124:125], v97 offset:40960
  ds_read_b64_tr_b16 a[126:127], v97 offset:41216
  s_waitcnt vmcnt(24)
  s_waitcnt lgkmcnt(0)
  s_barrier
  s_add_u32 m0, s38, 32768
  s_mov_b32 s40, 0
  buffer_load_dwordx4 v124, s[20:23], s40 offen  lds
  s_add_u32 m0, s38, 36864
  s_mov_b32 s40, 131072
  buffer_load_dwordx4 v124, s[20:23], s40 offen  lds
  s_add_u32 m0, s38, 40960
  s_mov_b32 s40, 262144
  buffer_load_dwordx4 v124, s[20:23], s40 offen  lds
  s_add_u32 m0, s38, 45056
  s_mov_b32 s40, 393216
  buffer_load_dwordx4 v124, s[20:23], s40 offen  lds
  s_add_u32 m0, s38, 49152
  s_mov_b32 s40, 0
  buffer_load_dwordx4 v125, s[20:23], s40 offen  lds
  s_add_u32 m0, s38, 53248
  s_mov_b32 s40, 131072
  buffer_load_dwordx4 v125, s[20:23], s40 offen  lds
  s_add_u32 m0, s38, 57344
  s_mov_b32 s40, 262144
  buffer_load_dwordx4 v125, s[20:23], s40 offen  lds
  s_add_u32 m0, s38, 61440
  s_mov_b32 s40, 393216
  buffer_load_dwordx4 v125, s[20:23], s40 offen  lds
  v_add_u32 v108, 65536, v101
  v_add_u32 v109, 65536, v102
  v_add_u32 v110, 65536, v96
  v_add_u32 v111, 65536, v97
  ds_read_b64_tr_b16 a[96:97], v108 offset:0
  ds_read_b64_tr_b16 a[98:99], v108 offset:256
  ds_read_b64_tr_b16 a[100:101], v108 offset:8192
  ds_read_b64_tr_b16 a[102:103], v108 offset:8448
  ds_read_b64_tr_b16 a[104:105], v109 offset:0
  ds_read_b64_tr_b16 a[106:107], v109 offset:256
  ds_read_b64_tr_b16 a[108:109], v109 offset:8192
  ds_read_b64_tr_b16 a[110:111], v109 offset:8448
  ds_read_b64_tr_b16 a[128:129], v110 offset:0
  ds_read_b64_tr_b16 a[130:131], v110 offset:256
  ds_read_b64_tr_b16 a[132:133], v110 offset:8192
  ds_read_b64_tr_b16 a[134:135], v110 offset:8448
  ds_read_b64_tr_b16 a[136:137], v111 offset:0
  ds_read_b64_tr_b16 a[138:139], v111 offset:256
  ds_read_b64_tr_b16 a[140:141], v111 offset:8192
  ds_read_b64_tr_b16 a[142:143], v111 offset:8448
  s_waitcnt vmcnt(24)
  s_waitcnt lgkmcnt(0)
  s_barrier
  s_add_u32 m0, s38, 65536
  s_mov_b32 s40, 524288
  buffer_load_dwordx4 v124, s[20:23], s40 offen  lds
  s_add_u32 m0, s38, 69632
  s_mov_b32 s40, 655360
  buffer_load_dwordx4 v124, s[20:23], s40 offen  lds
  s_add_u32 m0, s38, 73728
  s_mov_b32 s40, 786432
  buffer_load_dwordx4 v124, s[20:23], s40 offen  lds
  s_add_u32 m0, s38, 77824
  s_mov_b32 s40, 917504
  buffer_load_dwordx4 v124, s[20:23], s40 offen  lds
  s_add_u32 m0, s38, 81920
  s_mov_b32 s40, 524288
  buffer_load_dwordx4 v125, s[20:23], s40 offen  lds
  s_add_u32 m0, s38, 86016
  s_mov_b32 s40, 655360
  buffer_load_dwordx4 v125, s[20:23], s40 offen  lds
  s_add_u32 m0, s38, 90112
  s_mov_b32 s40, 786432
  buffer_load_dwordx4 v125, s[20:23], s40 offen  lds
  s_add_u32 m0, s38, 94208
  s_mov_b32 s40, 917504
  buffer_load_dwordx4 v125, s[20:23], s40 offen  lds
  v_add_u32 v108, 65536, v101
  v_add_u32 v109, 65536, v102
  v_add_u32 v110, 65536, v96
  v_add_u32 v111, 65536, v97
  ds_read_b64_tr_b16 a[144:145], v108 offset:32768
  ds_read_b64_tr_b16 a[146:147], v108 offset:33024
  ds_read_b64_tr_b16 a[148:149], v108 offset:40960
  ds_read_b64_tr_b16 a[150:151], v108 offset:41216
  ds_read_b64_tr_b16 a[152:153], v109 offset:32768
  ds_read_b64_tr_b16 a[154:155], v109 offset:33024
  ds_read_b64_tr_b16 a[156:157], v109 offset:40960
  ds_read_b64_tr_b16 a[158:159], v109 offset:41216
  ds_read_b64_tr_b16 a[176:177], v110 offset:32768
  ds_read_b64_tr_b16 a[178:179], v110 offset:33024
  ds_read_b64_tr_b16 a[180:181], v110 offset:40960
  ds_read_b64_tr_b16 a[182:183], v110 offset:41216
  ds_read_b64_tr_b16 a[184:185], v111 offset:32768
  ds_read_b64_tr_b16 a[186:187], v111 offset:33024
  ds_read_b64_tr_b16 a[188:189], v111 offset:40960
  ds_read_b64_tr_b16 a[190:191], v111 offset:41216
  s_waitcnt vmcnt(24)
  s_waitcnt lgkmcnt(0)
  s_barrier
  s_add_u32 m0, s38, 98304
  s_mov_b32 s40, 524288
  buffer_load_dwordx4 v126, s[20:23], s40 offen  lds
  s_add_u32 m0, s38, 102400
  s_mov_b32 s40, 655360
  buffer_load_dwordx4 v126, s[20:23], s40 offen  lds
  s_add_u32 m0, s38, 106496
  s_mov_b32 s40, 786432
  buffer_load_dwordx4 v126, s[20:23], s40 offen  lds
  s_add_u32 m0, s38, 110592
  s_mov_b32 s40, 917504
  buffer_load_dwordx4 v126, s[20:23], s40 offen  lds
  s_add_u32 m0, s38, 114688
  s_mov_b32 s40, 524288
  buffer_load_dwordx4 v127, s[20:23], s40 offen  lds
  s_add_u32 m0, s38, 118784
  s_mov_b32 s40, 655360
  buffer_load_dwordx4 v127, s[20:23], s40 offen  lds
  s_add_u32 m0, s38, 122880
  s_mov_b32 s40, 786432
  buffer_load_dwordx4 v127, s[20:23], s40 offen  lds
  s_add_u32 m0, s38, 126976
  s_mov_b32 s40, 917504
  buffer_load_dwordx4 v127, s[20:23], s40 offen  lds
  v_add_u32 v108, 131072, v101
  v_add_u32 v109, 131072, v102
  v_add_u32 v110, 131072, v96
  v_add_u32 v111, 131072, v97
  ds_read_b64_tr_b16 a[208:209], v108 offset:0
  ds_read_b64_tr_b16 a[210:211], v108 offset:256
  ds_read_b64_tr_b16 a[212:213], v108 offset:8192
  ds_read_b64_tr_b16 a[214:215], v108 offset:8448
  ds_read_b64_tr_b16 a[216:217], v109 offset:0
  ds_read_b64_tr_b16 a[218:219], v109 offset:256
  ds_read_b64_tr_b16 a[220:221], v109 offset:8192
  ds_read_b64_tr_b16 a[222:223], v109 offset:8448
  ds_read_b64_tr_b16 a[224:225], v110 offset:0
  ds_read_b64_tr_b16 a[226:227], v110 offset:256
  ds_read_b64_tr_b16 a[228:229], v110 offset:8192
  ds_read_b64_tr_b16 a[230:231], v110 offset:8448
  ds_read_b64_tr_b16 a[232:233], v111 offset:0
  ds_read_b64_tr_b16 a[234:235], v111 offset:256
  ds_read_b64_tr_b16 a[236:237], v111 offset:8192
  ds_read_b64_tr_b16 a[238:239], v111 offset:8448
  s_waitcnt vmcnt(24)
  s_waitcnt lgkmcnt(0)
  s_barrier
  s_add_u32 m0, s38, 131072
  s_mov_b32 s40, 0
  buffer_load_dwordx4 v126, s[24:27], s40 offen  lds
  s_add_u32 m0, s38, 135168
  s_mov_b32 s40, 131072
  buffer_load_dwordx4 v126, s[24:27], s40 offen  lds
  s_add_u32 m0, s38, 139264
  s_mov_b32 s40, 262144
  buffer_load_dwordx4 v126, s[24:27], s40 offen  lds
  s_add_u32 m0, s38, 143360
  s_mov_b32 s40, 393216
  buffer_load_dwordx4 v126, s[24:27], s40 offen  lds
  s_add_u32 m0, s38, 147456
  s_mov_b32 s40, 0
  buffer_load_dwordx4 v127, s[24:27], s40 offen  lds
  s_add_u32 m0, s38, 151552
  s_mov_b32 s40, 131072
  buffer_load_dwordx4 v127, s[24:27], s40 offen  lds
  s_add_u32 m0, s38, 155648
  s_mov_b32 s40, 262144
  buffer_load_dwordx4 v127, s[24:27], s40 offen  lds
  s_add_u32 m0, s38, 159744
  s_mov_b32 s40, 393216
  buffer_load_dwordx4 v127, s[24:27], s40 offen  lds
  ds_read_b64_tr_b16 a[240:241], v101 offset:0
  ds_read_b64_tr_b16 a[242:243], v101 offset:256
  ds_read_b64_tr_b16 a[244:245], v101 offset:8192
  ds_read_b64_tr_b16 a[246:247], v101 offset:8448
  ds_read_b64_tr_b16 a[248:249], v102 offset:0
  ds_read_b64_tr_b16 a[250:251], v102 offset:256
  ds_read_b64_tr_b16 a[252:253], v102 offset:8192
  ds_read_b64_tr_b16 a[254:255], v102 offset:8448
  ds_read_b64_tr_b16 v[144:145], v96 offset:0
  ds_read_b64_tr_b16 v[146:147], v96 offset:256
  ds_read_b64_tr_b16 v[148:149], v96 offset:8192
  ds_read_b64_tr_b16 v[150:151], v96 offset:8448
  ds_read_b64_tr_b16 v[152:153], v97 offset:0
  ds_read_b64_tr_b16 v[154:155], v97 offset:256
  ds_read_b64_tr_b16 v[156:157], v97 offset:8192
  ds_read_b64_tr_b16 v[158:159], v97 offset:8448
  s_waitcnt vmcnt(24)
  s_waitcnt lgkmcnt(0)
  s_barrier
  s_add_u32 m0, s38, 0
  s_mov_b32 s40, 0
  buffer_load_dwordx4 v125, s[28:31], s40 offen  lds
  s_add_u32 m0, s38, 4096
  s_mov_b32 s40, 131072
  buffer_load_dwordx4 v125, s[28:31], s40 offen  lds
  s_add_u32 m0, s38, 8192
  s_mov_b32 s40, 262144
  buffer_load_dwordx4 v125, s[28:31], s40 offen  lds
  s_add_u32 m0, s38, 12288
  s_mov_b32 s40, 393216
  buffer_load_dwordx4 v125, s[28:31], s40 offen  lds
  s_add_u32 m0, s38, 16384
  s_mov_b32 s40, 0
  buffer_load_dwordx4 v124, s[28:31], s40 offen  lds
  s_add_u32 m0, s38, 20480
  s_mov_b32 s40, 131072
  buffer_load_dwordx4 v124, s[28:31], s40 offen  lds
  s_add_u32 m0, s38, 24576
  s_mov_b32 s40, 262144
  buffer_load_dwordx4 v124, s[28:31], s40 offen  lds
  s_add_u32 m0, s38, 28672
  s_mov_b32 s40, 393216
  buffer_load_dwordx4 v124, s[28:31], s40 offen  lds
  ds_read_b64_tr_b16 v[64:65], v101 offset:32768
  ds_read_b64_tr_b16 v[66:67], v101 offset:33024
  ds_read_b64_tr_b16 v[68:69], v101 offset:40960
  ds_read_b64_tr_b16 v[70:71], v101 offset:41216
  ds_read_b64_tr_b16 v[72:73], v102 offset:32768
  ds_read_b64_tr_b16 v[74:75], v102 offset:33024
  ds_read_b64_tr_b16 v[76:77], v102 offset:40960
  ds_read_b64_tr_b16 v[78:79], v102 offset:41216
  ds_read_b64_tr_b16 a[0:1], v96 offset:32768
  ds_read_b64_tr_b16 a[2:3], v96 offset:33024
  ds_read_b64_tr_b16 a[4:5], v96 offset:40960
  ds_read_b64_tr_b16 a[6:7], v96 offset:41216
  ds_read_b64_tr_b16 a[8:9], v97 offset:32768
  ds_read_b64_tr_b16 a[10:11], v97 offset:33024
  ds_read_b64_tr_b16 a[12:13], v97 offset:40960
  ds_read_b64_tr_b16 a[14:15], v97 offset:41216
  s_waitcnt vmcnt(24)
  s_waitcnt lgkmcnt(0)
  s_barrier
  s_add_u32 m0, s38, 32768
  s_mov_b32 s40, 524288
  buffer_load_dwordx4 v127, s[28:31], s40 offen  lds
  s_add_u32 m0, s38, 36864
  s_mov_b32 s40, 655360
  buffer_load_dwordx4 v127, s[28:31], s40 offen  lds
  s_add_u32 m0, s38, 40960
  s_mov_b32 s40, 786432
  buffer_load_dwordx4 v127, s[28:31], s40 offen  lds
  s_add_u32 m0, s38, 45056
  s_mov_b32 s40, 917504
  buffer_load_dwordx4 v127, s[28:31], s40 offen  lds
  s_add_u32 m0, s38, 49152
  s_mov_b32 s40, 524288
  buffer_load_dwordx4 v126, s[28:31], s40 offen  lds
  s_add_u32 m0, s38, 53248
  s_mov_b32 s40, 655360
  buffer_load_dwordx4 v126, s[28:31], s40 offen  lds
  s_add_u32 m0, s38, 57344
  s_mov_b32 s40, 786432
  buffer_load_dwordx4 v126, s[28:31], s40 offen  lds
  s_add_u32 m0, s38, 61440
  s_mov_b32 s40, 917504
  buffer_load_dwordx4 v126, s[28:31], s40 offen  lds
  v_add_u32 v108, 65536, v101
  v_add_u32 v109, 65536, v102
  v_add_u32 v110, 65536, v96
  v_add_u32 v111, 65536, v97
  ds_read_b64_tr_b16 v[80:81], v108 offset:0
  ds_read_b64_tr_b16 v[82:83], v108 offset:256
  ds_read_b64_tr_b16 v[84:85], v108 offset:8192
  ds_read_b64_tr_b16 v[86:87], v108 offset:8448
  ds_read_b64_tr_b16 v[88:89], v109 offset:0
  ds_read_b64_tr_b16 v[90:91], v109 offset:256
  ds_read_b64_tr_b16 v[92:93], v109 offset:8192
  ds_read_b64_tr_b16 v[94:95], v109 offset:8448
  ds_read_b64_tr_b16 a[16:17], v110 offset:0
  ds_read_b64_tr_b16 a[18:19], v110 offset:256
  ds_read_b64_tr_b16 a[20:21], v110 offset:8192
  ds_read_b64_tr_b16 a[22:23], v110 offset:8448
  ds_read_b64_tr_b16 a[24:25], v111 offset:0
  ds_read_b64_tr_b16 a[26:27], v111 offset:256
  ds_read_b64_tr_b16 a[28:29], v111 offset:8192
  ds_read_b64_tr_b16 a[30:31], v111 offset:8448
  buffer_load_dwordx4 v[116:119], v103, s[12:15], 0 offen
  buffer_load_dwordx4 v[120:123], v103, s[12:15], 0 offen offset:128
  s_waitcnt vmcnt(26)
  s_waitcnt lgkmcnt(0)
  s_barrier
  ds_write_b128 v4, v[64:67] offset:0
  ds_write_b128 v4, v[68:71] offset:1024
  ds_write_b128 v4, v[72:75] offset:8192
  ds_write_b128 v4, v[76:79] offset:9216
  ds_write_b128 v4, v[80:83] offset:16384
  ds_write_b128 v4, v[84:87] offset:17408
  ds_write_b128 v4, v[88:91] offset:24576
  ds_write_b128 v4, v[92:95] offset:25600
  v_add_u32 v108, 65536, v101
  v_add_u32 v109, 65536, v102
  v_add_u32 v110, 65536, v96
  v_add_u32 v111, 65536, v97
  ds_read_b64_tr_b16 v[64:65], v108 offset:32768
  ds_read_b64_tr_b16 v[66:67], v108 offset:33024
  ds_read_b64_tr_b16 v[68:69], v108 offset:40960
  ds_read_b64_tr_b16 v[70:71], v108 offset:41216
  ds_read_b64_tr_b16 v[72:73], v109 offset:32768
  ds_read_b64_tr_b16 v[74:75], v109 offset:33024
  ds_read_b64_tr_b16 v[76:77], v109 offset:40960
  ds_read_b64_tr_b16 v[78:79], v109 offset:41216
  ds_read_b64_tr_b16 a[64:65], v110 offset:32768
  ds_read_b64_tr_b16 a[66:67], v110 offset:33024
  ds_read_b64_tr_b16 a[68:69], v110 offset:40960
  ds_read_b64_tr_b16 a[70:71], v110 offset:41216
  ds_read_b64_tr_b16 a[72:73], v111 offset:32768
  ds_read_b64_tr_b16 a[74:75], v111 offset:33024
  ds_read_b64_tr_b16 a[76:77], v111 offset:40960
  ds_read_b64_tr_b16 a[78:79], v111 offset:41216
  s_waitcnt vmcnt(18)
  s_waitcnt lgkmcnt(0)
  s_barrier
  ds_write_b128 v4, v[64:67] offset:32768
  ds_write_b128 v4, v[68:71] offset:33792
  ds_write_b128 v4, v[72:75] offset:40960
  ds_write_b128 v4, v[76:79] offset:41984
  v_add_u32 v108, 131072, v101
  v_add_u32 v109, 131072, v102
  v_add_u32 v110, 131072, v96
  v_add_u32 v111, 131072, v97
  ds_read_b64_tr_b16 v[80:81], v108 offset:0
  ds_read_b64_tr_b16 v[82:83], v108 offset:256
  ds_read_b64_tr_b16 v[84:85], v108 offset:8192
  ds_read_b64_tr_b16 v[86:87], v108 offset:8448
  ds_read_b64_tr_b16 v[88:89], v109 offset:0
  ds_read_b64_tr_b16 v[90:91], v109 offset:256
  ds_read_b64_tr_b16 v[92:93], v109 offset:8192
  ds_read_b64_tr_b16 v[94:95], v109 offset:8448
  ds_read_b64_tr_b16 a[160:161], v110 offset:0
  ds_read_b64_tr_b16 a[162:163], v110 offset:256
  ds_read_b64_tr_b16 a[164:165], v110 offset:8192
  ds_read_b64_tr_b16 a[166:167], v110 offset:8448
  ds_read_b64_tr_b16 a[168:169], v111 offset:0
  ds_read_b64_tr_b16 a[170:171], v111 offset:256
  ds_read_b64_tr_b16 a[172:173], v111 offset:8192
  ds_read_b64_tr_b16 a[174:175], v111 offset:8448
  s_waitcnt vmcnt(10)
  s_waitcnt lgkmcnt(0)
  s_barrier
  ds_write_b128 v4, v[80:83] offset:49152
  ds_write_b128 v4, v[84:87] offset:50176
  ds_write_b128 v4, v[88:91] offset:57344
  ds_write_b128 v4, v[92:95] offset:58368
  ds_read_b64_tr_b16 v[64:65], v101 offset:0
  ds_read_b64_tr_b16 v[66:67], v101 offset:256
  ds_read_b64_tr_b16 v[68:69], v101 offset:8192
  ds_read_b64_tr_b16 v[70:71], v101 offset:8448
  ds_read_b64_tr_b16 v[72:73], v102 offset:0
  ds_read_b64_tr_b16 v[74:75], v102 offset:256
  ds_read_b64_tr_b16 v[76:77], v102 offset:8192
  ds_read_b64_tr_b16 v[78:79], v102 offset:8448
  ds_read_b64_tr_b16 a[192:193], v96 offset:0
  ds_read_b64_tr_b16 a[194:195], v96 offset:256
  ds_read_b64_tr_b16 a[196:197], v96 offset:8192
  ds_read_b64_tr_b16 a[198:199], v96 offset:8448
  ds_read_b64_tr_b16 a[200:201], v97 offset:0
  ds_read_b64_tr_b16 a[202:203], v97 offset:256
  ds_read_b64_tr_b16 a[204:205], v97 offset:8192
  ds_read_b64_tr_b16 a[206:207], v97 offset:8448
  s_waitcnt vmcnt(2)
  s_waitcnt lgkmcnt(0)
  s_barrier
  ds_write_b128 v5, v[64:67] offset:0
  ds_write_b128 v5, v[68:71] offset:1024
  ds_write_b128 v5, v[72:75] offset:8192
  ds_write_b128 v5, v[76:79] offset:9216
  ds_read_b64_tr_b16 v[80:81], v101 offset:32768
  ds_read_b64_tr_b16 v[82:83], v101 offset:33024
  ds_read_b64_tr_b16 v[84:85], v101 offset:40960
  ds_read_b64_tr_b16 v[86:87], v101 offset:41216
  ds_read_b64_tr_b16 v[88:89], v102 offset:32768
  ds_read_b64_tr_b16 v[90:91], v102 offset:33024
  ds_read_b64_tr_b16 v[92:93], v102 offset:40960
  ds_read_b64_tr_b16 v[94:95], v102 offset:41216
  ds_read_b64_tr_b16 v[128:129], v96 offset:32768
  ds_read_b64_tr_b16 v[130:131], v96 offset:33024
  ds_read_b64_tr_b16 v[132:133], v96 offset:40960
  ds_read_b64_tr_b16 v[134:135], v96 offset:41216
  ds_read_b64_tr_b16 v[136:137], v97 offset:32768
  ds_read_b64_tr_b16 v[138:139], v97 offset:33024
  ds_read_b64_tr_b16 v[140:141], v97 offset:40960
  ds_read_b64_tr_b16 v[142:143], v97 offset:41216
  s_waitcnt lgkmcnt(0)
  s_barrier
  ds_write_b128 v5, v[80:83] offset:16384
  ds_write_b128 v5, v[84:87] offset:17408
  ds_write_b128 v5, v[88:91] offset:24576
  ds_write_b128 v5, v[92:95] offset:25600
  ds_write_b128 v0, v[32:35] offset:32768
  ds_write_b128 v0, v[36:39] offset:33792
  ds_write_b128 v0, v[40:43] offset:40960
  ds_write_b128 v0, v[44:47] offset:41984
  ds_write_b128 v0, v[48:51] offset:49152
  ds_write_b128 v0, v[52:55] offset:50176
  ds_write_b128 v0, v[56:59] offset:57344
  ds_write_b128 v0, v[60:63] offset:58368
  s_waitcnt vmcnt(0)
  s_waitcnt lgkmcnt(0)
  s_mov_b32 s36, 0x05040100
  s_mov_b32 s37, 0x07060302
  v_perm_b32 v32, v118, v116, s36
  v_perm_b32 v33, v118, v116, s37
  v_perm_b32 v34, v119, v117, s36
  v_perm_b32 v35, v119, v117, s37
  v_perm_b32 v36, v122, v120, s36
  v_perm_b32 v37, v122, v120, s37
  v_perm_b32 v38, v123, v121, s36
  v_perm_b32 v39, v123, v121, s37
  ds_read_b128 v[48:51], v4 offset:0
  ds_read_b128 v[52:55], v4 offset:1024
  ds_read_b128 v[56:59], v4 offset:8192
  ds_read_b128 v[60:63], v4 offset:9216
  ds_read_b128 v[64:67], v4 offset:16384
  ds_read_b128 v[68:71], v4 offset:17408
  ds_read_b128 v[72:75], v4 offset:24576
  ds_read_b128 v[76:79], v4 offset:25600
  s_lshl_b32 s36, s16, 13
  s_add_u32 s38, s36, 2097152
  s_add_u32 s39, s36, 18874368
  s_add_u32 s40, s36, 52428800
  s_mov_b32 s41, 70516736
  s_cmp_eq_u32 s17, 0
  s_cselect_b32 s46, 1, 0
  s_mov_b32 s47, 0
  s_lshl_b32 m0, s17, 11
  s_add_u32 m0, m0, 20480
  s_mov_b32 s43, 0x3e0293ee
  s_mov_b32 s36, 0
  v_mov_b64 v[104:105], 0
  v_mov_b64 v[106:107], 0
  v_mov_b64 v[108:109], 0
  v_mov_b64 v[110:111], 0
  v_mov_b64 v[112:113], 0
  v_mov_b64 v[114:115], 0
  v_mov_b64 v[116:117], 0
  v_mov_b64 v[118:119], 0
  v_mov_b64 v[120:121], 0
  v_mov_b64 v[122:123], 0
  v_mov_b64 v[124:125], 0
  v_mov_b64 v[126:127], 0
  s_waitcnt lgkmcnt(0)
  v_mbcnt_lo_u32_b32 v21, -1, 0
  v_lshlrev_b32 v20, 2, v21
  v_add_u32 v20, s3, v20
  s_mov_b32 s99, 0
  s_mov_b64 exec, 15
CH_BP:
  buffer_load_dword v21, v20, s[8:11], 0 offen offset:64 sc1
  s_add_u32 s99, s99, 1
  s_cmp_gt_u32 s99, 0x20000
  s_cbranch_scc1 KEND
  s_waitcnt vmcnt(0)
  v_cmp_lt_u32 vcc, 0xffff, v21
  s_mov_b32 s98, 0
  s_cbranch_vccnz CH_BPX
  v_cmp_eq_u32 vcc, 32, v21
  s_and_b32 s97, vcc_lo, 15
  s_mov_b32 s98, 1
  s_cmp_eq_u32 s97, 15
  s_cbranch_scc1 CH_BPX
  s_branch CH_BP
CH_BPX:
  s_mov_b64 exec, -1
  s_cmp_eq_u32 s98, 0
  s_cbranch_scc1 FALLBACK
  s_movk_i32 s58, 0x2000
  s_mov_b32 s36, -1
  s_mov_b32 s37, 0
CH_R0:
  buffer_load_dword v20, v30, s[4:7], s58 offen sc1
  s_add_u32 s37, s37, 1
  s_cmp_gt_u32 s37, 0x20000
  s_cbranch_scc1 KEND
  s_waitcnt vmcnt(0)
  v_readlane_b32 s56, v20, 0
  v_readlane_b32 s57, v20, 1
  s_min_u32 s56, s56, s57
  s_sub_u32 s56, s56, 2
  s_cmp_lt_i32 s56, s36
  s_cbranch_scc1 CH_R0
  s_mov_b32 s36, 0
  buffer_load_dwordx4 v[80:83], v0, s[4:7], s38 offen sc1
  buffer_load_dwordx4 v[84:87], v0, s[4:7], s38 offen offset:1024 sc1
  buffer_load_dwordx4 v[88:91], v0, s[4:7], s39 offen sc1
  buffer_load_dwordx4 v[92:95], v0, s[4:7], s39 offen offset:1024 sc1
  s_add_u32 s39, s39, 262144
  s_add_u32 s38, s38, 262144
  v_mov_b32 v31, 0
  v_xor_b32 v21, 2048, v0
  v_xor_b32 v22, 4096, v0
  v_xor_b32 v23, 6144, v0
  s_waitcnt vmcnt(0)
  s_waitcnt lgkmcnt(0)
  s_cmp_eq_u32 s18, 0
  s_cbranch_scc1 CHS_LOOP
CHP_LOOP:
  ds_write_b128 v0, v[32:35] offset:0
  ds_write_b128 v0, v[36:39] offset:1024
  v_smfmac_f32_16x16x64_bf16 v[104:107], v[32:35], v[48:55], v9
  v_smfmac_f32_16x16x64_bf16 v[108:111], v[32:35], v[56:63], v9
  v_smfmac_f32_16x16x64_bf16 v[104:107], v[36:39], v[64:71], v9
  v_smfmac_f32_16x16x64_bf16 v[108:111], v[36:39], v[72:79], v9
  s_waitcnt lgkmcnt(0)
  s_barrier
  ds_read_b128 v[40:43], v21 offset:0
  ds_read_b128 v[44:47], v21 offset:1024
  ds_read_b128 v[48:51], v22 offset:0
  ds_read_b128 v[52:55], v22 offset:1024
  ds_read_b128 v[56:59], v23 offset:0
  ds_read_b128 v[60:63], v23 offset:1024
  v_smfmac_f32_16x16x64_bf16 v[112:115], v[32:35], a[80:87], v9
  s_mov_b64 exec, s[46:47]
  buffer_store_dword v31, v30, s[4:7], 0 offen sc1
  s_mov_b64 exec, -1
  v_smfmac_f32_16x16x64_bf16 v[116:119], v[32:35], a[88:95], v9
  s_cmp_lt_i32 s56, s36
  s_cbranch_scc1 CHP_ARS
CHP_ARB:
  v_smfmac_f32_16x16x64_bf16 v[112:115], v[36:39], a[96:103], v9
  v_smfmac_f32_16x16x64_bf16 v[116:119], v[36:39], a[104:111], v9
  v_smfmac_f32_16x16x64_bf16 v[120:123], v[32:35], a[192:199], v9
  ds_read_b128 v[64:67], v4 offset:32768
  v_smfmac_f32_16x16x64_bf16 v[124:127], v[32:35], a[200:207], v9
  ds_read_b128 v[68:71], v4 offset:33792
  v_smfmac_f32_16x16x64_bf16 v[120:123], v[36:39], a[208:215], v9
  ds_read_b128 v[72:75], v4 offset:40960
  v_smfmac_f32_16x16x64_bf16 v[124:127], v[36:39], a[216:223], v9
  ds_read_b128 v[76:79], v4 offset:41984
  s_waitcnt lgkmcnt(9)
  v_smfmac_f32_16x16x64_bf16 v[104:107], v[40:43], a[0:7], v9
  buffer_store_dwordx4 v[24:27], v0, s[4:7], s40 offen sc1
  v_smfmac_f32_16x16x64_bf16 v[108:111], v[40:43], a[8:15], v9
  s_waitcnt lgkmcnt(8)
  v_smfmac_f32_16x16x64_bf16 v[104:107], v[44:47], a[16:23], v9
  v_smfmac_f32_16x16x64_bf16 v[108:111], v[44:47], a[24:31], v9
  s_waitcnt lgkmcnt(7)
  v_smfmac_f32_16x16x64_bf16 v[104:107], v[48:51], a[32:39], v9
  buffer_load_dwordx4 v[96:99], v0, s[4:7], s39 offen sc1
  v_smfmac_f32_16x16x64_bf16 v[108:111], v[48:51], a[40:47], v9
  s_waitcnt lgkmcnt(0)
  v_smfmac_f32_16x16x64_bf16 v[104:107], v[52:55], v[64:71], v9
  v_smfmac_f32_16x16x64_bf16 v[108:111], v[52:55], v[72:79], v9
  ds_read_b128 v[64:67], v4 offset:49152
  v_smfmac_f32_16x16x64_bf16 v[104:107], v[56:59], a[48:55], v9
  ds_read_b128 v[68:71], v4 offset:50176
  buffer_load_dwordx4 v[100:103], v0, s[4:7], s39 offen offset:1024 sc1
  v_smfmac_f32_16x16x64_bf16 v[108:111], v[56:59], a[56:63], v9
  ds_read_b128 v[72:75], v4 offset:57344
  v_smfmac_f32_16x16x64_bf16 v[104:107], v[60:63], a[64:71], v9
  ds_read_b128 v[76:79], v4 offset:58368
  v_smfmac_f32_16x16x64_bf16 v[108:111], v[60:63], a[72:79], v9
  v_smfmac_f32_16x16x64_bf16 v[112:115], v[40:43], a[112:119], v9
  buffer_store_dwordx4 v[28:31], v0, s[4:7], s40 offen offset:1024 sc1
  v_smfmac_f32_16x16x64_bf16 v[116:119], v[40:43], a[120:127], v9
  v_add_f32 v104, v104, v105
  v_add_f32 v106, v106, v107
  v_smfmac_f32_16x16x64_bf16 v[112:115], v[44:47], a[128:135], v9
  v_add_f32 v108, v108, v109
  v_add_f32 v110, v110, v111
  v_cvt_pk_bf16_f32 v24, v104, v106
  v_cvt_pk_bf16_f32 v25, v108, v110
  v_smfmac_f32_16x16x64_bf16 v[116:119], v[44:47], a[136:143], v9
  s_waitcnt lgkmcnt(0)
  v_mfma_f32_16x16x16_bf16 v[104:107], v[24:25], v[12:13], 0
  v_mfma_f32_16x16x16_bf16 v[108:111], v[24:25], v[14:15], 0
  v_smfmac_f32_16x16x64_bf16 v[112:115], v[48:51], v[64:71], v9
  v_smfmac_f32_16x16x64_bf16 v[116:119], v[48:51], v[72:79], v9
  ds_read_b128 v[64:67], v5 offset:0
  s_nop 0
  v_cvt_pk_bf16_f32 v20, v104, v105
  v_cvt_pk_bf16_f32 v21, v106, v107
  v_smfmac_f32_16x16x64_bf16 v[112:115], v[52:55], a[144:151], v9
  ds_read_b128 v[68:71], v5 offset:1024
  v_cvt_pk_bf16_f32 v22, v108, v109
  v_cvt_pk_bf16_f32 v23, v110, v111
  v_smfmac_f32_16x16x64_bf16 v[116:119], v[52:55], a[152:159], v9
  ds_read_b128 v[72:75], v5 offset:8192
  v_mfma_f32_16x16x32_bf16 v[104:107], v[80:83], v[20:23], 0
  v_mfma_f32_16x16x32_bf16 v[108:111], v[84:87], v[20:23], 0
  v_smfmac_f32_16x16x64_bf16 v[112:115], v[56:59], a[160:167], v9
  ds_read_b128 v[76:79], v5 offset:9216
  v_smfmac_f32_16x16x64_bf16 v[116:119], v[56:59], a[168:175], v9
  v_smfmac_f32_16x16x64_bf16 v[112:115], v[60:63], a[176:183], v9
  s_nop 0
  v_cndmask_b32 v104, v104, v108, s[44:45]
  v_cndmask_b32 v105, v105, v109, s[44:45]
  v_cndmask_b32 v106, v106, v110, s[44:45]
  v_cndmask_b32 v107, v107, v111, s[44:45]
  v_smfmac_f32_16x16x64_bf16 v[116:119], v[60:63], a[184:191], v9
  ds_write_b128 v0, v[104:107] offset:8192
  v_smfmac_f32_16x16x64_bf16 v[120:123], v[44:47], a[224:231], v9
  v_smfmac_f32_16x16x64_bf16 v[124:127], v[44:47], a[232:239], v9
  v_add_f32 v112, v112, v113
  v_add_f32 v114, v114, v115
  s_nop 0
  v_add_f32 v116, v116, v117
  v_add_f32 v118, v118, v119
  v_cvt_pk_bf16_f32 v24, v112, v114
  v_cvt_pk_bf16_f32 v25, v116, v118
  s_waitcnt lgkmcnt(0)
  s_barrier
  ds_read_b128 v[104:107], v1 offset:8192
  ds_read_b128 v[108:111], v1 offset:10240
  ds_read_b128 v[32:35], v1 offset:12288
  ds_read_b128 v[36:39], v1 offset:14336
  v_mfma_f32_16x16x16_bf16 v[112:115], v[24:25], v[12:13], 0
  v_mfma_f32_16x16x16_bf16 v[116:119], v[24:25], v[14:15], 0
  v_smfmac_f32_16x16x64_bf16 v[120:123], v[40:43], v[64:71], v9
  buffer_load_dwordx4 v[80:83], v0, s[4:7], s38 offen sc1
  v_smfmac_f32_16x16x64_bf16 v[124:127], v[40:43], v[72:79], v9
  ds_read_b128 v[64:67], v5 offset:16384
  v_cvt_pk_bf16_f32 v24, v112, v113
  v_cvt_pk_bf16_f32 v25, v114, v115
  v_cvt_pk_bf16_f32 v26, v116, v117
  v_cvt_pk_bf16_f32 v27, v118, v119
  v_smfmac_f32_16x16x64_bf16 v[120:123], v[48:51], a[240:247], v9
  ds_read_b128 v[68:71], v5 offset:17408
  v_mfma_f32_16x16x32_bf16 v[112:115], v[24:27], v[20:23], 0
  v_smfmac_f32_16x16x64_bf16 v[124:127], v[48:51], a[248:255], v9
  ds_read_b128 v[72:75], v5 offset:24576
  s_waitcnt lgkmcnt(5)
  v_add_f32 v104, v104, v108
  v_add_f32 v105, v105, v109
  v_add_f32 v106, v106, v110
  v_add_f32 v107, v107, v111
  v_cndmask_b32 v112, v112, v114, s[44:45]
  ds_write_b32 v2, v112 offset:16384
  v_smfmac_f32_16x16x64_bf16 v[120:123], v[52:55], v[128:135], v9
  ds_read_b128 v[76:79], v5 offset:25600
  s_waitcnt lgkmcnt(5)
  v_add_f32 v32, v32, v36
  v_add_f32 v33, v33, v37
  v_add_f32 v34, v34, v38
  v_add_f32 v35, v35, v39
  v_smfmac_f32_16x16x64_bf16 v[124:127], v[52:55], v[136:143], v9
  v_add_f32 v104, v104, v32
  v_add_f32 v105, v105, v33
  v_add_f32 v106, v106, v34
  v_add_f32 v107, v107, v35
  s_waitcnt lgkmcnt(0)
  s_barrier
  ds_read_b128 v[116:119], v1 offset:16384
  v_max3_f32 v108, v104, v105, v106
  v_max_f32 v108, v108, v107
  v_smfmac_f32_16x16x64_bf16 v[120:123], v[56:59], v[144:151], v9
  buffer_load_dwordx4 v[84:87], v0, s[4:7], s38 offen offset:1024 sc1
  v_mov_b32 v20, 0x3f803f80
  v_max_f32_dpp v108, v108, v108 quad_perm:[1,0,3,2] row_mask:0xf bank_mask:0xf
  v_mov_b32 v109, v108
  v_smfmac_f32_16x16x64_bf16 v[124:127], v[56:59], v[152:159], v9
  v_mov_b32 v21, 0x3f803f80
  v_permlane16_swap_b32 v108, v109
  v_max_f32 v108, v108, v109
  v_mov_b32 v109, v108
  v_smfmac_f32_16x16x64_bf16 v[120:123], v[60:63], v[64:71], v9
  v_smfmac_f32_16x16x64_bf16 v[124:127], v[60:63], v[72:79], v9
  v_permlane32_swap_b32 v108, v109
  v_max_f32 v108, v108, v109
  v_mul_f32 v108, s43, v108
  ds_read_b128 v[64:67], v0 offset:32768
  v_fma_f32 v104, v104, s43, -v108
  v_fma_f32 v105, v105, s43, -v108
  v_fma_f32 v106, v106, s43, -v108
  v_fma_f32 v107, v107, s43, -v108
  v_mfma_f32_32x32x8_bf16 v[48:63], v[12:13], v[14:15], 0
  ds_read_b128 v[68:71], v0 offset:33792
  v_exp_f32 v104, v104
  v_exp_f32 v105, v105
  v_exp_f32 v106, v106
  v_exp_f32 v107, v107
  s_waitcnt lgkmcnt(2)
  v_add_f32 v116, v116, v117
  v_add_f32 v118, v118, v119
  v_cvt_pk_bf16_f32 v110, v104, v105
  v_cvt_pk_bf16_f32 v111, v106, v107
  v_add_f32 v116, v116, v118
  v_fma_f32 v116, v116, s43, -v108
  v_mfma_f32_16x16x16_bf16 v[112:115], v[20:21], v[110:111], 0
  ds_read_b128 v[72:75], v0 offset:40960
  v_and_b32_dpp v32, v110, v10 quad_perm:[0,0,2,2] row_mask:0xf bank_mask:0xf
  v_and_b32_dpp v33, v111, v10 quad_perm:[0,0,2,2] row_mask:0xf bank_mask:0xf
  v_and_b32_dpp v34, v110, v10 quad_perm:[1,1,3,3] row_mask:0xf bank_mask:0xf
  v_and_b32_dpp v35, v111, v10 quad_perm:[1,1,3,3] row_mask:0xf bank_mask:0xf
  v_cmp_lt_f32 vcc, 0x42700000, v116
  v_add_f32 v120, v120, v121
  v_mfma_f32_16x16x32_bf16 v[104:107], v[88:91], v[32:35], 0
  ds_read_b128 v[76:79], v0 offset:41984
  v_and_b32_dpp v36, v110, v11 quad_perm:[0,0,2,2] row_mask:0xf bank_mask:0xf
  v_and_b32_dpp v37, v111, v11 quad_perm:[0,0,2,2] row_mask:0xf bank_mask:0xf
  v_and_b32_dpp v38, v110, v11 quad_perm:[1,1,3,3] row_mask:0xf bank_mask:0xf
  v_and_b32_dpp v39, v111, v11 quad_perm:[1,1,3,3] row_mask:0xf bank_mask:0xf
  v_add_f32_dpp v112, v112, v112 quad_perm:[1,0,3,2] row_mask:0xf bank_mask:0xf
  v_add_f32 v122, v122, v123
  v_mfma_f32_16x16x32_bf16 v[104:107], v[92:95], v[36:39], v[104:107]
  s_cbranch_vccnz CHP_AMX
CHP_AMB:
  v_exp_f32 v116, v116
  v_add_f32 v124, v124, v125
  v_add_f32 v126, v126, v127
  v_mov_b32_dpp v117, v116 quad_perm:[0,0,2,2] row_mask:0xf bank_mask:0xf
  v_mov_b32_dpp v118, v116 quad_perm:[1,1,3,3] row_mask:0xf bank_mask:0xf
  v_cvt_pk_bf16_f32 v117, v117, v118
  v_and_b32 v22, v117, v10
  v_and_b32 v23, v117, v11
  v_cvt_pk_bf16_f32 v28, v120, v122
  v_cvt_pk_bf16_f32 v29, v124, v126
  v_mfma_f32_16x16x16_bf16 v[112:115], v[20:21], v[22:23], v[112:115]
  v_mfma_f32_16x16x16_bf16 v[104:107], v[28:29], v[22:23], v[104:107]
  v_mfma_f32_32x32x8_bf16 v[32:47], v[12:13], v[14:15], 0
  s_add_u32 s39, s39, 262144
  s_add_u32 s38, s38, 262144
  s_nop 1
  v_rcp_f32 v108, v112
  s_nop 0
  v_mul_f32 v104, v104, v108
  v_mul_f32 v105, v105, v108
  v_mul_f32 v106, v106, v108
  v_mul_f32 v107, v107, v108
  v_cvt_pk_bf16_f32 v110, v104, v105
  v_cvt_pk_bf16_f32 v111, v106, v107
  ds_write_b64 v3, v[110:111] offset:17408
  s_waitcnt lgkmcnt(0)
  s_barrier
  ds_read_b128 v[120:123], v1 offset:17408
  ds_read_b128 v[124:127], v1 offset:18432
  buffer_load_dword v31, v30, s[4:7], s58 offen sc1
  s_waitcnt lgkmcnt(1)
  v_smfmac_f32_16x16x64_bf16 v[32:35], v[120:123], v[64:71], v9
  v_smfmac_f32_16x16x64_bf16 v[36:39], v[120:123], v[72:79], v9
  ds_read_b128 v[64:67], v0 offset:49152
  s_waitcnt lgkmcnt(1)
  v_smfmac_f32_16x16x64_bf16 v[32:35], v[124:127], v[192:199], v9
  ds_read_b128 v[68:71], v0 offset:50176
  v_smfmac_f32_16x16x64_bf16 v[36:39], v[124:127], v[200:207], v9
  ds_read_b128 v[72:75], v0 offset:57344
  v_smfmac_f32_16x16x64_bf16 v[40:43], v[120:123], v[160:167], v9
  ds_read_b128 v[76:79], v0 offset:58368
  v_smfmac_f32_16x16x64_bf16 v[44:47], v[120:123], v[168:175], v9
  v_smfmac_f32_16x16x64_bf16 v[40:43], v[124:127], v[208:215], v9
  v_add_f32 v32, v32, v33
  v_add_f32 v34, v34, v35
  v_smfmac_f32_16x16x64_bf16 v[44:47], v[124:127], v[216:223], v9
  v_cvt_pk_bf16_f32 v104, v32, v34
  v_or_b32 v104, 1, v104
  v_smfmac_f32_16x16x64_bf16 v[48:51], v[120:123], v[176:183], v9
  v_add_f32 v36, v36, v37
  v_add_f32 v38, v38, v39
  v_smfmac_f32_16x16x64_bf16 v[52:55], v[120:123], v[184:191], v9
  v_cvt_pk_bf16_f32 v105, v36, v38
  v_smfmac_f32_16x16x64_bf16 v[48:51], v[124:127], v[224:231], v9
  v_add_f32 v40, v40, v41
  v_add_f32 v42, v42, v43
  v_smfmac_f32_16x16x64_bf16 v[52:55], v[124:127], v[232:239], v9
  v_cvt_pk_bf16_f32 v106, v40, v42
  v_add_f32 v44, v44, v45
  s_waitcnt lgkmcnt(0)
  v_smfmac_f32_16x16x64_bf16 v[56:59], v[120:123], v[64:71], v9
  v_add_f32 v46, v46, v47
  v_cvt_pk_bf16_f32 v107, v44, v46
  v_smfmac_f32_16x16x64_bf16 v[60:63], v[120:123], v[72:79], v9
  buffer_store_dwordx4 v[104:107], v6, s[4:7], 0 offen
  v_smfmac_f32_16x16x64_bf16 v[56:59], v[124:127], v[240:247], v9
  v_add_f32 v48, v48, v49
  v_add_f32 v50, v50, v51
  v_smfmac_f32_16x16x64_bf16 v[60:63], v[124:127], v[248:255], v9
  v_cvt_pk_bf16_f32 v108, v48, v50
  v_or_b32 v108, 1, v108
  v_add_f32 v52, v52, v53
  v_add_f32 v54, v54, v55
  v_cvt_pk_bf16_f32 v109, v52, v54
  v_add_f32 v56, v56, v57
  v_add_f32 v58, v58, v59
  v_cvt_pk_bf16_f32 v110, v56, v58
  v_add_f32 v60, v60, v61
  v_add_f32 v62, v62, v63
  v_cvt_pk_bf16_f32 v111, v60, v62
  buffer_store_dwordx4 v[108:111], v6, s[4:7], s42 offen
  ds_read_b128 v[48:51], v4 offset:0
  ds_read_b128 v[52:55], v4 offset:1024
  ds_read_b128 v[56:59], v4 offset:8192
  ds_read_b128 v[60:63], v4 offset:9216
  ds_read_b128 v[64:67], v4 offset:16384
  ds_read_b128 v[68:71], v4 offset:17408
  ds_read_b128 v[72:75], v4 offset:24576
  ds_read_b128 v[76:79], v4 offset:25600
  s_add_u32 s36, s36, 1
  s_mov_b32 s37, 0
  s_add_u32 s40, s40, 262144
  v_mov_b64 v[112:113], 0
  v_mov_b64 v[114:115], 0
  v_mov_b64 v[116:117], 0
  v_mov_b64 v[118:119], 0
  v_mov_b64 v[120:121], 0
  v_mov_b64 v[122:123], 0
  v_mov_b64 v[124:125], 0
  v_mov_b64 v[126:127], 0
  v_mov_b64 v[104:105], 0
  v_mov_b64 v[106:107], 0
  v_mov_b64 v[108:109], 0
  v_mov_b64 v[110:111], 0
  s_waitcnt vmcnt(0)
CHP_AP1:
  buffer_load_dwordx4 v[40:43], v7, s[4:7], 0 offen sc1
  buffer_load_dwordx4 v[44:47], v7, s[4:7], 0 offen offset:1024 sc1
  s_add_u32 s37, s37, 1
  s_cmp_gt_u32 s37, 0x20000
  s_cbranch_scc1 KEND
  s_waitcnt vmcnt(1)
  v_mfma_f32_16x16x32_bf16 v[32:35], v[40:43], v[16:19], 0
  s_waitcnt vmcnt(0)
  v_mfma_f32_16x16x32_bf16 v[32:35], v[44:47], v[16:19], v[32:35]
  v_bitop3_b32 v20, v40, v44, 1 bitop3:0x80
  v_cmpx_ne_u32 vcc, 1, v20
  s_cbranch_vccnz CHP_AP1
  s_mov_b64 exec, -1
  s_nop 3
  v_add_f32 v32, v32, v33
  v_add_f32 v34, v34, v35
  v_add_f32 v32, v32, v34
  s_nop 1
  v_mov_b32_dpp v33, v32 quad_perm:[2,3,2,3] row_mask:0xf bank_mask:0xf
  v_cvt_pk_bf16_f32 v32, v32, v33
  v_or_b32 v32, 1, v32
  buffer_store_dword v32, v8, s[4:7], 0 offen
  v_readlane_b32 s56, v31, 0
  v_readlane_b32 s57, v31, 1
  s_min_u32 s56, s56, s57
  s_sub_u32 s56, s56, 2
  v_mov_b32 v31, s36
  v_xor_b32 v21, 2048, v0
  v_xor_b32 v22, 4096, v0
  v_xor_b32 v23, 6144, v0
  s_waitcnt lgkmcnt(0)
  s_mov_b32 s37, 0
  s_waitcnt vmcnt(0)
CHP_AP2:
  buffer_load_dwordx4 v[32:35], v0, s[4:7], s41 offen sc1
  buffer_load_dwordx4 v[36:39], v0, s[4:7], s41 offen offset:1024 sc1
CHP_AP2C:
  s_add_u32 s37, s37, 1
  s_cmp_gt_u32 s37, 0x20000
  s_cbranch_scc1 KEND
  s_waitcnt vmcnt(1)
  v_bitop3_b32 v20, v32, v33, v34 bitop3:0x80
  s_waitcnt vmcnt(0)
  v_bitop3_b32 v20, v20, v35, v36 bitop3:0x80
  v_bitop3_b32 v20, v20, v37, v38 bitop3:0x80
  v_bitop3_b32 v20, v20, v39, 1 bitop3:0x80
  v_cmpx_ne_u32 vcc, 1, v20
  s_cbranch_vccnz CHP_AP2
  s_mov_b64 exec, -1
CHP_AP2D:
  ds_write_b128 v0, v[32:35] offset:0
  ds_write_b128 v0, v[36:39] offset:1024
  v_smfmac_f32_16x16x64_bf16 v[104:107], v[32:35], v[48:55], v9
  v_smfmac_f32_16x16x64_bf16 v[108:111], v[32:35], v[56:63], v9
  v_smfmac_f32_16x16x64_bf16 v[104:107], v[36:39], v[64:71], v9
  v_smfmac_f32_16x16x64_bf16 v[108:111], v[36:39], v[72:79], v9
  s_waitcnt lgkmcnt(0)
  s_barrier
  ds_read_b128 v[40:43], v21 offset:0
  ds_read_b128 v[44:47], v21 offset:1024
  ds_read_b128 v[48:51], v22 offset:0
  ds_read_b128 v[52:55], v22 offset:1024
  ds_read_b128 v[56:59], v23 offset:0
  ds_read_b128 v[60:63], v23 offset:1024
  v_smfmac_f32_16x16x64_bf16 v[112:115], v[32:35], a[80:87], v9
  s_mov_b64 exec, s[46:47]
  buffer_store_dword v31, v30, s[4:7], 0 offen sc1
  s_mov_b64 exec, -1
  v_smfmac_f32_16x16x64_bf16 v[116:119], v[32:35], a[88:95], v9
  s_cmp_lt_i32 s56, s36
  s_cbranch_scc1 CHP_BRS
CHP_BRB:
  v_smfmac_f32_16x16x64_bf16 v[112:115], v[36:39], a[96:103], v9
  v_smfmac_f32_16x16x64_bf16 v[116:119], v[36:39], a[104:111], v9
  v_smfmac_f32_16x16x64_bf16 v[120:123], v[32:35], a[192:199], v9
  ds_read_b128 v[64:67], v4 offset:32768
  v_smfmac_f32_16x16x64_bf16 v[124:127], v[32:35], a[200:207], v9
  ds_read_b128 v[68:71], v4 offset:33792
  v_smfmac_f32_16x16x64_bf16 v[120:123], v[36:39], a[208:215], v9
  ds_read_b128 v[72:75], v4 offset:40960
  v_smfmac_f32_16x16x64_bf16 v[124:127], v[36:39], a[216:223], v9
  ds_read_b128 v[76:79], v4 offset:41984
  s_waitcnt lgkmcnt(9)
  v_smfmac_f32_16x16x64_bf16 v[104:107], v[40:43], a[0:7], v9
  buffer_store_dwordx4 v[24:27], v0, s[4:7], s40 offen sc1
  v_smfmac_f32_16x16x64_bf16 v[108:111], v[40:43], a[8:15], v9
  s_waitcnt lgkmcnt(8)
  v_smfmac_f32_16x16x64_bf16 v[104:107], v[44:47], a[16:23], v9
  v_smfmac_f32_16x16x64_bf16 v[108:111], v[44:47], a[24:31], v9
  s_waitcnt lgkmcnt(7)
  v_smfmac_f32_16x16x64_bf16 v[104:107], v[48:51], a[32:39], v9
  buffer_load_dwordx4 v[88:91], v0, s[4:7], s39 offen sc1
  v_smfmac_f32_16x16x64_bf16 v[108:111], v[48:51], a[40:47], v9
  s_waitcnt lgkmcnt(0)
  v_smfmac_f32_16x16x64_bf16 v[104:107], v[52:55], v[64:71], v9
  v_smfmac_f32_16x16x64_bf16 v[108:111], v[52:55], v[72:79], v9
  ds_read_b128 v[64:67], v4 offset:49152
  v_smfmac_f32_16x16x64_bf16 v[104:107], v[56:59], a[48:55], v9
  ds_read_b128 v[68:71], v4 offset:50176
  buffer_load_dwordx4 v[92:95], v0, s[4:7], s39 offen offset:1024 sc1
  v_smfmac_f32_16x16x64_bf16 v[108:111], v[56:59], a[56:63], v9
  ds_read_b128 v[72:75], v4 offset:57344
  v_smfmac_f32_16x16x64_bf16 v[104:107], v[60:63], a[64:71], v9
  ds_read_b128 v[76:79], v4 offset:58368
  v_smfmac_f32_16x16x64_bf16 v[108:111], v[60:63], a[72:79], v9
  v_smfmac_f32_16x16x64_bf16 v[112:115], v[40:43], a[112:119], v9
  buffer_store_dwordx4 v[28:31], v0, s[4:7], s40 offen offset:1024 sc1
  v_smfmac_f32_16x16x64_bf16 v[116:119], v[40:43], a[120:127], v9
  v_add_f32 v104, v104, v105
  v_add_f32 v106, v106, v107
  v_smfmac_f32_16x16x64_bf16 v[112:115], v[44:47], a[128:135], v9
  v_add_f32 v108, v108, v109
  v_add_f32 v110, v110, v111
  v_cvt_pk_bf16_f32 v24, v104, v106
  v_cvt_pk_bf16_f32 v25, v108, v110
  v_smfmac_f32_16x16x64_bf16 v[116:119], v[44:47], a[136:143], v9
  s_waitcnt lgkmcnt(0)
  v_mfma_f32_16x16x16_bf16 v[104:107], v[24:25], v[12:13], 0
  v_mfma_f32_16x16x16_bf16 v[108:111], v[24:25], v[14:15], 0
  v_smfmac_f32_16x16x64_bf16 v[112:115], v[48:51], v[64:71], v9
  v_smfmac_f32_16x16x64_bf16 v[116:119], v[48:51], v[72:79], v9
  ds_read_b128 v[64:67], v5 offset:0
  s_nop 0
  v_cvt_pk_bf16_f32 v20, v104, v105
  v_cvt_pk_bf16_f32 v21, v106, v107
  v_smfmac_f32_16x16x64_bf16 v[112:115], v[52:55], a[144:151], v9
  ds_read_b128 v[68:71], v5 offset:1024
  v_cvt_pk_bf16_f32 v22, v108, v109
  v_cvt_pk_bf16_f32 v23, v110, v111
  v_smfmac_f32_16x16x64_bf16 v[116:119], v[52:55], a[152:159], v9
  ds_read_b128 v[72:75], v5 offset:8192
  v_mfma_f32_16x16x32_bf16 v[104:107], v[80:83], v[20:23], 0
  v_mfma_f32_16x16x32_bf16 v[108:111], v[84:87], v[20:23], 0
  v_smfmac_f32_16x16x64_bf16 v[112:115], v[56:59], a[160:167], v9
  ds_read_b128 v[76:79], v5 offset:9216
  v_smfmac_f32_16x16x64_bf16 v[116:119], v[56:59], a[168:175], v9
  v_smfmac_f32_16x16x64_bf16 v[112:115], v[60:63], a[176:183], v9
  s_nop 0
  v_cndmask_b32 v104, v104, v108, s[44:45]
  v_cndmask_b32 v105, v105, v109, s[44:45]
  v_cndmask_b32 v106, v106, v110, s[44:45]
  v_cndmask_b32 v107, v107, v111, s[44:45]
  v_smfmac_f32_16x16x64_bf16 v[116:119], v[60:63], a[184:191], v9
  ds_write_b128 v0, v[104:107] offset:8192
  v_smfmac_f32_16x16x64_bf16 v[120:123], v[44:47], a[224:231], v9
  v_smfmac_f32_16x16x64_bf16 v[124:127], v[44:47], a[232:239], v9
  v_add_f32 v112, v112, v113
  v_add_f32 v114, v114, v115
  s_nop 0
  v_add_f32 v116, v116, v117
  v_add_f32 v118, v118, v119
  v_cvt_pk_bf16_f32 v24, v112, v114
  v_cvt_pk_bf16_f32 v25, v116, v118
  s_waitcnt lgkmcnt(0)
  s_barrier
  ds_read_b128 v[104:107], v1 offset:8192
  ds_read_b128 v[108:111], v1 offset:10240
  ds_read_b128 v[32:35], v1 offset:12288
  ds_read_b128 v[36:39], v1 offset:14336
  v_mfma_f32_16x16x16_bf16 v[112:115], v[24:25], v[12:13], 0
  v_mfma_f32_16x16x16_bf16 v[116:119], v[24:25], v[14:15], 0
  v_smfmac_f32_16x16x64_bf16 v[120:123], v[40:43], v[64:71], v9
  buffer_load_dwordx4 v[80:83], v0, s[4:7], s38 offen sc1
  v_smfmac_f32_16x16x64_bf16 v[124:127], v[40:43], v[72:79], v9
  ds_read_b128 v[64:67], v5 offset:16384
  v_cvt_pk_bf16_f32 v24, v112, v113
  v_cvt_pk_bf16_f32 v25, v114, v115
  v_cvt_pk_bf16_f32 v26, v116, v117
  v_cvt_pk_bf16_f32 v27, v118, v119
  v_smfmac_f32_16x16x64_bf16 v[120:123], v[48:51], a[240:247], v9
  ds_read_b128 v[68:71], v5 offset:17408
  v_mfma_f32_16x16x32_bf16 v[112:115], v[24:27], v[20:23], 0
  v_smfmac_f32_16x16x64_bf16 v[124:127], v[48:51], a[248:255], v9
  ds_read_b128 v[72:75], v5 offset:24576
  s_waitcnt lgkmcnt(5)
  v_add_f32 v104, v104, v108
  v_add_f32 v105, v105, v109
  v_add_f32 v106, v106, v110
  v_add_f32 v107, v107, v111
  v_cndmask_b32 v112, v112, v114, s[44:45]
  ds_write_b32 v2, v112 offset:16384
  v_smfmac_f32_16x16x64_bf16 v[120:123], v[52:55], v[128:135], v9
  ds_read_b128 v[76:79], v5 offset:25600
  s_waitcnt lgkmcnt(5)
  v_add_f32 v32, v32, v36
  v_add_f32 v33, v33, v37
  v_add_f32 v34, v34, v38
  v_add_f32 v35, v35, v39
  v_smfmac_f32_16x16x64_bf16 v[124:127], v[52:55], v[136:143], v9
  v_add_f32 v104, v104, v32
  v_add_f32 v105, v105, v33
  v_add_f32 v106, v106, v34
  v_add_f32 v107, v107, v35
  s_waitcnt lgkmcnt(0)
  s_barrier
  ds_read_b128 v[116:119], v1 offset:16384
  v_max3_f32 v108, v104, v105, v106
  v_max_f32 v108, v108, v107
  v_smfmac_f32_16x16x64_bf16 v[120:123], v[56:59], v[144:151], v9
  buffer_load_dwordx4 v[84:87], v0, s[4:7], s38 offen offset:1024 sc1
  v_mov_b32 v20, 0x3f803f80
  v_max_f32_dpp v108, v108, v108 quad_perm:[1,0,3,2] row_mask:0xf bank_mask:0xf
  v_mov_b32 v109, v108
  v_smfmac_f32_16x16x64_bf16 v[124:127], v[56:59], v[152:159], v9
  v_mov_b32 v21, 0x3f803f80
  v_permlane16_swap_b32 v108, v109
  v_max_f32 v108, v108, v109
  v_mov_b32 v109, v108
  v_smfmac_f32_16x16x64_bf16 v[120:123], v[60:63], v[64:71], v9
  v_smfmac_f32_16x16x64_bf16 v[124:127], v[60:63], v[72:79], v9
  v_permlane32_swap_b32 v108, v109
  v_max_f32 v108, v108, v109
  v_mul_f32 v108, s43, v108
  ds_read_b128 v[64:67], v0 offset:32768
  v_fma_f32 v104, v104, s43, -v108
  v_fma_f32 v105, v105, s43, -v108
  v_fma_f32 v106, v106, s43, -v108
  v_fma_f32 v107, v107, s43, -v108
  v_mfma_f32_32x32x8_bf16 v[48:63], v[12:13], v[14:15], 0
  ds_read_b128 v[68:71], v0 offset:33792
  v_exp_f32 v104, v104
  v_exp_f32 v105, v105
  v_exp_f32 v106, v106
  v_exp_f32 v107, v107
  s_waitcnt lgkmcnt(2)
  v_add_f32 v116, v116, v117
  v_add_f32 v118, v118, v119
  v_cvt_pk_bf16_f32 v110, v104, v105
  v_cvt_pk_bf16_f32 v111, v106, v107
  v_add_f32 v116, v116, v118
  v_fma_f32 v116, v116, s43, -v108
  v_mfma_f32_16x16x16_bf16 v[112:115], v[20:21], v[110:111], 0
  ds_read_b128 v[72:75], v0 offset:40960
  v_and_b32_dpp v32, v110, v10 quad_perm:[0,0,2,2] row_mask:0xf bank_mask:0xf
  v_and_b32_dpp v33, v111, v10 quad_perm:[0,0,2,2] row_mask:0xf bank_mask:0xf
  v_and_b32_dpp v34, v110, v10 quad_perm:[1,1,3,3] row_mask:0xf bank_mask:0xf
  v_and_b32_dpp v35, v111, v10 quad_perm:[1,1,3,3] row_mask:0xf bank_mask:0xf
  v_cmp_lt_f32 vcc, 0x42700000, v116
  v_add_f32 v120, v120, v121
  v_mfma_f32_16x16x32_bf16 v[104:107], v[96:99], v[32:35], 0
  ds_read_b128 v[76:79], v0 offset:41984
  v_and_b32_dpp v36, v110, v11 quad_perm:[0,0,2,2] row_mask:0xf bank_mask:0xf
  v_and_b32_dpp v37, v111, v11 quad_perm:[0,0,2,2] row_mask:0xf bank_mask:0xf
  v_and_b32_dpp v38, v110, v11 quad_perm:[1,1,3,3] row_mask:0xf bank_mask:0xf
  v_and_b32_dpp v39, v111, v11 quad_perm:[1,1,3,3] row_mask:0xf bank_mask:0xf
  v_add_f32_dpp v112, v112, v112 quad_perm:[1,0,3,2] row_mask:0xf bank_mask:0xf
  v_add_f32 v122, v122, v123
  v_mfma_f32_16x16x32_bf16 v[104:107], v[100:103], v[36:39], v[104:107]
  s_cbranch_vccnz CHP_BMX
CHP_BMB:
  v_exp_f32 v116, v116
  v_add_f32 v124, v124, v125
  v_add_f32 v126, v126, v127
  v_mov_b32_dpp v117, v116 quad_perm:[0,0,2,2] row_mask:0xf bank_mask:0xf
  v_mov_b32_dpp v118, v116 quad_perm:[1,1,3,3] row_mask:0xf bank_mask:0xf
  v_cvt_pk_bf16_f32 v117, v117, v118
  v_and_b32 v22, v117, v10
  v_and_b32 v23, v117, v11
  v_cvt_pk_bf16_f32 v28, v120, v122
  v_cvt_pk_bf16_f32 v29, v124, v126
  v_mfma_f32_16x16x16_bf16 v[112:115], v[20:21], v[22:23], v[112:115]
  s_cmp_eq_u32 s36, 63
  v_mfma_f32_16x16x16_bf16 v[104:107], v[28:29], v[22:23], v[104:107]
  s_cbranch_scc1 CHP_BTAIL
  v_mfma_f32_32x32x8_bf16 v[32:47], v[12:13], v[14:15], 0
  s_add_u32 s39, s39, 262144
  s_add_u32 s38, s38, 262144
  v_rcp_f32 v108, v112
  s_nop 1
  v_mul_f32 v104, v104, v108
  v_mul_f32 v105, v105, v108
  v_mul_f32 v106, v106, v108
  v_mul_f32 v107, v107, v108
  v_cvt_pk_bf16_f32 v110, v104, v105
  v_cvt_pk_bf16_f32 v111, v106, v107
  ds_write_b64 v3, v[110:111] offset:17408
  s_waitcnt lgkmcnt(0)
  s_barrier
  ds_read_b128 v[120:123], v1 offset:17408
  ds_read_b128 v[124:127], v1 offset:18432
  buffer_load_dword v31, v30, s[4:7], s58 offen sc1
  s_waitcnt lgkmcnt(1)
  v_smfmac_f32_16x16x64_bf16 v[32:35], v[120:123], v[64:71], v9
  v_smfmac_f32_16x16x64_bf16 v[36:39], v[120:123], v[72:79], v9
  ds_read_b128 v[64:67], v0 offset:49152
  s_waitcnt lgkmcnt(1)
  v_smfmac_f32_16x16x64_bf16 v[32:35], v[124:127], v[192:199], v9
  ds_read_b128 v[68:71], v0 offset:50176
  v_smfmac_f32_16x16x64_bf16 v[36:39], v[124:127], v[200:207], v9
  ds_read_b128 v[72:75], v0 offset:57344
  v_smfmac_f32_16x16x64_bf16 v[40:43], v[120:123], v[160:167], v9
  ds_read_b128 v[76:79], v0 offset:58368
  v_smfmac_f32_16x16x64_bf16 v[44:47], v[120:123], v[168:175], v9
  v_smfmac_f32_16x16x64_bf16 v[40:43], v[124:127], v[208:215], v9
  v_add_f32 v32, v32, v33
  v_add_f32 v34, v34, v35
  v_smfmac_f32_16x16x64_bf16 v[44:47], v[124:127], v[216:223], v9
  v_cvt_pk_bf16_f32 v104, v32, v34
  v_and_b32 v104, -2, v104
  v_smfmac_f32_16x16x64_bf16 v[48:51], v[120:123], v[176:183], v9
  v_add_f32 v36, v36, v37
  v_add_f32 v38, v38, v39
  v_smfmac_f32_16x16x64_bf16 v[52:55], v[120:123], v[184:191], v9
  v_cvt_pk_bf16_f32 v105, v36, v38
  v_smfmac_f32_16x16x64_bf16 v[48:51], v[124:127], v[224:231], v9
  v_add_f32 v40, v40, v41
  v_add_f32 v42, v42, v43
  v_smfmac_f32_16x16x64_bf16 v[52:55], v[124:127], v[232:239], v9
  v_cvt_pk_bf16_f32 v106, v40, v42
  v_add_f32 v44, v44, v45
  s_waitcnt lgkmcnt(0)
  v_smfmac_f32_16x16x64_bf16 v[56:59], v[120:123], v[64:71], v9
  v_add_f32 v46, v46, v47
  v_cvt_pk_bf16_f32 v107, v44, v46
  v_smfmac_f32_16x16x64_bf16 v[60:63], v[120:123], v[72:79], v9
  buffer_store_dwordx4 v[104:107], v6, s[4:7], 0 offen
  v_smfmac_f32_16x16x64_bf16 v[56:59], v[124:127], v[240:247], v9
  v_add_f32 v48, v48, v49
  v_add_f32 v50, v50, v51
  v_smfmac_f32_16x16x64_bf16 v[60:63], v[124:127], v[248:255], v9
  v_cvt_pk_bf16_f32 v108, v48, v50
  v_and_b32 v108, -2, v108
  v_add_f32 v52, v52, v53
  v_add_f32 v54, v54, v55
  v_cvt_pk_bf16_f32 v109, v52, v54
  v_add_f32 v56, v56, v57
  v_add_f32 v58, v58, v59
  v_cvt_pk_bf16_f32 v110, v56, v58
  v_add_f32 v60, v60, v61
  v_add_f32 v62, v62, v63
  v_cvt_pk_bf16_f32 v111, v60, v62
  buffer_store_dwordx4 v[108:111], v6, s[4:7], s42 offen
  ds_read_b128 v[48:51], v4 offset:0
  ds_read_b128 v[52:55], v4 offset:1024
  ds_read_b128 v[56:59], v4 offset:8192
  ds_read_b128 v[60:63], v4 offset:9216
  ds_read_b128 v[64:67], v4 offset:16384
  ds_read_b128 v[68:71], v4 offset:17408
  ds_read_b128 v[72:75], v4 offset:24576
  ds_read_b128 v[76:79], v4 offset:25600
  s_add_u32 s36, s36, 1
  s_mov_b32 s37, 0
  s_add_u32 s40, s40, 262144
  v_mov_b64 v[112:113], 0
  v_mov_b64 v[114:115], 0
  v_mov_b64 v[116:117], 0
  v_mov_b64 v[118:119], 0
  v_mov_b64 v[120:121], 0
  v_mov_b64 v[122:123], 0
  v_mov_b64 v[124:125], 0
  v_mov_b64 v[126:127], 0
  v_mov_b64 v[104:105], 0
  v_mov_b64 v[106:107], 0
  v_mov_b64 v[108:109], 0
  v_mov_b64 v[110:111], 0
  s_waitcnt vmcnt(0)
CHP_BP1:
  buffer_load_dwordx4 v[40:43], v7, s[4:7], 0 offen sc1
  buffer_load_dwordx4 v[44:47], v7, s[4:7], 0 offen offset:1024 sc1
  s_add_u32 s37, s37, 1
  s_cmp_gt_u32 s37, 0x20000
  s_cbranch_scc1 KEND
  s_waitcnt vmcnt(1)
  v_mfma_f32_16x16x32_bf16 v[32:35], v[40:43], v[16:19], 0
  s_waitcnt vmcnt(0)
  v_mfma_f32_16x16x32_bf16 v[32:35], v[44:47], v[16:19], v[32:35]
  v_bitop3_b32 v20, v40, v44, 1 bitop3:0xa8
  v_cmpx_ne_u32 vcc, 0, v20
  s_cbranch_vccnz CHP_BP1
  s_mov_b64 exec, -1
  s_nop 3
  v_add_f32 v32, v32, v33
  v_add_f32 v34, v34, v35
  v_add_f32 v32, v32, v34
  s_nop 1
  v_mov_b32_dpp v33, v32 quad_perm:[2,3,2,3] row_mask:0xf bank_mask:0xf
  v_cvt_pk_bf16_f32 v32, v32, v33
  v_and_b32 v32, -2, v32
  buffer_store_dword v32, v8, s[4:7], 0 offen
  v_readlane_b32 s56, v31, 0
  v_readlane_b32 s57, v31, 1
  s_min_u32 s56, s56, s57
  s_sub_u32 s56, s56, 2
  v_mov_b32 v31, s36
  v_xor_b32 v21, 2048, v0
  v_xor_b32 v22, 4096, v0
  v_xor_b32 v23, 6144, v0
  s_waitcnt lgkmcnt(0)
  s_mov_b32 s37, 0
  s_waitcnt vmcnt(0)
CHP_BP2:
  buffer_load_dwordx4 v[32:35], v0, s[4:7], s41 offen sc1
  buffer_load_dwordx4 v[36:39], v0, s[4:7], s41 offen offset:1024 sc1
CHP_BP2C:
  s_add_u32 s37, s37, 1
  s_cmp_gt_u32 s37, 0x20000
  s_cbranch_scc1 KEND
  s_waitcnt vmcnt(1)
  v_bitop3_b32 v20, v32, v33, v34 bitop3:0xfe
  s_waitcnt vmcnt(0)
  v_bitop3_b32 v20, v20, v35, v36 bitop3:0xfe
  v_bitop3_b32 v20, v20, v37, v38 bitop3:0xfe
  v_bitop3_b32 v20, v20, v39, 1 bitop3:0xa8
  v_cmpx_ne_u32 vcc, 0, v20
  s_cbranch_vccnz CHP_BP2
  s_mov_b64 exec, -1
CHP_BP2D:
  s_branch CHP_LOOP
CHP_BTAIL:
  s_add_u32 s40, s40, 262144
  buffer_store_dwordx4 v[24:27], v0, s[4:7], s40 offen sc1
  buffer_store_dwordx4 v[28:31], v0, s[4:7], s40 offen offset:1024 sc1
  s_nop 1
  v_mov_b32 v31, 0xff
  s_waitcnt vmcnt(0)
  s_barrier
  s_mov_b64 exec, s[46:47]
  buffer_store_dword v31, v30, s[4:7], 0 offen sc1
  s_mov_b64 exec, -1
  s_branch CH_END
CHP_ARS:
  s_mov_b32 s37, 0
CHP_ARL:
  buffer_load_dword v20, v30, s[4:7], s58 offen sc1
  s_add_u32 s37, s37, 1
  s_cmp_gt_u32 s37, 0x20000
  s_cbranch_scc1 KEND
  s_waitcnt vmcnt(0)
  v_readlane_b32 s56, v20, 0
  v_readlane_b32 s57, v20, 1
  s_min_u32 s56, s56, s57
  s_sub_u32 s56, s56, 2
  s_cmp_lt_i32 s56, s36
  s_cbranch_scc1 CHP_ARL
  s_branch CHP_ARB
CHP_AMX:
  v_max_f32 v108, 0, v116
  s_nop 1
  v_max_f32_dpp v108, v108, v108 quad_perm:[1,0,3,2] row_mask:0xf bank_mask:0xf
  v_mov_b32 v109, v108
  s_nop 1
  v_permlane16_swap_b32 v108, v109
  v_max_f32 v108, v108, v109
  v_mov_b32 v109, v108
  s_nop 1
  v_permlane32_swap_b32 v108, v109
  v_max_f32 v108, v108, v109
  v_sub_f32 v116, v116, v108
  v_exp_f32 v108, -v108
  s_nop 7
  v_mul_f32 v112, v112, v108
  v_mul_f32 v104, v104, v108
  v_mul_f32 v105, v105, v108
  v_mul_f32 v106, v106, v108
  v_mul_f32 v107, v107, v108
  s_nop 1
  s_branch CHP_AMB
CHP_BRS:
  s_mov_b32 s37, 0
CHP_BRL:
  buffer_load_dword v20, v30, s[4:7], s58 offen sc1
  s_add_u32 s37, s37, 1
  s_cmp_gt_u32 s37, 0x20000
  s_cbranch_scc1 KEND
  s_waitcnt vmcnt(0)
  v_readlane_b32 s56, v20, 0
  v_readlane_b32 s57, v20, 1
  s_min_u32 s56, s56, s57
  s_sub_u32 s56, s56, 2
  s_cmp_lt_i32 s56, s36
  s_cbranch_scc1 CHP_BRL
  s_branch CHP_BRB
CHP_BMX:
  v_max_f32 v108, 0, v116
  s_nop 1
  v_max_f32_dpp v108, v108, v108 quad_perm:[1,0,3,2] row_mask:0xf bank_mask:0xf
  v_mov_b32 v109, v108
  s_nop 1
  v_permlane16_swap_b32 v108, v109
  v_max_f32 v108, v108, v109
  v_mov_b32 v109, v108
  s_nop 1
  v_permlane32_swap_b32 v108, v109
  v_max_f32 v108, v108, v109
  v_sub_f32 v116, v116, v108
  v_exp_f32 v108, -v108
  s_nop 7
  v_mul_f32 v112, v112, v108
  v_mul_f32 v104, v104, v108
  v_mul_f32 v105, v105, v108
  v_mul_f32 v106, v106, v108
  v_mul_f32 v107, v107, v108
  s_nop 1
  s_branch CHP_BMB
CHS_LOOP:
  ds_write_b128 v0, v[32:35] offset:0
  ds_write_b128 v0, v[36:39] offset:1024
  v_smfmac_f32_16x16x64_bf16 v[104:107], v[32:35], v[48:55], v9
  v_smfmac_f32_16x16x64_bf16 v[108:111], v[32:35], v[56:63], v9
  v_smfmac_f32_16x16x64_bf16 v[104:107], v[36:39], v[64:71], v9
  v_smfmac_f32_16x16x64_bf16 v[108:111], v[36:39], v[72:79], v9
  s_waitcnt lgkmcnt(0)
  s_barrier
  ds_read_b128 v[40:43], v21 offset:0
  ds_read_b128 v[44:47], v21 offset:1024
  ds_read_b128 v[48:51], v22 offset:0
  ds_read_b128 v[52:55], v22 offset:1024
  ds_read_b128 v[56:59], v23 offset:0
  ds_read_b128 v[60:63], v23 offset:1024
  v_smfmac_f32_16x16x64_bf16 v[112:115], v[32:35], a[80:87], v9
  s_mov_b64 exec, s[46:47]
  buffer_store_dword v31, v30, s[4:7], 0 offen sc1
  s_mov_b64 exec, -1
  v_smfmac_f32_16x16x64_bf16 v[116:119], v[32:35], a[88:95], v9
  s_cmp_lt_i32 s56, s36
  s_cbranch_scc1 CHS_ARS
CHS_ARB:
  v_smfmac_f32_16x16x64_bf16 v[112:115], v[36:39], a[96:103], v9
  v_smfmac_f32_16x16x64_bf16 v[116:119], v[36:39], a[104:111], v9
  v_smfmac_f32_16x16x64_bf16 v[120:123], v[32:35], a[192:199], v9
  ds_read_b128 v[64:67], v4 offset:32768
  v_smfmac_f32_16x16x64_bf16 v[124:127], v[32:35], a[200:207], v9
  ds_read_b128 v[68:71], v4 offset:33792
  v_smfmac_f32_16x16x64_bf16 v[120:123], v[36:39], a[208:215], v9
  ds_read_b128 v[72:75], v4 offset:40960
  v_smfmac_f32_16x16x64_bf16 v[124:127], v[36:39], a[216:223], v9
  ds_read_b128 v[76:79], v4 offset:41984
  s_waitcnt lgkmcnt(9)
  v_smfmac_f32_16x16x64_bf16 v[104:107], v[40:43], a[0:7], v9
  buffer_store_dwordx4 v[24:27], v0, s[4:7], s40 offen sc1
  v_smfmac_f32_16x16x64_bf16 v[108:111], v[40:43], a[8:15], v9
  s_waitcnt lgkmcnt(8)
  v_smfmac_f32_16x16x64_bf16 v[104:107], v[44:47], a[16:23], v9
  v_smfmac_f32_16x16x64_bf16 v[108:111], v[44:47], a[24:31], v9
  s_waitcnt lgkmcnt(7)
  v_smfmac_f32_16x16x64_bf16 v[104:107], v[48:51], a[32:39], v9
  buffer_load_dwordx4 v[96:99], v0, s[4:7], s39 offen sc1
  v_smfmac_f32_16x16x64_bf16 v[108:111], v[48:51], a[40:47], v9
  s_waitcnt lgkmcnt(0)
  v_smfmac_f32_16x16x64_bf16 v[104:107], v[52:55], v[64:71], v9
  v_smfmac_f32_16x16x64_bf16 v[108:111], v[52:55], v[72:79], v9
  ds_read_b128 v[64:67], v4 offset:49152
  v_smfmac_f32_16x16x64_bf16 v[104:107], v[56:59], a[48:55], v9
  ds_read_b128 v[68:71], v4 offset:50176
  buffer_load_dwordx4 v[100:103], v0, s[4:7], s39 offen offset:1024 sc1
  v_smfmac_f32_16x16x64_bf16 v[108:111], v[56:59], a[56:63], v9
  ds_read_b128 v[72:75], v4 offset:57344
  v_smfmac_f32_16x16x64_bf16 v[104:107], v[60:63], a[64:71], v9
  ds_read_b128 v[76:79], v4 offset:58368
  v_smfmac_f32_16x16x64_bf16 v[108:111], v[60:63], a[72:79], v9
  v_smfmac_f32_16x16x64_bf16 v[112:115], v[40:43], a[112:119], v9
  buffer_store_dwordx4 v[28:31], v0, s[4:7], s40 offen offset:1024 sc1
  v_smfmac_f32_16x16x64_bf16 v[116:119], v[40:43], a[120:127], v9
  v_add_f32 v104, v104, v105
  v_add_f32 v106, v106, v107
  v_smfmac_f32_16x16x64_bf16 v[112:115], v[44:47], a[128:135], v9
  v_add_f32 v108, v108, v109
  v_add_f32 v110, v110, v111
  v_cvt_pk_bf16_f32 v24, v104, v106
  v_cvt_pk_bf16_f32 v25, v108, v110
  v_smfmac_f32_16x16x64_bf16 v[116:119], v[44:47], a[136:143], v9
  s_waitcnt lgkmcnt(0)
  v_mfma_f32_16x16x16_bf16 v[104:107], v[24:25], v[12:13], 0
  v_mfma_f32_16x16x16_bf16 v[108:111], v[24:25], v[14:15], 0
  v_smfmac_f32_16x16x64_bf16 v[112:115], v[48:51], v[64:71], v9
  v_smfmac_f32_16x16x64_bf16 v[116:119], v[48:51], v[72:79], v9
  ds_read_b128 v[64:67], v5 offset:0
  s_nop 0
  v_cvt_pk_bf16_f32 v20, v104, v105
  v_cvt_pk_bf16_f32 v21, v106, v107
  v_smfmac_f32_16x16x64_bf16 v[112:115], v[52:55], a[144:151], v9
  ds_read_b128 v[68:71], v5 offset:1024
  v_cvt_pk_bf16_f32 v22, v108, v109
  v_cvt_pk_bf16_f32 v23, v110, v111
  v_smfmac_f32_16x16x64_bf16 v[116:119], v[52:55], a[152:159], v9
  ds_read_b128 v[72:75], v5 offset:8192
  v_mfma_f32_16x16x32_bf16 v[104:107], v[80:83], v[20:23], 0
  v_mfma_f32_16x16x32_bf16 v[108:111], v[84:87], v[20:23], 0
  v_smfmac_f32_16x16x64_bf16 v[112:115], v[56:59], a[160:167], v9
  ds_read_b128 v[76:79], v5 offset:9216
  v_smfmac_f32_16x16x64_bf16 v[116:119], v[56:59], a[168:175], v9
  v_smfmac_f32_16x16x64_bf16 v[112:115], v[60:63], a[176:183], v9
  s_nop 0
  v_cndmask_b32 v104, v104, v108, s[44:45]
  v_cndmask_b32 v105, v105, v109, s[44:45]
  v_cndmask_b32 v106, v106, v110, s[44:45]
  v_cndmask_b32 v107, v107, v111, s[44:45]
  v_smfmac_f32_16x16x64_bf16 v[116:119], v[60:63], a[184:191], v9
  ds_write_b128 v0, v[104:107] offset:8192
  v_smfmac_f32_16x16x64_bf16 v[120:123], v[44:47], a[224:231], v9
  v_smfmac_f32_16x16x64_bf16 v[124:127], v[44:47], a[232:239], v9
  v_add_f32 v112, v112, v113
  v_add_f32 v114, v114, v115
  s_nop 0
  v_add_f32 v116, v116, v117
  v_add_f32 v118, v118, v119
  v_cvt_pk_bf16_f32 v24, v112, v114
  v_cvt_pk_bf16_f32 v25, v116, v118
  s_waitcnt lgkmcnt(0)
  s_barrier
  ds_read_b128 v[104:107], v1 offset:8192
  ds_read_b128 v[108:111], v1 offset:10240
  ds_read_b128 v[32:35], v1 offset:12288
  ds_read_b128 v[36:39], v1 offset:14336
  v_mfma_f32_16x16x16_bf16 v[112:115], v[24:25], v[12:13], 0
  v_mfma_f32_16x16x16_bf16 v[116:119], v[24:25], v[14:15], 0
  v_smfmac_f32_16x16x64_bf16 v[120:123], v[40:43], v[64:71], v9
  buffer_load_dwordx4 v[80:83], v0, s[4:7], s38 offen sc1
  v_smfmac_f32_16x16x64_bf16 v[124:127], v[40:43], v[72:79], v9
  ds_read_b128 v[64:67], v5 offset:16384
  v_cvt_pk_bf16_f32 v24, v112, v113
  v_cvt_pk_bf16_f32 v25, v114, v115
  v_cvt_pk_bf16_f32 v26, v116, v117
  v_cvt_pk_bf16_f32 v27, v118, v119
  v_smfmac_f32_16x16x64_bf16 v[120:123], v[48:51], a[240:247], v9
  ds_read_b128 v[68:71], v5 offset:17408
  v_mfma_f32_16x16x32_bf16 v[112:115], v[24:27], v[20:23], 0
  v_smfmac_f32_16x16x64_bf16 v[124:127], v[48:51], a[248:255], v9
  ds_read_b128 v[72:75], v5 offset:24576
  s_waitcnt lgkmcnt(5)
  v_add_f32 v104, v104, v108
  v_add_f32 v105, v105, v109
  v_add_f32 v106, v106, v110
  v_add_f32 v107, v107, v111
  v_cndmask_b32 v112, v112, v114, s[44:45]
  ds_write_b32 v2, v112 offset:16384
  v_smfmac_f32_16x16x64_bf16 v[120:123], v[52:55], v[128:135], v9
  ds_read_b128 v[76:79], v5 offset:25600
  s_waitcnt lgkmcnt(5)
  v_add_f32 v32, v32, v36
  v_add_f32 v33, v33, v37
  v_add_f32 v34, v34, v38
  v_add_f32 v35, v35, v39
  v_smfmac_f32_16x16x64_bf16 v[124:127], v[52:55], v[136:143], v9
  v_add_f32 v104, v104, v32
  v_add_f32 v105, v105, v33
  v_add_f32 v106, v106, v34
  v_add_f32 v107, v107, v35
  s_waitcnt lgkmcnt(0)
  s_barrier
  ds_read_b128 v[116:119], v1 offset:16384
  v_max3_f32 v108, v104, v105, v106
  v_max_f32 v108, v108, v107
  v_smfmac_f32_16x16x64_bf16 v[120:123], v[56:59], v[144:151], v9
  buffer_load_dwordx4 v[84:87], v0, s[4:7], s38 offen offset:1024 sc1
  v_mov_b32 v20, 0x3f803f80
  v_max_f32_dpp v108, v108, v108 quad_perm:[1,0,3,2] row_mask:0xf bank_mask:0xf
  v_mov_b32 v109, v108
  v_smfmac_f32_16x16x64_bf16 v[124:127], v[56:59], v[152:159], v9
  v_mov_b32 v21, 0x3f803f80
  v_permlane16_swap_b32 v108, v109
  v_max_f32 v108, v108, v109
  v_mov_b32 v109, v108
  v_smfmac_f32_16x16x64_bf16 v[120:123], v[60:63], v[64:71], v9
  v_smfmac_f32_16x16x64_bf16 v[124:127], v[60:63], v[72:79], v9
  v_permlane32_swap_b32 v108, v109
  v_max_f32 v108, v108, v109
  v_mul_f32 v108, s43, v108
  ds_read_b128 v[64:67], v0 offset:32768
  v_fma_f32 v104, v104, s43, -v108
  v_fma_f32 v105, v105, s43, -v108
  v_fma_f32 v106, v106, s43, -v108
  v_fma_f32 v107, v107, s43, -v108
  v_mfma_f32_32x32x8_bf16 v[48:63], v[12:13], v[14:15], 0
  ds_read_b128 v[68:71], v0 offset:33792
  v_exp_f32 v104, v104
  v_exp_f32 v105, v105
  v_exp_f32 v106, v106
  v_exp_f32 v107, v107
  s_waitcnt lgkmcnt(2)
  v_add_f32 v116, v116, v117
  v_add_f32 v118, v118, v119
  v_cvt_pk_bf16_f32 v110, v104, v105
  v_cvt_pk_bf16_f32 v111, v106, v107
  v_add_f32 v116, v116, v118
  v_fma_f32 v116, v116, s43, -v108
  v_mfma_f32_16x16x16_bf16 v[112:115], v[20:21], v[110:111], 0
  ds_read_b128 v[72:75], v0 offset:40960
  v_and_b32_dpp v32, v110, v10 quad_perm:[0,0,2,2] row_mask:0xf bank_mask:0xf
  v_and_b32_dpp v33, v111, v10 quad_perm:[0,0,2,2] row_mask:0xf bank_mask:0xf
  v_and_b32_dpp v34, v110, v10 quad_perm:[1,1,3,3] row_mask:0xf bank_mask:0xf
  v_and_b32_dpp v35, v111, v10 quad_perm:[1,1,3,3] row_mask:0xf bank_mask:0xf
  v_cmp_lt_f32 vcc, 0x42700000, v116
  v_add_f32 v120, v120, v121
  v_mfma_f32_16x16x32_bf16 v[104:107], v[88:91], v[32:35], 0
  ds_read_b128 v[76:79], v0 offset:41984
  v_and_b32_dpp v36, v110, v11 quad_perm:[0,0,2,2] row_mask:0xf bank_mask:0xf
  v_and_b32_dpp v37, v111, v11 quad_perm:[0,0,2,2] row_mask:0xf bank_mask:0xf
  v_and_b32_dpp v38, v110, v11 quad_perm:[1,1,3,3] row_mask:0xf bank_mask:0xf
  v_and_b32_dpp v39, v111, v11 quad_perm:[1,1,3,3] row_mask:0xf bank_mask:0xf
  v_add_f32_dpp v112, v112, v112 quad_perm:[1,0,3,2] row_mask:0xf bank_mask:0xf
  v_add_f32 v122, v122, v123
  v_mfma_f32_16x16x32_bf16 v[104:107], v[92:95], v[36:39], v[104:107]
  s_cbranch_vccnz CHS_AMX
CHS_AMB:
  v_exp_f32 v116, v116
  v_add_f32 v124, v124, v125
  v_add_f32 v126, v126, v127
  v_mov_b32_dpp v117, v116 quad_perm:[0,0,2,2] row_mask:0xf bank_mask:0xf
  v_mov_b32_dpp v118, v116 quad_perm:[1,1,3,3] row_mask:0xf bank_mask:0xf
  v_cvt_pk_bf16_f32 v117, v117, v118
  v_and_b32 v22, v117, v10
  v_and_b32 v23, v117, v11
  v_cvt_pk_bf16_f32 v28, v120, v122
  v_cvt_pk_bf16_f32 v29, v124, v126
  v_mfma_f32_16x16x16_bf16 v[112:115], v[20:21], v[22:23], v[112:115]
  v_mfma_f32_16x16x16_bf16 v[104:107], v[28:29], v[22:23], v[104:107]
  v_mfma_f32_32x32x8_bf16 v[32:47], v[12:13], v[14:15], 0
  s_add_u32 s39, s39, 262144
  s_add_u32 s38, s38, 262144
  s_nop 1
  v_rcp_f32 v108, v112
  s_nop 0
  v_mul_f32 v104, v104, v108
  v_mul_f32 v105, v105, v108
  v_mul_f32 v106, v106, v108
  v_mul_f32 v107, v107, v108
  v_cvt_pk_bf16_f32 v110, v104, v105
  v_cvt_pk_bf16_f32 v111, v106, v107
  ds_write_b64 v3, v[110:111] offset:17408
  s_waitcnt lgkmcnt(0)
  s_barrier
  ds_read_b128 v[120:123], v1 offset:17408
  ds_read_b128 v[124:127], v1 offset:18432
  buffer_load_dword v31, v30, s[4:7], s58 offen sc1
  s_waitcnt lgkmcnt(1)
  v_smfmac_f32_16x16x64_bf16 v[32:35], v[120:123], v[64:71], v9
  v_smfmac_f32_16x16x64_bf16 v[36:39], v[120:123], v[72:79], v9
  ds_read_b128 v[64:67], v0 offset:49152
  s_waitcnt lgkmcnt(1)
  v_smfmac_f32_16x16x64_bf16 v[32:35], v[124:127], v[192:199], v9
  ds_read_b128 v[68:71], v0 offset:50176
  v_smfmac_f32_16x16x64_bf16 v[36:39], v[124:127], v[200:207], v9
  ds_read_b128 v[72:75], v0 offset:57344
  v_smfmac_f32_16x16x64_bf16 v[40:43], v[120:123], v[160:167], v9
  ds_read_b128 v[76:79], v0 offset:58368
  v_smfmac_f32_16x16x64_bf16 v[44:47], v[120:123], v[168:175], v9
  v_smfmac_f32_16x16x64_bf16 v[40:43], v[124:127], v[208:215], v9
  v_add_f32 v32, v32, v33
  v_add_f32 v34, v34, v35
  v_smfmac_f32_16x16x64_bf16 v[44:47], v[124:127], v[216:223], v9
  v_cvt_pk_bf16_f32 v104, v32, v34
  v_or_b32 v104, 1, v104
  v_smfmac_f32_16x16x64_bf16 v[48:51], v[120:123], v[176:183], v9
  v_add_f32 v36, v36, v37
  v_add_f32 v38, v38, v39
  v_smfmac_f32_16x16x64_bf16 v[52:55], v[120:123], v[184:191], v9
  v_cvt_pk_bf16_f32 v105, v36, v38
  v_smfmac_f32_16x16x64_bf16 v[48:51], v[124:127], v[224:231], v9
  v_add_f32 v40, v40, v41
  v_add_f32 v42, v42, v43
  v_smfmac_f32_16x16x64_bf16 v[52:55], v[124:127], v[232:239], v9
  v_cvt_pk_bf16_f32 v106, v40, v42
  v_add_f32 v44, v44, v45
  s_waitcnt lgkmcnt(0)
  v_smfmac_f32_16x16x64_bf16 v[56:59], v[120:123], v[64:71], v9
  v_add_f32 v46, v46, v47
  v_cvt_pk_bf16_f32 v107, v44, v46
  v_smfmac_f32_16x16x64_bf16 v[60:63], v[120:123], v[72:79], v9
  buffer_store_dwordx4 v[104:107], v6, s[4:7], 0 offen sc1
  v_smfmac_f32_16x16x64_bf16 v[56:59], v[124:127], v[240:247], v9
  v_add_f32 v48, v48, v49
  v_add_f32 v50, v50, v51
  v_smfmac_f32_16x16x64_bf16 v[60:63], v[124:127], v[248:255], v9
  v_cvt_pk_bf16_f32 v108, v48, v50
  v_or_b32 v108, 1, v108
  v_add_f32 v52, v52, v53
  v_add_f32 v54, v54, v55
  v_cvt_pk_bf16_f32 v109, v52, v54
  v_add_f32 v56, v56, v57
  v_add_f32 v58, v58, v59
  v_cvt_pk_bf16_f32 v110, v56, v58
  v_add_f32 v60, v60, v61
  v_add_f32 v62, v62, v63
  v_cvt_pk_bf16_f32 v111, v60, v62
  buffer_store_dwordx4 v[108:111], v6, s[4:7], s42 offen sc1
  ds_read_b128 v[48:51], v4 offset:0
  ds_read_b128 v[52:55], v4 offset:1024
  ds_read_b128 v[56:59], v4 offset:8192
  ds_read_b128 v[60:63], v4 offset:9216
  ds_read_b128 v[64:67], v4 offset:16384
  ds_read_b128 v[68:71], v4 offset:17408
  ds_read_b128 v[72:75], v4 offset:24576
  ds_read_b128 v[76:79], v4 offset:25600
  s_add_u32 s36, s36, 1
  s_mov_b32 s37, 0
  s_add_u32 s40, s40, 262144
  v_mov_b64 v[112:113], 0
  v_mov_b64 v[114:115], 0
  v_mov_b64 v[116:117], 0
  v_mov_b64 v[118:119], 0
  v_mov_b64 v[120:121], 0
  v_mov_b64 v[122:123], 0
  v_mov_b64 v[124:125], 0
  v_mov_b64 v[126:127], 0
  v_mov_b64 v[104:105], 0
  v_mov_b64 v[106:107], 0
  v_mov_b64 v[108:109], 0
  v_mov_b64 v[110:111], 0
  s_waitcnt vmcnt(0)
CHS_AP1:
  buffer_load_dwordx4 v[40:43], v7, s[4:7], 0 offen sc1
  buffer_load_dwordx4 v[44:47], v7, s[4:7], 0 offen offset:1024 sc1
  s_add_u32 s37, s37, 1
  s_cmp_gt_u32 s37, 0x20000
  s_cbranch_scc1 KEND
  s_waitcnt vmcnt(1)
  v_mfma_f32_16x16x32_bf16 v[32:35], v[40:43], v[16:19], 0
  s_waitcnt vmcnt(0)
  v_mfma_f32_16x16x32_bf16 v[32:35], v[44:47], v[16:19], v[32:35]
  v_bitop3_b32 v20, v40, v44, 1 bitop3:0x80
  v_cmpx_ne_u32 vcc, 1, v20
  s_cbranch_vccnz CHS_AP1
  s_mov_b64 exec, -1
  s_nop 3
  v_add_f32 v32, v32, v33
  v_add_f32 v34, v34, v35
  v_add_f32 v32, v32, v34
  s_nop 1
  v_mov_b32_dpp v33, v32 quad_perm:[2,3,2,3] row_mask:0xf bank_mask:0xf
  v_cvt_pk_bf16_f32 v32, v32, v33
  v_or_b32 v32, 1, v32
  buffer_store_dword v32, v8, s[4:7], 0 offen sc1
  v_readlane_b32 s56, v31, 0
  v_readlane_b32 s57, v31, 1
  s_min_u32 s56, s56, s57
  s_sub_u32 s56, s56, 2
  v_mov_b32 v31, s36
  v_xor_b32 v21, 2048, v0
  v_xor_b32 v22, 4096, v0
  v_xor_b32 v23, 6144, v0
  s_waitcnt lgkmcnt(0)
  s_mov_b32 s37, 0
  s_waitcnt vmcnt(0)
CHS_AP2:
  buffer_load_dwordx4 v[32:35], v0, s[4:7], s41 offen sc1
  buffer_load_dwordx4 v[36:39], v0, s[4:7], s41 offen offset:1024 sc1
CHS_AP2C:
  s_add_u32 s37, s37, 1
  s_cmp_gt_u32 s37, 0x20000
  s_cbranch_scc1 KEND
  s_waitcnt vmcnt(1)
  v_bitop3_b32 v20, v32, v33, v34 bitop3:0x80
  s_waitcnt vmcnt(0)
  v_bitop3_b32 v20, v20, v35, v36 bitop3:0x80
  v_bitop3_b32 v20, v20, v37, v38 bitop3:0x80
  v_bitop3_b32 v20, v20, v39, 1 bitop3:0x80
  v_cmpx_ne_u32 vcc, 1, v20
  s_cbranch_vccnz CHS_AP2
  s_mov_b64 exec, -1
CHS_AP2D:
  ds_write_b128 v0, v[32:35] offset:0
  ds_write_b128 v0, v[36:39] offset:1024
  v_smfmac_f32_16x16x64_bf16 v[104:107], v[32:35], v[48:55], v9
  v_smfmac_f32_16x16x64_bf16 v[108:111], v[32:35], v[56:63], v9
  v_smfmac_f32_16x16x64_bf16 v[104:107], v[36:39], v[64:71], v9
  v_smfmac_f32_16x16x64_bf16 v[108:111], v[36:39], v[72:79], v9
  s_waitcnt lgkmcnt(0)
  s_barrier
  ds_read_b128 v[40:43], v21 offset:0
  ds_read_b128 v[44:47], v21 offset:1024
  ds_read_b128 v[48:51], v22 offset:0
  ds_read_b128 v[52:55], v22 offset:1024
  ds_read_b128 v[56:59], v23 offset:0
  ds_read_b128 v[60:63], v23 offset:1024
  v_smfmac_f32_16x16x64_bf16 v[112:115], v[32:35], a[80:87], v9
  s_mov_b64 exec, s[46:47]
  buffer_store_dword v31, v30, s[4:7], 0 offen sc1
  s_mov_b64 exec, -1
  v_smfmac_f32_16x16x64_bf16 v[116:119], v[32:35], a[88:95], v9
  s_cmp_lt_i32 s56, s36
  s_cbranch_scc1 CHS_BRS
CHS_BRB:
  v_smfmac_f32_16x16x64_bf16 v[112:115], v[36:39], a[96:103], v9
  v_smfmac_f32_16x16x64_bf16 v[116:119], v[36:39], a[104:111], v9
  v_smfmac_f32_16x16x64_bf16 v[120:123], v[32:35], a[192:199], v9
  ds_read_b128 v[64:67], v4 offset:32768
  v_smfmac_f32_16x16x64_bf16 v[124:127], v[32:35], a[200:207], v9
  ds_read_b128 v[68:71], v4 offset:33792
  v_smfmac_f32_16x16x64_bf16 v[120:123], v[36:39], a[208:215], v9
  ds_read_b128 v[72:75], v4 offset:40960
  v_smfmac_f32_16x16x64_bf16 v[124:127], v[36:39], a[216:223], v9
  ds_read_b128 v[76:79], v4 offset:41984
  s_waitcnt lgkmcnt(9)
  v_smfmac_f32_16x16x64_bf16 v[104:107], v[40:43], a[0:7], v9
  buffer_store_dwordx4 v[24:27], v0, s[4:7], s40 offen sc1
  v_smfmac_f32_16x16x64_bf16 v[108:111], v[40:43], a[8:15], v9
  s_waitcnt lgkmcnt(8)
  v_smfmac_f32_16x16x64_bf16 v[104:107], v[44:47], a[16:23], v9
  v_smfmac_f32_16x16x64_bf16 v[108:111], v[44:47], a[24:31], v9
  s_waitcnt lgkmcnt(7)
  v_smfmac_f32_16x16x64_bf16 v[104:107], v[48:51], a[32:39], v9
  buffer_load_dwordx4 v[88:91], v0, s[4:7], s39 offen sc1
  v_smfmac_f32_16x16x64_bf16 v[108:111], v[48:51], a[40:47], v9
  s_waitcnt lgkmcnt(0)
  v_smfmac_f32_16x16x64_bf16 v[104:107], v[52:55], v[64:71], v9
  v_smfmac_f32_16x16x64_bf16 v[108:111], v[52:55], v[72:79], v9
  ds_read_b128 v[64:67], v4 offset:49152
  v_smfmac_f32_16x16x64_bf16 v[104:107], v[56:59], a[48:55], v9
  ds_read_b128 v[68:71], v4 offset:50176
  buffer_load_dwordx4 v[92:95], v0, s[4:7], s39 offen offset:1024 sc1
  v_smfmac_f32_16x16x64_bf16 v[108:111], v[56:59], a[56:63], v9
  ds_read_b128 v[72:75], v4 offset:57344
  v_smfmac_f32_16x16x64_bf16 v[104:107], v[60:63], a[64:71], v9
  ds_read_b128 v[76:79], v4 offset:58368
  v_smfmac_f32_16x16x64_bf16 v[108:111], v[60:63], a[72:79], v9
  v_smfmac_f32_16x16x64_bf16 v[112:115], v[40:43], a[112:119], v9
  buffer_store_dwordx4 v[28:31], v0, s[4:7], s40 offen offset:1024 sc1
  v_smfmac_f32_16x16x64_bf16 v[116:119], v[40:43], a[120:127], v9
  v_add_f32 v104, v104, v105
  v_add_f32 v106, v106, v107
  v_smfmac_f32_16x16x64_bf16 v[112:115], v[44:47], a[128:135], v9
  v_add_f32 v108, v108, v109
  v_add_f32 v110, v110, v111
  v_cvt_pk_bf16_f32 v24, v104, v106
  v_cvt_pk_bf16_f32 v25, v108, v110
  v_smfmac_f32_16x16x64_bf16 v[116:119], v[44:47], a[136:143], v9
  s_waitcnt lgkmcnt(0)
  v_mfma_f32_16x16x16_bf16 v[104:107], v[24:25], v[12:13], 0
  v_mfma_f32_16x16x16_bf16 v[108:111], v[24:25], v[14:15], 0
  v_smfmac_f32_16x16x64_bf16 v[112:115], v[48:51], v[64:71], v9
  v_smfmac_f32_16x16x64_bf16 v[116:119], v[48:51], v[72:79], v9
  ds_read_b128 v[64:67], v5 offset:0
  s_nop 0
  v_cvt_pk_bf16_f32 v20, v104, v105
  v_cvt_pk_bf16_f32 v21, v106, v107
  v_smfmac_f32_16x16x64_bf16 v[112:115], v[52:55], a[144:151], v9
  ds_read_b128 v[68:71], v5 offset:1024
  v_cvt_pk_bf16_f32 v22, v108, v109
  v_cvt_pk_bf16_f32 v23, v110, v111
  v_smfmac_f32_16x16x64_bf16 v[116:119], v[52:55], a[152:159], v9
  ds_read_b128 v[72:75], v5 offset:8192
  v_mfma_f32_16x16x32_bf16 v[104:107], v[80:83], v[20:23], 0
  v_mfma_f32_16x16x32_bf16 v[108:111], v[84:87], v[20:23], 0
  v_smfmac_f32_16x16x64_bf16 v[112:115], v[56:59], a[160:167], v9
  ds_read_b128 v[76:79], v5 offset:9216
  v_smfmac_f32_16x16x64_bf16 v[116:119], v[56:59], a[168:175], v9
  v_smfmac_f32_16x16x64_bf16 v[112:115], v[60:63], a[176:183], v9
  s_nop 0
  v_cndmask_b32 v104, v104, v108, s[44:45]
  v_cndmask_b32 v105, v105, v109, s[44:45]
  v_cndmask_b32 v106, v106, v110, s[44:45]
  v_cndmask_b32 v107, v107, v111, s[44:45]
  v_smfmac_f32_16x16x64_bf16 v[116:119], v[60:63], a[184:191], v9
  ds_write_b128 v0, v[104:107] offset:8192
  v_smfmac_f32_16x16x64_bf16 v[120:123], v[44:47], a[224:231], v9
  v_smfmac_f32_16x16x64_bf16 v[124:127], v[44:47], a[232:239], v9
  v_add_f32 v112, v112, v113
  v_add_f32 v114, v114, v115
  s_nop 0
  v_add_f32 v116, v116, v117
  v_add_f32 v118, v118, v119
  v_cvt_pk_bf16_f32 v24, v112, v114
  v_cvt_pk_bf16_f32 v25, v116, v118
  s_waitcnt lgkmcnt(0)
  s_barrier
  ds_read_b128 v[104:107], v1 offset:8192
  ds_read_b128 v[108:111], v1 offset:10240
  ds_read_b128 v[32:35], v1 offset:12288
  ds_read_b128 v[36:39], v1 offset:14336
  v_mfma_f32_16x16x16_bf16 v[112:115], v[24:25], v[12:13], 0
  v_mfma_f32_16x16x16_bf16 v[116:119], v[24:25], v[14:15], 0
  v_smfmac_f32_16x16x64_bf16 v[120:123], v[40:43], v[64:71], v9
  buffer_load_dwordx4 v[80:83], v0, s[4:7], s38 offen sc1
  v_smfmac_f32_16x16x64_bf16 v[124:127], v[40:43], v[72:79], v9
  ds_read_b128 v[64:67], v5 offset:16384
  v_cvt_pk_bf16_f32 v24, v112, v113
  v_cvt_pk_bf16_f32 v25, v114, v115
  v_cvt_pk_bf16_f32 v26, v116, v117
  v_cvt_pk_bf16_f32 v27, v118, v119
  v_smfmac_f32_16x16x64_bf16 v[120:123], v[48:51], a[240:247], v9
  ds_read_b128 v[68:71], v5 offset:17408
  v_mfma_f32_16x16x32_bf16 v[112:115], v[24:27], v[20:23], 0
  v_smfmac_f32_16x16x64_bf16 v[124:127], v[48:51], a[248:255], v9
  ds_read_b128 v[72:75], v5 offset:24576
  s_waitcnt lgkmcnt(5)
  v_add_f32 v104, v104, v108
  v_add_f32 v105, v105, v109
  v_add_f32 v106, v106, v110
  v_add_f32 v107, v107, v111
  v_cndmask_b32 v112, v112, v114, s[44:45]
  ds_write_b32 v2, v112 offset:16384
  v_smfmac_f32_16x16x64_bf16 v[120:123], v[52:55], v[128:135], v9
  ds_read_b128 v[76:79], v5 offset:25600
  s_waitcnt lgkmcnt(5)
  v_add_f32 v32, v32, v36
  v_add_f32 v33, v33, v37
  v_add_f32 v34, v34, v38
  v_add_f32 v35, v35, v39
  v_smfmac_f32_16x16x64_bf16 v[124:127], v[52:55], v[136:143], v9
  v_add_f32 v104, v104, v32
  v_add_f32 v105, v105, v33
  v_add_f32 v106, v106, v34
  v_add_f32 v107, v107, v35
  s_waitcnt lgkmcnt(0)
  s_barrier
  ds_read_b128 v[116:119], v1 offset:16384
  v_max3_f32 v108, v104, v105, v106
  v_max_f32 v108, v108, v107
  v_smfmac_f32_16x16x64_bf16 v[120:123], v[56:59], v[144:151], v9
  buffer_load_dwordx4 v[84:87], v0, s[4:7], s38 offen offset:1024 sc1
  v_mov_b32 v20, 0x3f803f80
  v_max_f32_dpp v108, v108, v108 quad_perm:[1,0,3,2] row_mask:0xf bank_mask:0xf
  v_mov_b32 v109, v108
  v_smfmac_f32_16x16x64_bf16 v[124:127], v[56:59], v[152:159], v9
  v_mov_b32 v21, 0x3f803f80
  v_permlane16_swap_b32 v108, v109
  v_max_f32 v108, v108, v109
  v_mov_b32 v109, v108
  v_smfmac_f32_16x16x64_bf16 v[120:123], v[60:63], v[64:71], v9
  v_smfmac_f32_16x16x64_bf16 v[124:127], v[60:63], v[72:79], v9
  v_permlane32_swap_b32 v108, v109
  v_max_f32 v108, v108, v109
  v_mul_f32 v108, s43, v108
  ds_read_b128 v[64:67], v0 offset:32768
  v_fma_f32 v104, v104, s43, -v108
  v_fma_f32 v105, v105, s43, -v108
  v_fma_f32 v106, v106, s43, -v108
  v_fma_f32 v107, v107, s43, -v108
  v_mfma_f32_32x32x8_bf16 v[48:63], v[12:13], v[14:15], 0
  ds_read_b128 v[68:71], v0 offset:33792
  v_exp_f32 v104, v104
  v_exp_f32 v105, v105
  v_exp_f32 v106, v106
  v_exp_f32 v107, v107
  s_waitcnt lgkmcnt(2)
  v_add_f32 v116, v116, v117
  v_add_f32 v118, v118, v119
  v_cvt_pk_bf16_f32 v110, v104, v105
  v_cvt_pk_bf16_f32 v111, v106, v107
  v_add_f32 v116, v116, v118
  v_fma_f32 v116, v116, s43, -v108
  v_mfma_f32_16x16x16_bf16 v[112:115], v[20:21], v[110:111], 0
  ds_read_b128 v[72:75], v0 offset:40960
  v_and_b32_dpp v32, v110, v10 quad_perm:[0,0,2,2] row_mask:0xf bank_mask:0xf
  v_and_b32_dpp v33, v111, v10 quad_perm:[0,0,2,2] row_mask:0xf bank_mask:0xf
  v_and_b32_dpp v34, v110, v10 quad_perm:[1,1,3,3] row_mask:0xf bank_mask:0xf
  v_and_b32_dpp v35, v111, v10 quad_perm:[1,1,3,3] row_mask:0xf bank_mask:0xf
  v_cmp_lt_f32 vcc, 0x42700000, v116
  v_add_f32 v120, v120, v121
  v_mfma_f32_16x16x32_bf16 v[104:107], v[96:99], v[32:35], 0
  ds_read_b128 v[76:79], v0 offset:41984
  v_and_b32_dpp v36, v110, v11 quad_perm:[0,0,2,2] row_mask:0xf bank_mask:0xf
  v_and_b32_dpp v37, v111, v11 quad_perm:[0,0,2,2] row_mask:0xf bank_mask:0xf
  v_and_b32_dpp v38, v110, v11 quad_perm:[1,1,3,3] row_mask:0xf bank_mask:0xf
  v_and_b32_dpp v39, v111, v11 quad_perm:[1,1,3,3] row_mask:0xf bank_mask:0xf
  v_add_f32_dpp v112, v112, v112 quad_perm:[1,0,3,2] row_mask:0xf bank_mask:0xf
  v_add_f32 v122, v122, v123
  v_mfma_f32_16x16x32_bf16 v[104:107], v[100:103], v[36:39], v[104:107]
  s_cbranch_vccnz CHS_BMX
CHS_BMB:
  v_exp_f32 v116, v116
  v_add_f32 v124, v124, v125
  v_add_f32 v126, v126, v127
  v_mov_b32_dpp v117, v116 quad_perm:[0,0,2,2] row_mask:0xf bank_mask:0xf
  v_mov_b32_dpp v118, v116 quad_perm:[1,1,3,3] row_mask:0xf bank_mask:0xf
  v_cvt_pk_bf16_f32 v117, v117, v118
  v_and_b32 v22, v117, v10
  v_and_b32 v23, v117, v11
  v_cvt_pk_bf16_f32 v28, v120, v122
  v_cvt_pk_bf16_f32 v29, v124, v126
  v_mfma_f32_16x16x16_bf16 v[112:115], v[20:21], v[22:23], v[112:115]
  s_cmp_eq_u32 s36, 63
  v_mfma_f32_16x16x16_bf16 v[104:107], v[28:29], v[22:23], v[104:107]
  s_cbranch_scc1 CHS_BTAIL
  v_mfma_f32_32x32x8_bf16 v[32:47], v[12:13], v[14:15], 0
  s_add_u32 s39, s39, 262144
  s_add_u32 s38, s38, 262144
  v_rcp_f32 v108, v112
  s_nop 1
  v_mul_f32 v104, v104, v108
  v_mul_f32 v105, v105, v108
  v_mul_f32 v106, v106, v108
  v_mul_f32 v107, v107, v108
  v_cvt_pk_bf16_f32 v110, v104, v105
  v_cvt_pk_bf16_f32 v111, v106, v107
  ds_write_b64 v3, v[110:111] offset:17408
  s_waitcnt lgkmcnt(0)
  s_barrier
  ds_read_b128 v[120:123], v1 offset:17408
  ds_read_b128 v[124:127], v1 offset:18432
  buffer_load_dword v31, v30, s[4:7], s58 offen sc1
  s_waitcnt lgkmcnt(1)
  v_smfmac_f32_16x16x64_bf16 v[32:35], v[120:123], v[64:71], v9
  v_smfmac_f32_16x16x64_bf16 v[36:39], v[120:123], v[72:79], v9
  ds_read_b128 v[64:67], v0 offset:49152
  s_waitcnt lgkmcnt(1)
  v_smfmac_f32_16x16x64_bf16 v[32:35], v[124:127], v[192:199], v9
  ds_read_b128 v[68:71], v0 offset:50176
  v_smfmac_f32_16x16x64_bf16 v[36:39], v[124:127], v[200:207], v9
  ds_read_b128 v[72:75], v0 offset:57344
  v_smfmac_f32_16x16x64_bf16 v[40:43], v[120:123], v[160:167], v9
  ds_read_b128 v[76:79], v0 offset:58368
  v_smfmac_f32_16x16x64_bf16 v[44:47], v[120:123], v[168:175], v9
  v_smfmac_f32_16x16x64_bf16 v[40:43], v[124:127], v[208:215], v9
  v_add_f32 v32, v32, v33
  v_add_f32 v34, v34, v35
  v_smfmac_f32_16x16x64_bf16 v[44:47], v[124:127], v[216:223], v9
  v_cvt_pk_bf16_f32 v104, v32, v34
  v_and_b32 v104, -2, v104
  v_smfmac_f32_16x16x64_bf16 v[48:51], v[120:123], v[176:183], v9
  v_add_f32 v36, v36, v37
  v_add_f32 v38, v38, v39
  v_smfmac_f32_16x16x64_bf16 v[52:55], v[120:123], v[184:191], v9
  v_cvt_pk_bf16_f32 v105, v36, v38
  v_smfmac_f32_16x16x64_bf16 v[48:51], v[124:127], v[224:231], v9
  v_add_f32 v40, v40, v41
  v_add_f32 v42, v42, v43
  v_smfmac_f32_16x16x64_bf16 v[52:55], v[124:127], v[232:239], v9
  v_cvt_pk_bf16_f32 v106, v40, v42
  v_add_f32 v44, v44, v45
  s_waitcnt lgkmcnt(0)
  v_smfmac_f32_16x16x64_bf16 v[56:59], v[120:123], v[64:71], v9
  v_add_f32 v46, v46, v47
  v_cvt_pk_bf16_f32 v107, v44, v46
  v_smfmac_f32_16x16x64_bf16 v[60:63], v[120:123], v[72:79], v9
  buffer_store_dwordx4 v[104:107], v6, s[4:7], 0 offen sc1
  v_smfmac_f32_16x16x64_bf16 v[56:59], v[124:127], v[240:247], v9
  v_add_f32 v48, v48, v49
  v_add_f32 v50, v50, v51
  v_smfmac_f32_16x16x64_bf16 v[60:63], v[124:127], v[248:255], v9
  v_cvt_pk_bf16_f32 v108, v48, v50
  v_and_b32 v108, -2, v108
  v_add_f32 v52, v52, v53
  v_add_f32 v54, v54, v55
  v_cvt_pk_bf16_f32 v109, v52, v54
  v_add_f32 v56, v56, v57
  v_add_f32 v58, v58, v59
  v_cvt_pk_bf16_f32 v110, v56, v58
  v_add_f32 v60, v60, v61
  v_add_f32 v62, v62, v63
  v_cvt_pk_bf16_f32 v111, v60, v62
  buffer_store_dwordx4 v[108:111], v6, s[4:7], s42 offen sc1
  ds_read_b128 v[48:51], v4 offset:0
  ds_read_b128 v[52:55], v4 offset:1024
  ds_read_b128 v[56:59], v4 offset:8192
  ds_read_b128 v[60:63], v4 offset:9216
  ds_read_b128 v[64:67], v4 offset:16384
  ds_read_b128 v[68:71], v4 offset:17408
  ds_read_b128 v[72:75], v4 offset:24576
  ds_read_b128 v[76:79], v4 offset:25600
  s_add_u32 s36, s36, 1
  s_mov_b32 s37, 0
  s_add_u32 s40, s40, 262144
  v_mov_b64 v[112:113], 0
  v_mov_b64 v[114:115], 0
  v_mov_b64 v[116:117], 0
  v_mov_b64 v[118:119], 0
  v_mov_b64 v[120:121], 0
  v_mov_b64 v[122:123], 0
  v_mov_b64 v[124:125], 0
  v_mov_b64 v[126:127], 0
  v_mov_b64 v[104:105], 0
  v_mov_b64 v[106:107], 0
  v_mov_b64 v[108:109], 0
  v_mov_b64 v[110:111], 0
  s_waitcnt vmcnt(0)
CHS_BP1:
  buffer_load_dwordx4 v[40:43], v7, s[4:7], 0 offen sc1
  buffer_load_dwordx4 v[44:47], v7, s[4:7], 0 offen offset:1024 sc1
  s_add_u32 s37, s37, 1
  s_cmp_gt_u32 s37, 0x20000
  s_cbranch_scc1 KEND
  s_waitcnt vmcnt(1)
  v_mfma_f32_16x16x32_bf16 v[32:35], v[40:43], v[16:19], 0
  s_waitcnt vmcnt(0)
  v_mfma_f32_16x16x32_bf16 v[32:35], v[44:47], v[16:19], v[32:35]
  v_bitop3_b32 v20, v40, v44, 1 bitop3:0xa8
  v_cmpx_ne_u32 vcc, 0, v20
  s_cbranch_vccnz CHS_BP1
  s_mov_b64 exec, -1
  s_nop 3
  v_add_f32 v32, v32, v33
  v_add_f32 v34, v34, v35
  v_add_f32 v32, v32, v34
  s_nop 1
  v_mov_b32_dpp v33, v32 quad_perm:[2,3,2,3] row_mask:0xf bank_mask:0xf
  v_cvt_pk_bf16_f32 v32, v32, v33
  v_and_b32 v32, -2, v32
  buffer_store_dword v32, v8, s[4:7], 0 offen sc1
  v_readlane_b32 s56, v31, 0
  v_readlane_b32 s57, v31, 1
  s_min_u32 s56, s56, s57
  s_sub_u32 s56, s56, 2
  v_mov_b32 v31, s36
  v_xor_b32 v21, 2048, v0
  v_xor_b32 v22, 4096, v0
  v_xor_b32 v23, 6144, v0
  s_waitcnt lgkmcnt(0)
  s_mov_b32 s37, 0
  s_waitcnt vmcnt(0)
CHS_BP2:
  buffer_load_dwordx4 v[32:35], v0, s[4:7], s41 offen sc1
  buffer_load_dwordx4 v[36:39], v0, s[4:7], s41 offen offset:1024 sc1
CHS_BP2C:
  s_add_u32 s37, s37, 1
  s_cmp_gt_u32 s37, 0x20000
  s_cbranch_scc1 KEND
  s_waitcnt vmcnt(1)
  v_bitop3_b32 v20, v32, v33, v34 bitop3:0xfe
  s_waitcnt vmcnt(0)
  v_bitop3_b32 v20, v20, v35, v36 bitop3:0xfe
  v_bitop3_b32 v20, v20, v37, v38 bitop3:0xfe
  v_bitop3_b32 v20, v20, v39, 1 bitop3:0xa8
  v_cmpx_ne_u32 vcc, 0, v20
  s_cbranch_vccnz CHS_BP2
  s_mov_b64 exec, -1
CHS_BP2D:
  s_branch CHS_LOOP
CHS_BTAIL:
  s_add_u32 s40, s40, 262144
  buffer_store_dwordx4 v[24:27], v0, s[4:7], s40 offen sc1
  buffer_store_dwordx4 v[28:31], v0, s[4:7], s40 offen offset:1024 sc1
  s_nop 1
  v_mov_b32 v31, 0xff
  s_waitcnt vmcnt(0)
  s_barrier
  s_mov_b64 exec, s[46:47]
  buffer_store_dword v31, v30, s[4:7], 0 offen sc1
  s_mov_b64 exec, -1
  s_branch CH_END
CHS_ARS:
  s_mov_b32 s37, 0
CHS_ARL:
  buffer_load_dword v20, v30, s[4:7], s58 offen sc1
  s_add_u32 s37, s37, 1
  s_cmp_gt_u32 s37, 0x20000
  s_cbranch_scc1 KEND
  s_waitcnt vmcnt(0)
  v_readlane_b32 s56, v20, 0
  v_readlane_b32 s57, v20, 1
  s_min_u32 s56, s56, s57
  s_sub_u32 s56, s56, 2
  s_cmp_lt_i32 s56, s36
  s_cbranch_scc1 CHS_ARL
  s_branch CHS_ARB
CHS_AMX:
  v_max_f32 v108, 0, v116
  s_nop 1
  v_max_f32_dpp v108, v108, v108 quad_perm:[1,0,3,2] row_mask:0xf bank_mask:0xf
  v_mov_b32 v109, v108
  s_nop 1
  v_permlane16_swap_b32 v108, v109
  v_max_f32 v108, v108, v109
  v_mov_b32 v109, v108
  s_nop 1
  v_permlane32_swap_b32 v108, v109
  v_max_f32 v108, v108, v109
  v_sub_f32 v116, v116, v108
  v_exp_f32 v108, -v108
  s_nop 7
  v_mul_f32 v112, v112, v108
  v_mul_f32 v104, v104, v108
  v_mul_f32 v105, v105, v108
  v_mul_f32 v106, v106, v108
  v_mul_f32 v107, v107, v108
  s_nop 1
  s_branch CHS_AMB
CHS_BRS:
  s_mov_b32 s37, 0
CHS_BRL:
  buffer_load_dword v20, v30, s[4:7], s58 offen sc1
  s_add_u32 s37, s37, 1
  s_cmp_gt_u32 s37, 0x20000
  s_cbranch_scc1 KEND
  s_waitcnt vmcnt(0)
  v_readlane_b32 s56, v20, 0
  v_readlane_b32 s57, v20, 1
  s_min_u32 s56, s56, s57
  s_sub_u32 s56, s56, 2
  s_cmp_lt_i32 s56, s36
  s_cbranch_scc1 CHS_BRL
  s_branch CHS_BRB
CHS_BMX:
  v_max_f32 v108, 0, v116
  s_nop 1
  v_max_f32_dpp v108, v108, v108 quad_perm:[1,0,3,2] row_mask:0xf bank_mask:0xf
  v_mov_b32 v109, v108
  s_nop 1
  v_permlane16_swap_b32 v108, v109
  v_max_f32 v108, v108, v109
  v_mov_b32 v109, v108
  s_nop 1
  v_permlane32_swap_b32 v108, v109
  v_max_f32 v108, v108, v109
  v_sub_f32 v116, v116, v108
  v_exp_f32 v108, -v108
  s_nop 7
  v_mul_f32 v112, v112, v108
  v_mul_f32 v104, v104, v108
  v_mul_f32 v105, v105, v108
  v_mul_f32 v106, v106, v108
  v_mul_f32 v107, v107, v108
  s_nop 1
  s_branch CHS_BMB
CH_END:
KEND:
  s_endpgm
QKV:
  s_load_dwordx4 s[24:27], s[0:1], 16
  s_load_dwordx2 s[28:29], s[0:1], 32
  v_and_b32 v40, 63, v0
  v_and_b32 v41, 15, v0
  v_bfe_u32 v42, v0, 4, 2
  v_lshlrev_b32 v1, 4, v40
  s_lshl_b32 s36, s19, 12
  s_lshl_b32 s37, s16, 7
  s_add_u32 s36, s36, s37
  s_lshl_b32 s37, s17, 2
  s_add_u32 s36, s36, s37
  s_add_u32 s36, s36, 70582272
  v_mov_b32 v43, 0x80000000
  v_mov_b32 v44, s36
  v_cmp_eq_u32 vcc, 0, v40
  s_nop 1
  v_cndmask_b32 v2, v43, v44, vcc
  v_mov_b32 v43, 0
  buffer_store_dword v43, v2, s[4:7], 0 offen sc1
  s_waitcnt lgkmcnt(0)
  s_cmp_eq_u32 s19, 1
  s_cselect_b32 s20, s26, s24
  s_cselect_b32 s21, s27, s25
  s_cmp_eq_u32 s19, 2
  s_cselect_b32 s20, s28, s20
  s_cselect_b32 s21, s29, s21
  s_mov_b32 s22, 0x400000
  s_mov_b32 s23, 0x00020000
  v_lshlrev_b32 v43, 1, v42
  v_xor_b32 v43, v43, v41
  v_lshlrev_b32 v43, 4, v43
  v_lshl_add_u32 v43, v42, 13, v43
  s_lshl_b32 s36, s16, 8
  v_add_u32 v3, s36, v43
  v_xor_b32 v4, 0x80, v3
  s_lshl_b32 s36, s17, 20
  s_lshl_b32 s37, s17, 15
  s_add_u32 m0, s37, 0
  s_nop 0
  buffer_load_dwordx4 v3, s[20:23], s36 offen lds
  s_add_u32 s36, s36, 32768
  s_add_u32 m0, s37, 1024
  s_nop 0
  buffer_load_dwordx4 v3, s[20:23], s36 offen lds
  s_add_u32 s36, s36, 32768
  s_add_u32 m0, s37, 2048
  s_nop 0
  buffer_load_dwordx4 v4, s[20:23], s36 offen lds
  s_add_u32 s36, s36, 32768
  s_add_u32 m0, s37, 3072
  s_nop 0
  buffer_load_dwordx4 v4, s[20:23], s36 offen lds
  s_add_u32 s36, s36, 32768
  s_add_u32 m0, s37, 4096
  s_nop 0
  buffer_load_dwordx4 v3, s[20:23], s36 offen lds
  s_add_u32 s36, s36, 32768
  s_add_u32 m0, s37, 5120
  s_nop 0
  buffer_load_dwordx4 v3, s[20:23], s36 offen lds
  s_add_u32 s36, s36, 32768
  s_add_u32 m0, s37, 6144
  s_nop 0
  buffer_load_dwordx4 v4, s[20:23], s36 offen lds
  s_add_u32 s36, s36, 32768
  s_add_u32 m0, s37, 7168
  s_nop 0
  buffer_load_dwordx4 v4, s[20:23], s36 offen lds
  s_add_u32 s36, s36, 32768
  s_add_u32 m0, s37, 8192
  s_nop 0
  buffer_load_dwordx4 v3, s[20:23], s36 offen lds
  s_add_u32 s36, s36, 32768
  s_add_u32 m0, s37, 9216
  s_nop 0
  buffer_load_dwordx4 v3, s[20:23], s36 offen lds
  s_add_u32 s36, s36, 32768
  s_add_u32 m0, s37, 10240
  s_nop 0
  buffer_load_dwordx4 v4, s[20:23], s36 offen lds
  s_add_u32 s36, s36, 32768
  s_add_u32 m0, s37, 11264
  s_nop 0
  buffer_load_dwordx4 v4, s[20:23], s36 offen lds
  s_add_u32 s36, s36, 32768
  s_add_u32 m0, s37, 12288
  s_nop 0
  buffer_load_dwordx4 v3, s[20:23], s36 offen lds
  s_add_u32 s36, s36, 32768
  s_add_u32 m0, s37, 13312
  s_nop 0
  buffer_load_dwordx4 v3, s[20:23], s36 offen lds
  s_add_u32 s36, s36, 32768
  s_add_u32 m0, s37, 14336
  s_nop 0
  buffer_load_dwordx4 v4, s[20:23], s36 offen lds
  s_add_u32 s36, s36, 32768
  s_add_u32 m0, s37, 15360
  s_nop 0
  buffer_load_dwordx4 v4, s[20:23], s36 offen lds
  s_add_u32 s36, s36, 32768
  s_add_u32 m0, s37, 16384
  s_nop 0
  buffer_load_dwordx4 v3, s[20:23], s36 offen lds
  s_add_u32 s36, s36, 32768
  s_add_u32 m0, s37, 17408
  s_nop 0
  buffer_load_dwordx4 v3, s[20:23], s36 offen lds
  s_add_u32 s36, s36, 32768
  s_add_u32 m0, s37, 18432
  s_nop 0
  buffer_load_dwordx4 v4, s[20:23], s36 offen lds
  s_add_u32 s36, s36, 32768
  s_add_u32 m0, s37, 19456
  s_nop 0
  buffer_load_dwordx4 v4, s[20:23], s36 offen lds
  s_add_u32 s36, s36, 32768
  s_add_u32 m0, s37, 20480
  s_nop 0
  buffer_load_dwordx4 v3, s[20:23], s36 offen lds
  s_add_u32 s36, s36, 32768
  s_add_u32 m0, s37, 21504
  s_nop 0
  buffer_load_dwordx4 v3, s[20:23], s36 offen lds
  s_add_u32 s36, s36, 32768
  s_add_u32 m0, s37, 22528
  s_nop 0
  buffer_load_dwordx4 v4, s[20:23], s36 offen lds
  s_add_u32 s36, s36, 32768
  s_add_u32 m0, s37, 23552
  s_nop 0
  buffer_load_dwordx4 v4, s[20:23], s36 offen lds
  s_add_u32 s36, s36, 32768
  s_add_u32 m0, s37, 24576
  s_nop 0
  buffer_load_dwordx4 v3, s[20:23], s36 offen lds
  s_add_u32 s36, s36, 32768
  s_add_u32 m0, s37, 25600
  s_nop 0
  buffer_load_dwordx4 v3, s[20:23], s36 offen lds
  s_add_u32 s36, s36, 32768
  s_add_u32 m0, s37, 26624
  s_nop 0
  buffer_load_dwordx4 v4, s[20:23], s36 offen lds
  s_add_u32 s36, s36, 32768
  s_add_u32 m0, s37, 27648
  s_nop 0
  buffer_load_dwordx4 v4, s[20:23], s36 offen lds
  s_add_u32 s36, s36, 32768
  s_add_u32 m0, s37, 28672
  s_nop 0
  buffer_load_dwordx4 v3, s[20:23], s36 offen lds
  s_add_u32 s36, s36, 32768
  s_add_u32 m0, s37, 29696
  s_nop 0
  buffer_load_dwordx4 v3, s[20:23], s36 offen lds
  s_add_u32 s36, s36, 32768
  s_add_u32 m0, s37, 30720
  s_nop 0
  buffer_load_dwordx4 v4, s[20:23], s36 offen lds
  s_add_u32 s36, s36, 32768
  s_add_u32 m0, s37, 31744
  s_nop 0
  buffer_load_dwordx4 v4, s[20:23], s36 offen lds
  s_add_u32 s36, s36, 32768
  v_lshrrev_b32 v43, 2, v41
  v_and_b32 v44, 3, v41
  v_and_b32 v45, 1, v42
  v_lshl_add_u32 v45, v45, 2, v43
  s_lshl_b32 s36, s17, 1
  v_xor_b32 v45, s36, v45
  v_lshl_add_u32 v43, v42, 3, v43
  v_lshlrev_b32 v43, 8, v43
  v_lshl_add_u32 v43, v45, 5, v43
  v_lshl_add_u32 v6, v44, 3, v43
  v_xor_b32 v7, 32, v6
  v_add_u32 v8, 0x10000, v6
  v_add_u32 v9, 0x10000, v7
  s_waitcnt vmcnt(32)
  s_barrier
  s_cmp_lg_u32 s17, 0
  s_cbranch_scc1 QKV_AR
  v_mov_b32 v43, 1
  s_mov_b64 exec, 1
  s_cmp_gt_u32 s19, 4
  s_cselect_b32 s99, 8, 4
  s_lshl_b32 s98, s99, 4
  s_add_u32 s98, s98, 64
  s_cmp_eq_u32 s19, 4
  s_cselect_b32 s98, 0, s98
  s_cselect_b32 s99, 0, s99
  s_cselect_b32 s97, 31, 95
  v_mov_b32 v44, s3
  buffer_atomic_add v43, v44, s[8:11], s98 offen sc0 sc1
  s_waitcnt vmcnt(0)
  v_readfirstlane_b32 s98, v43
  v_mov_b32 v43, 32
  s_cmp_lg_u32 s98, s97
  s_cbranch_scc1 QKV_ARN
  buffer_store_dword v43, v44, s[8:11], s99 offen offset:64 sc1
QKV_ARN:
  s_mov_b64 exec, -1
QKV_AR:
  s_waitcnt vmcnt(0)
  s_barrier
  ds_read_b64_tr_b16 a[0:1], v6 offset:0
  ds_read_b64_tr_b16 a[2:3], v6 offset:1024
  ds_read_b64_tr_b16 a[4:5], v6 offset:8192
  ds_read_b64_tr_b16 a[6:7], v6 offset:9216
  ds_read_b64_tr_b16 a[8:9], v6 offset:16384
  ds_read_b64_tr_b16 a[10:11], v6 offset:17408
  ds_read_b64_tr_b16 a[12:13], v6 offset:24576
  ds_read_b64_tr_b16 a[14:15], v6 offset:25600
  s_waitcnt lgkmcnt(0)
  ds_read_b64_tr_b16 a[16:17], v6 offset:32768
  ds_read_b64_tr_b16 a[18:19], v6 offset:33792
  ds_read_b64_tr_b16 a[20:21], v6 offset:40960
  ds_read_b64_tr_b16 a[22:23], v6 offset:41984
  ds_read_b64_tr_b16 a[24:25], v6 offset:49152
  ds_read_b64_tr_b16 a[26:27], v6 offset:50176
  ds_read_b64_tr_b16 a[28:29], v6 offset:57344
  ds_read_b64_tr_b16 a[30:31], v6 offset:58368
  s_waitcnt lgkmcnt(0)
  ds_read_b64_tr_b16 a[32:33], v8 offset:0
  ds_read_b64_tr_b16 a[34:35], v8 offset:1024
  ds_read_b64_tr_b16 a[36:37], v8 offset:8192
  ds_read_b64_tr_b16 a[38:39], v8 offset:9216
  ds_read_b64_tr_b16 a[40:41], v8 offset:16384
  ds_read_b64_tr_b16 a[42:43], v8 offset:17408
  ds_read_b64_tr_b16 a[44:45], v8 offset:24576
  ds_read_b64_tr_b16 a[46:47], v8 offset:25600
  s_waitcnt lgkmcnt(0)
  ds_read_b64_tr_b16 a[48:49], v8 offset:32768
  ds_read_b64_tr_b16 a[50:51], v8 offset:33792
  ds_read_b64_tr_b16 a[52:53], v8 offset:40960
  ds_read_b64_tr_b16 a[54:55], v8 offset:41984
  ds_read_b64_tr_b16 a[56:57], v8 offset:49152
  ds_read_b64_tr_b16 a[58:59], v8 offset:50176
  ds_read_b64_tr_b16 a[60:61], v8 offset:57344
  ds_read_b64_tr_b16 a[62:63], v8 offset:58368
  s_waitcnt lgkmcnt(0)
  ds_read_b64_tr_b16 a[64:65], v7 offset:0
  ds_read_b64_tr_b16 a[66:67], v7 offset:1024
  ds_read_b64_tr_b16 a[68:69], v7 offset:8192
  ds_read_b64_tr_b16 a[70:71], v7 offset:9216
  ds_read_b64_tr_b16 a[72:73], v7 offset:16384
  ds_read_b64_tr_b16 a[74:75], v7 offset:17408
  ds_read_b64_tr_b16 a[76:77], v7 offset:24576
  ds_read_b64_tr_b16 a[78:79], v7 offset:25600
  s_waitcnt lgkmcnt(0)
  ds_read_b64_tr_b16 a[80:81], v7 offset:32768
  ds_read_b64_tr_b16 a[82:83], v7 offset:33792
  ds_read_b64_tr_b16 a[84:85], v7 offset:40960
  ds_read_b64_tr_b16 a[86:87], v7 offset:41984
  ds_read_b64_tr_b16 a[88:89], v7 offset:49152
  ds_read_b64_tr_b16 a[90:91], v7 offset:50176
  ds_read_b64_tr_b16 a[92:93], v7 offset:57344
  ds_read_b64_tr_b16 a[94:95], v7 offset:58368
  s_waitcnt lgkmcnt(0)
  ds_read_b64_tr_b16 a[96:97], v9 offset:0
  ds_read_b64_tr_b16 a[98:99], v9 offset:1024
  ds_read_b64_tr_b16 a[100:101], v9 offset:8192
  ds_read_b64_tr_b16 a[102:103], v9 offset:9216
  ds_read_b64_tr_b16 a[104:105], v9 offset:16384
  ds_read_b64_tr_b16 a[106:107], v9 offset:17408
  ds_read_b64_tr_b16 a[108:109], v9 offset:24576
  ds_read_b64_tr_b16 a[110:111], v9 offset:25600
  s_waitcnt lgkmcnt(0)
  ds_read_b64_tr_b16 a[112:113], v9 offset:32768
  ds_read_b64_tr_b16 a[114:115], v9 offset:33792
  ds_read_b64_tr_b16 a[116:117], v9 offset:40960
  ds_read_b64_tr_b16 a[118:119], v9 offset:41984
  ds_read_b64_tr_b16 a[120:121], v9 offset:49152
  ds_read_b64_tr_b16 a[122:123], v9 offset:50176
  ds_read_b64_tr_b16 a[124:125], v9 offset:57344
  ds_read_b64_tr_b16 a[126:127], v9 offset:58368
  s_waitcnt lgkmcnt(0)
  s_cmp_lg_u32 s17, 0
  s_cbranch_scc1 QKV_HPB
  v_mbcnt_lo_u32_b32 v44, -1, 0
  v_lshlrev_b32 v43, 2, v44
  v_add_u32 v43, s3, v43
  s_mov_b32 s99, 0
  s_mov_b64 exec, 15
QKV_HP:
  buffer_load_dword v44, v43, s[8:11], 0 offen offset:64 sc1
  s_add_u32 s99, s99, 1
  s_cmp_gt_u32 s99, 0x20000
  s_cbranch_scc1 KEND
  s_waitcnt vmcnt(0)
  v_cmp_lt_u32 vcc, 0xffff, v44
  s_mov_b32 s98, 0
  s_cbranch_vccnz QKV_HPX
  v_cmp_eq_u32 vcc, 32, v44
  s_and_b32 s97, vcc_lo, 15
  s_mov_b32 s98, 1
  s_cmp_eq_u32 s97, 15
  s_cbranch_scc1 QKV_HPX
  s_sleep 4
  s_branch QKV_HP
QKV_HPX:
  s_mov_b64 exec, -1
  s_cmp_eq_u32 s98, 0
  s_cbranch_scc1 QKV_HX
  v_lshrrev_b32 v43, 1, v1
  s_mov_b32 s97, 70615040
QKV_HL:
  buffer_load_dwordx2 v[44:45], v43, s[4:7], s97 offen sc1
  s_add_u32 s99, s99, 1
  s_cmp_gt_u32 s99, 0x20000
  s_cbranch_scc1 KEND
  s_waitcnt vmcnt(0)
  v_and_b32 v44, v44, v45
  v_cmp_ne_u32 vcc, 1, v44
  s_cbranch_vccz QKV_HX
  s_sleep 4
  s_branch QKV_HL
QKV_HX:
  v_mov_b32 v43, 131072
  v_mov_b32 v44, s98
  ds_write_b32 v43, v44
  s_waitcnt lgkmcnt(0)
QKV_HPB:
  s_barrier
  v_mov_b32 v43, 131072
  ds_read_b32 v44, v43
  s_waitcnt lgkmcnt(0)
  v_readfirstlane_b32 s98, v44
  s_cmp_eq_u32 s98, 0
  s_cbranch_scc1 FALLBACK
  s_lshl_b32 s36, s17, 13
  v_add_u32 v3, s36, v1
  v_add_u32 v4, 4096, v3
  s_lshl_b32 s36, s17, 11
  v_add_u32 v6, s36, v1
  s_lshl_b32 s36, s19, 24
  s_lshl_b32 s37, s16, 13
  s_add_u32 s36, s36, s37
  s_sub_u32 s36, s36, 14680064
  s_mov_b32 s37, 0
  s_mov_b32 s38, 0
  buffer_load_dwordx4 v[16:19], v3, s[4:7], s37 offen offset:0 sc1
  buffer_load_dwordx4 v[20:23], v3, s[4:7], s37 offen offset:1024 sc1
  buffer_load_dwordx4 v[24:27], v3, s[4:7], s37 offen offset:2048 sc1
  buffer_load_dwordx4 v[28:31], v3, s[4:7], s37 offen offset:3072 sc1
  buffer_load_dwordx4 v[32:35], v4, s[4:7], s37 offen offset:0 sc1
  buffer_load_dwordx4 v[36:39], v4, s[4:7], s37 offen offset:1024 sc1
  buffer_load_dwordx4 v[40:43], v4, s[4:7], s37 offen offset:2048 sc1
  buffer_load_dwordx4 v[44:47], v4, s[4:7], s37 offen offset:3072 sc1
  s_add_u32 s37, s37, 32768
  s_waitcnt vmcnt(0)
  ds_write_b128 v3, v[16:19] offset:0
  ds_write_b128 v3, v[20:23] offset:1024
  ds_write_b128 v3, v[24:27] offset:2048
  ds_write_b128 v3, v[28:31] offset:3072
  ds_write_b128 v3, v[32:35] offset:4096
  ds_write_b128 v3, v[36:39] offset:5120
  ds_write_b128 v3, v[40:43] offset:6144
  ds_write_b128 v3, v[44:47] offset:7168
  s_waitcnt lgkmcnt(0)
  buffer_load_dwordx4 v[16:19], v3, s[4:7], s37 offen offset:0 sc1
  buffer_load_dwordx4 v[20:23], v3, s[4:7], s37 offen offset:1024 sc1
  buffer_load_dwordx4 v[24:27], v3, s[4:7], s37 offen offset:2048 sc1
  buffer_load_dwordx4 v[28:31], v3, s[4:7], s37 offen offset:3072 sc1
  buffer_load_dwordx4 v[32:35], v4, s[4:7], s37 offen offset:0 sc1
  buffer_load_dwordx4 v[36:39], v4, s[4:7], s37 offen offset:1024 sc1
  buffer_load_dwordx4 v[40:43], v4, s[4:7], s37 offen offset:2048 sc1
  buffer_load_dwordx4 v[44:47], v4, s[4:7], s37 offen offset:3072 sc1
  s_add_u32 s37, s37, 32768
  v_mov_b32 v10, 0
  buffer_store_dword v10, v2, s[4:7], 0 offen sc1
  buffer_store_dword v10, v2, s[4:7], 0 offen sc1
  buffer_store_dword v10, v2, s[4:7], 0 offen sc1
  s_cmp_eq_u32 s19, 2
  s_cbranch_scc1 QKV_V
QKV_K:
  s_barrier
  ds_read_b128 v[48:51], v1 offset:0
  ds_read_b128 v[52:55], v1 offset:1024
  ds_read_b128 v[56:59], v1 offset:2048
  ds_read_b128 v[60:63], v1 offset:3072
  ds_read_b128 v[64:67], v1 offset:4096
  ds_read_b128 v[68:71], v1 offset:5120
  ds_read_b128 v[72:75], v1 offset:6144
  ds_read_b128 v[76:79], v1 offset:7168
  s_waitcnt lgkmcnt(6)
  v_mfma_f32_16x16x32_bf16 v[112:115], a[0:3], v[48:51], 0
  v_mfma_f32_16x16x32_bf16 v[120:123], a[0:3], v[52:55], 0
  v_mfma_f32_16x16x32_bf16 v[116:119], a[64:67], v[48:51], 0
  v_mfma_f32_16x16x32_bf16 v[124:127], a[64:67], v[52:55], 0
  ds_read_b128 v[80:83], v1 offset:8192
  ds_read_b128 v[84:87], v1 offset:9216
  s_waitcnt lgkmcnt(6)
  v_mfma_f32_16x16x32_bf16 v[112:115], a[4:7], v[56:59], v[112:115]
  v_mfma_f32_16x16x32_bf16 v[120:123], a[4:7], v[60:63], v[120:123]
  v_mfma_f32_16x16x32_bf16 v[116:119], a[68:71], v[56:59], v[116:119]
  v_mfma_f32_16x16x32_bf16 v[124:127], a[68:71], v[60:63], v[124:127]
  ds_read_b128 v[88:91], v1 offset:10240
  ds_read_b128 v[92:95], v1 offset:11264
  s_waitcnt lgkmcnt(6)
  v_mfma_f32_16x16x32_bf16 v[112:115], a[8:11], v[64:67], v[112:115]
  v_mfma_f32_16x16x32_bf16 v[120:123], a[8:11], v[68:71], v[120:123]
  v_mfma_f32_16x16x32_bf16 v[116:119], a[72:75], v[64:67], v[116:119]
  v_mfma_f32_16x16x32_bf16 v[124:127], a[72:75], v[68:71], v[124:127]
  ds_read_b128 v[96:99], v1 offset:12288
  ds_read_b128 v[100:103], v1 offset:13312
  s_waitcnt lgkmcnt(6)
  v_mfma_f32_16x16x32_bf16 v[112:115], a[12:15], v[72:75], v[112:115]
  v_mfma_f32_16x16x32_bf16 v[120:123], a[12:15], v[76:79], v[120:123]
  v_mfma_f32_16x16x32_bf16 v[116:119], a[76:79], v[72:75], v[116:119]
  v_mfma_f32_16x16x32_bf16 v[124:127], a[76:79], v[76:79], v[124:127]
  ds_read_b128 v[104:107], v1 offset:14336
  ds_read_b128 v[108:111], v1 offset:15360
  s_waitcnt lgkmcnt(6)
  v_mfma_f32_16x16x32_bf16 v[112:115], a[16:19], v[80:83], v[112:115]
  v_mfma_f32_16x16x32_bf16 v[120:123], a[16:19], v[84:87], v[120:123]
  v_mfma_f32_16x16x32_bf16 v[116:119], a[80:83], v[80:83], v[116:119]
  v_mfma_f32_16x16x32_bf16 v[124:127], a[80:83], v[84:87], v[124:127]
  ds_read_b128 v[48:51], v1 offset:16384
  ds_read_b128 v[52:55], v1 offset:17408
  s_waitcnt lgkmcnt(6)
  v_mfma_f32_16x16x32_bf16 v[112:115], a[20:23], v[88:91], v[112:115]
  v_mfma_f32_16x16x32_bf16 v[120:123], a[20:23], v[92:95], v[120:123]
  v_mfma_f32_16x16x32_bf16 v[116:119], a[84:87], v[88:91], v[116:119]
  v_mfma_f32_16x16x32_bf16 v[124:127], a[84:87], v[92:95], v[124:127]
  ds_read_b128 v[56:59], v1 offset:18432
  ds_read_b128 v[60:63], v1 offset:19456
  s_waitcnt lgkmcnt(6)
  v_mfma_f32_16x16x32_bf16 v[112:115], a[24:27], v[96:99], v[112:115]
  v_mfma_f32_16x16x32_bf16 v[120:123], a[24:27], v[100:103], v[120:123]
  v_mfma_f32_16x16x32_bf16 v[116:119], a[88:91], v[96:99], v[116:119]
  v_mfma_f32_16x16x32_bf16 v[124:127], a[88:91], v[100:103], v[124:127]
  ds_read_b128 v[64:67], v1 offset:20480
  ds_read_b128 v[68:71], v1 offset:21504
  s_waitcnt lgkmcnt(6)
  v_mfma_f32_16x16x32_bf16 v[112:115], a[28:31], v[104:107], v[112:115]
  v_mfma_f32_16x16x32_bf16 v[120:123], a[28:31], v[108:111], v[120:123]
  v_mfma_f32_16x16x32_bf16 v[116:119], a[92:95], v[104:107], v[116:119]
  v_mfma_f32_16x16x32_bf16 v[124:127], a[92:95], v[108:111], v[124:127]
  ds_read_b128 v[72:75], v1 offset:22528
  ds_read_b128 v[76:79], v1 offset:23552
  s_waitcnt lgkmcnt(6)
  v_mfma_f32_16x16x32_bf16 v[112:115], a[32:35], v[48:51], v[112:115]
  v_mfma_f32_16x16x32_bf16 v[120:123], a[32:35], v[52:55], v[120:123]
  v_mfma_f32_16x16x32_bf16 v[116:119], a[96:99], v[48:51], v[116:119]
  v_mfma_f32_16x16x32_bf16 v[124:127], a[96:99], v[52:55], v[124:127]
  ds_read_b128 v[80:83], v1 offset:24576
  ds_read_b128 v[84:87], v1 offset:25600
  s_waitcnt lgkmcnt(6)
  v_mfma_f32_16x16x32_bf16 v[112:115], a[36:39], v[56:59], v[112:115]
  v_mfma_f32_16x16x32_bf16 v[120:123], a[36:39], v[60:63], v[120:123]
  v_mfma_f32_16x16x32_bf16 v[116:119], a[100:103], v[56:59], v[116:119]
  v_mfma_f32_16x16x32_bf16 v[124:127], a[100:103], v[60:63], v[124:127]
  ds_read_b128 v[88:91], v1 offset:26624
  ds_read_b128 v[92:95], v1 offset:27648
  s_waitcnt lgkmcnt(6)
  v_mfma_f32_16x16x32_bf16 v[112:115], a[40:43], v[64:67], v[112:115]
  v_mfma_f32_16x16x32_bf16 v[120:123], a[40:43], v[68:71], v[120:123]
  v_mfma_f32_16x16x32_bf16 v[116:119], a[104:107], v[64:67], v[116:119]
  v_mfma_f32_16x16x32_bf16 v[124:127], a[104:107], v[68:71], v[124:127]
  ds_read_b128 v[96:99], v1 offset:28672
  ds_read_b128 v[100:103], v1 offset:29696
  s_waitcnt lgkmcnt(6)
  v_mfma_f32_16x16x32_bf16 v[112:115], a[44:47], v[72:75], v[112:115]
  v_mfma_f32_16x16x32_bf16 v[120:123], a[44:47], v[76:79], v[120:123]
  v_mfma_f32_16x16x32_bf16 v[116:119], a[108:111], v[72:75], v[116:119]
  v_mfma_f32_16x16x32_bf16 v[124:127], a[108:111], v[76:79], v[124:127]
  ds_read_b128 v[104:107], v1 offset:30720
  ds_read_b128 v[108:111], v1 offset:31744
  s_waitcnt vmcnt(3)
  ds_write_b128 v3, v[16:19] offset:32768
  ds_write_b128 v3, v[20:23] offset:33792
  ds_write_b128 v3, v[24:27] offset:34816
  ds_write_b128 v3, v[28:31] offset:35840
  ds_write_b128 v3, v[32:35] offset:36864
  ds_write_b128 v3, v[36:39] offset:37888
  ds_write_b128 v3, v[40:43] offset:38912
  ds_write_b128 v3, v[44:47] offset:39936
  s_waitcnt lgkmcnt(14)
  v_mfma_f32_16x16x32_bf16 v[112:115], a[48:51], v[80:83], v[112:115]
  v_mfma_f32_16x16x32_bf16 v[120:123], a[48:51], v[84:87], v[120:123]
  v_mfma_f32_16x16x32_bf16 v[116:119], a[112:115], v[80:83], v[116:119]
  v_mfma_f32_16x16x32_bf16 v[124:127], a[112:115], v[84:87], v[124:127]
  s_waitcnt lgkmcnt(12)
  v_mfma_f32_16x16x32_bf16 v[112:115], a[52:55], v[88:91], v[112:115]
  v_mfma_f32_16x16x32_bf16 v[120:123], a[52:55], v[92:95], v[120:123]
  v_mfma_f32_16x16x32_bf16 v[116:119], a[116:119], v[88:91], v[116:119]
  v_mfma_f32_16x16x32_bf16 v[124:127], a[116:119], v[92:95], v[124:127]
  s_waitcnt lgkmcnt(10)
  v_mfma_f32_16x16x32_bf16 v[112:115], a[56:59], v[96:99], v[112:115]
  v_mfma_f32_16x16x32_bf16 v[120:123], a[56:59], v[100:103], v[120:123]
  v_mfma_f32_16x16x32_bf16 v[116:119], a[120:123], v[96:99], v[116:119]
  v_mfma_f32_16x16x32_bf16 v[124:127], a[120:123], v[100:103], v[124:127]
  s_waitcnt lgkmcnt(8)
  v_mfma_f32_16x16x32_bf16 v[112:115], a[60:63], v[104:107], v[112:115]
  v_mfma_f32_16x16x32_bf16 v[120:123], a[60:63], v[108:111], v[120:123]
  v_mfma_f32_16x16x32_bf16 v[116:119], a[124:127], v[104:107], v[116:119]
  v_mfma_f32_16x16x32_bf16 v[124:127], a[124:127], v[108:111], v[124:127]
  s_waitcnt lgkmcnt(0)
  buffer_load_dwordx4 v[16:19], v3, s[4:7], s37 offen offset:0 sc1
  buffer_load_dwordx4 v[20:23], v3, s[4:7], s37 offen offset:1024 sc1
  buffer_load_dwordx4 v[24:27], v3, s[4:7], s37 offen offset:2048 sc1
  buffer_load_dwordx4 v[28:31], v3, s[4:7], s37 offen offset:3072 sc1
  buffer_load_dwordx4 v[32:35], v4, s[4:7], s37 offen offset:0 sc1
  buffer_load_dwordx4 v[36:39], v4, s[4:7], s37 offen offset:1024 sc1
  buffer_load_dwordx4 v[40:43], v4, s[4:7], s37 offen offset:2048 sc1
  buffer_load_dwordx4 v[44:47], v4, s[4:7], s37 offen offset:3072 sc1
  s_add_u32 s37, s37, 32768
  v_cvt_pk_bf16_f32 v128, v112, v113
  v_cvt_pk_bf16_f32 v129, v114, v115
  v_cvt_pk_bf16_f32 v130, v116, v117
  v_cvt_pk_bf16_f32 v131, v118, v119
  v_cvt_pk_bf16_f32 v132, v120, v121
  v_cvt_pk_bf16_f32 v133, v122, v123
  v_cvt_pk_bf16_f32 v134, v124, v125
  v_cvt_pk_bf16_f32 v135, v126, v127
  v_mov_b32 v10, s38
  s_waitcnt vmcnt(8)
  buffer_store_dword v10, v2, s[4:7], 0 offen sc1
  buffer_store_dwordx4 v[128:131], v6, s[4:7], s36 offen sc1
  buffer_store_dwordx4 v[132:135], v6, s[4:7], s36 offen offset:1024 sc1
  s_add_u32 s36, s36, 262144
  s_add_u32 s38, s38, 1
  s_barrier
  ds_read_b128 v[48:51], v1 offset:32768
  ds_read_b128 v[52:55], v1 offset:33792
  ds_read_b128 v[56:59], v1 offset:34816
  ds_read_b128 v[60:63], v1 offset:35840
  ds_read_b128 v[64:67], v1 offset:36864
  ds_read_b128 v[68:71], v1 offset:37888
  ds_read_b128 v[72:75], v1 offset:38912
  ds_read_b128 v[76:79], v1 offset:39936
  s_waitcnt lgkmcnt(6)
  v_mfma_f32_16x16x32_bf16 v[112:115], a[0:3], v[48:51], 0
  v_mfma_f32_16x16x32_bf16 v[120:123], a[0:3], v[52:55], 0
  v_mfma_f32_16x16x32_bf16 v[116:119], a[64:67], v[48:51], 0
  v_mfma_f32_16x16x32_bf16 v[124:127], a[64:67], v[52:55], 0
  ds_read_b128 v[80:83], v1 offset:40960
  ds_read_b128 v[84:87], v1 offset:41984
  s_waitcnt lgkmcnt(6)
  v_mfma_f32_16x16x32_bf16 v[112:115], a[4:7], v[56:59], v[112:115]
  v_mfma_f32_16x16x32_bf16 v[120:123], a[4:7], v[60:63], v[120:123]
  v_mfma_f32_16x16x32_bf16 v[116:119], a[68:71], v[56:59], v[116:119]
  v_mfma_f32_16x16x32_bf16 v[124:127], a[68:71], v[60:63], v[124:127]
  ds_read_b128 v[88:91], v1 offset:43008
  ds_read_b128 v[92:95], v1 offset:44032
  s_waitcnt lgkmcnt(6)
  v_mfma_f32_16x16x32_bf16 v[112:115], a[8:11], v[64:67], v[112:115]
  v_mfma_f32_16x16x32_bf16 v[120:123], a[8:11], v[68:71], v[120:123]
  v_mfma_f32_16x16x32_bf16 v[116:119], a[72:75], v[64:67], v[116:119]
  v_mfma_f32_16x16x32_bf16 v[124:127], a[72:75], v[68:71], v[124:127]
  ds_read_b128 v[96:99], v1 offset:45056
  ds_read_b128 v[100:103], v1 offset:46080
  s_waitcnt lgkmcnt(6)
  v_mfma_f32_16x16x32_bf16 v[112:115], a[12:15], v[72:75], v[112:115]
  v_mfma_f32_16x16x32_bf16 v[120:123], a[12:15], v[76:79], v[120:123]
  v_mfma_f32_16x16x32_bf16 v[116:119], a[76:79], v[72:75], v[116:119]
  v_mfma_f32_16x16x32_bf16 v[124:127], a[76:79], v[76:79], v[124:127]
  ds_read_b128 v[104:107], v1 offset:47104
  ds_read_b128 v[108:111], v1 offset:48128
  s_waitcnt lgkmcnt(6)
  v_mfma_f32_16x16x32_bf16 v[112:115], a[16:19], v[80:83], v[112:115]
  v_mfma_f32_16x16x32_bf16 v[120:123], a[16:19], v[84:87], v[120:123]
  v_mfma_f32_16x16x32_bf16 v[116:119], a[80:83], v[80:83], v[116:119]
  v_mfma_f32_16x16x32_bf16 v[124:127], a[80:83], v[84:87], v[124:127]
  ds_read_b128 v[48:51], v1 offset:49152
  ds_read_b128 v[52:55], v1 offset:50176
  s_waitcnt lgkmcnt(6)
  v_mfma_f32_16x16x32_bf16 v[112:115], a[20:23], v[88:91], v[112:115]
  v_mfma_f32_16x16x32_bf16 v[120:123], a[20:23], v[92:95], v[120:123]
  v_mfma_f32_16x16x32_bf16 v[116:119], a[84:87], v[88:91], v[116:119]
  v_mfma_f32_16x16x32_bf16 v[124:127], a[84:87], v[92:95], v[124:127]
  ds_read_b128 v[56:59], v1 offset:51200
  ds_read_b128 v[60:63], v1 offset:52224
  s_waitcnt lgkmcnt(6)
  v_mfma_f32_16x16x32_bf16 v[112:115], a[24:27], v[96:99], v[112:115]
  v_mfma_f32_16x16x32_bf16 v[120:123], a[24:27], v[100:103], v[120:123]
  v_mfma_f32_16x16x32_bf16 v[116:119], a[88:91], v[96:99], v[116:119]
  v_mfma_f32_16x16x32_bf16 v[124:127], a[88:91], v[100:103], v[124:127]
  ds_read_b128 v[64:67], v1 offset:53248
  ds_read_b128 v[68:71], v1 offset:54272
  s_waitcnt lgkmcnt(6)
  v_mfma_f32_16x16x32_bf16 v[112:115], a[28:31], v[104:107], v[112:115]
  v_mfma_f32_16x16x32_bf16 v[120:123], a[28:31], v[108:111], v[120:123]
  v_mfma_f32_16x16x32_bf16 v[116:119], a[92:95], v[104:107], v[116:119]
  v_mfma_f32_16x16x32_bf16 v[124:127], a[92:95], v[108:111], v[124:127]
  ds_read_b128 v[72:75], v1 offset:55296
  ds_read_b128 v[76:79], v1 offset:56320
  s_waitcnt lgkmcnt(6)
  v_mfma_f32_16x16x32_bf16 v[112:115], a[32:35], v[48:51], v[112:115]
  v_mfma_f32_16x16x32_bf16 v[120:123], a[32:35], v[52:55], v[120:123]
  v_mfma_f32_16x16x32_bf16 v[116:119], a[96:99], v[48:51], v[116:119]
  v_mfma_f32_16x16x32_bf16 v[124:127], a[96:99], v[52:55], v[124:127]
  ds_read_b128 v[80:83], v1 offset:57344
  ds_read_b128 v[84:87], v1 offset:58368
  s_waitcnt lgkmcnt(6)
  v_mfma_f32_16x16x32_bf16 v[112:115], a[36:39], v[56:59], v[112:115]
  v_mfma_f32_16x16x32_bf16 v[120:123], a[36:39], v[60:63], v[120:123]
  v_mfma_f32_16x16x32_bf16 v[116:119], a[100:103], v[56:59], v[116:119]
  v_mfma_f32_16x16x32_bf16 v[124:127], a[100:103], v[60:63], v[124:127]
  ds_read_b128 v[88:91], v1 offset:59392
  ds_read_b128 v[92:95], v1 offset:60416
  s_waitcnt lgkmcnt(6)
  v_mfma_f32_16x16x32_bf16 v[112:115], a[40:43], v[64:67], v[112:115]
  v_mfma_f32_16x16x32_bf16 v[120:123], a[40:43], v[68:71], v[120:123]
  v_mfma_f32_16x16x32_bf16 v[116:119], a[104:107], v[64:67], v[116:119]
  v_mfma_f32_16x16x32_bf16 v[124:127], a[104:107], v[68:71], v[124:127]
  ds_read_b128 v[96:99], v1 offset:61440
  ds_read_b128 v[100:103], v1 offset:62464
  s_waitcnt lgkmcnt(6)
  v_mfma_f32_16x16x32_bf16 v[112:115], a[44:47], v[72:75], v[112:115]
  v_mfma_f32_16x16x32_bf16 v[120:123], a[44:47], v[76:79], v[120:123]
  v_mfma_f32_16x16x32_bf16 v[116:119], a[108:111], v[72:75], v[116:119]
  v_mfma_f32_16x16x32_bf16 v[124:127], a[108:111], v[76:79], v[124:127]
  ds_read_b128 v[104:107], v1 offset:63488
  ds_read_b128 v[108:111], v1 offset:64512
  s_waitcnt vmcnt(3)
  ds_write_b128 v3, v[16:19] offset:0
  ds_write_b128 v3, v[20:23] offset:1024
  ds_write_b128 v3, v[24:27] offset:2048
  ds_write_b128 v3, v[28:31] offset:3072
  ds_write_b128 v3, v[32:35] offset:4096
  ds_write_b128 v3, v[36:39] offset:5120
  ds_write_b128 v3, v[40:43] offset:6144
  ds_write_b128 v3, v[44:47] offset:7168
  s_waitcnt lgkmcnt(14)
  v_mfma_f32_16x16x32_bf16 v[112:115], a[48:51], v[80:83], v[112:115]
  v_mfma_f32_16x16x32_bf16 v[120:123], a[48:51], v[84:87], v[120:123]
  v_mfma_f32_16x16x32_bf16 v[116:119], a[112:115], v[80:83], v[116:119]
  v_mfma_f32_16x16x32_bf16 v[124:127], a[112:115], v[84:87], v[124:127]
  s_waitcnt lgkmcnt(12)
  v_mfma_f32_16x16x32_bf16 v[112:115], a[52:55], v[88:91], v[112:115]
  v_mfma_f32_16x16x32_bf16 v[120:123], a[52:55], v[92:95], v[120:123]
  v_mfma_f32_16x16x32_bf16 v[116:119], a[116:119], v[88:91], v[116:119]
  v_mfma_f32_16x16x32_bf16 v[124:127], a[116:119], v[92:95], v[124:127]
  s_waitcnt lgkmcnt(10)
  v_mfma_f32_16x16x32_bf16 v[112:115], a[56:59], v[96:99], v[112:115]
  v_mfma_f32_16x16x32_bf16 v[120:123], a[56:59], v[100:103], v[120:123]
  v_mfma_f32_16x16x32_bf16 v[116:119], a[120:123], v[96:99], v[116:119]
  v_mfma_f32_16x16x32_bf16 v[124:127], a[120:123], v[100:103], v[124:127]
  s_waitcnt lgkmcnt(8)
  v_mfma_f32_16x16x32_bf16 v[112:115], a[60:63], v[104:107], v[112:115]
  v_mfma_f32_16x16x32_bf16 v[120:123], a[60:63], v[108:111], v[120:123]
  v_mfma_f32_16x16x32_bf16 v[116:119], a[124:127], v[104:107], v[116:119]
  v_mfma_f32_16x16x32_bf16 v[124:127], a[124:127], v[108:111], v[124:127]
  s_waitcnt lgkmcnt(0)
  buffer_load_dwordx4 v[16:19], v3, s[4:7], s37 offen offset:0 sc1
  buffer_load_dwordx4 v[20:23], v3, s[4:7], s37 offen offset:1024 sc1
  buffer_load_dwordx4 v[24:27], v3, s[4:7], s37 offen offset:2048 sc1
  buffer_load_dwordx4 v[28:31], v3, s[4:7], s37 offen offset:3072 sc1
  buffer_load_dwordx4 v[32:35], v4, s[4:7], s37 offen offset:0 sc1
  buffer_load_dwordx4 v[36:39], v4, s[4:7], s37 offen offset:1024 sc1
  buffer_load_dwordx4 v[40:43], v4, s[4:7], s37 offen offset:2048 sc1
  buffer_load_dwordx4 v[44:47], v4, s[4:7], s37 offen offset:3072 sc1
  s_add_u32 s37, s37, 32768
  v_cvt_pk_bf16_f32 v128, v112, v113
  v_cvt_pk_bf16_f32 v129, v114, v115
  v_cvt_pk_bf16_f32 v130, v116, v117
  v_cvt_pk_bf16_f32 v131, v118, v119
  v_cvt_pk_bf16_f32 v132, v120, v121
  v_cvt_pk_bf16_f32 v133, v122, v123
  v_cvt_pk_bf16_f32 v134, v124, v125
  v_cvt_pk_bf16_f32 v135, v126, v127
  v_mov_b32 v10, s38
  s_waitcnt vmcnt(8)
  buffer_store_dword v10, v2, s[4:7], 0 offen sc1
  buffer_store_dwordx4 v[128:131], v6, s[4:7], s36 offen sc1
  buffer_store_dwordx4 v[132:135], v6, s[4:7], s36 offen offset:1024 sc1
  s_add_u32 s36, s36, 262144
  s_add_u32 s38, s38, 1
  s_cmp_lt_u32 s38, 64
  s_cbranch_scc1 QKV_K
  v_mov_b32 v10, 0xff
  s_waitcnt vmcnt(0)
  buffer_store_dword v10, v2, s[4:7], 0 offen sc1
  s_branch KEND
QKV_V:
  s_barrier
  ds_read_b128 v[48:51], v1 offset:0
  ds_read_b128 v[52:55], v1 offset:1024
  ds_read_b128 v[56:59], v1 offset:2048
  ds_read_b128 v[60:63], v1 offset:3072
  ds_read_b128 v[64:67], v1 offset:4096
  ds_read_b128 v[68:71], v1 offset:5120
  ds_read_b128 v[72:75], v1 offset:6144
  ds_read_b128 v[76:79], v1 offset:7168
  s_waitcnt lgkmcnt(6)
  v_mfma_f32_16x16x32_bf16 v[112:115], v[48:51], a[0:3], 0
  v_mfma_f32_16x16x32_bf16 v[116:119], v[52:55], a[0:3], 0
  v_mfma_f32_16x16x32_bf16 v[120:123], v[48:51], a[64:67], 0
  v_mfma_f32_16x16x32_bf16 v[124:127], v[52:55], a[64:67], 0
  ds_read_b128 v[80:83], v1 offset:8192
  ds_read_b128 v[84:87], v1 offset:9216
  s_waitcnt lgkmcnt(6)
  v_mfma_f32_16x16x32_bf16 v[112:115], v[56:59], a[4:7], v[112:115]
  v_mfma_f32_16x16x32_bf16 v[116:119], v[60:63], a[4:7], v[116:119]
  v_mfma_f32_16x16x32_bf16 v[120:123], v[56:59], a[68:71], v[120:123]
  v_mfma_f32_16x16x32_bf16 v[124:127], v[60:63], a[68:71], v[124:127]
  ds_read_b128 v[88:91], v1 offset:10240
  ds_read_b128 v[92:95], v1 offset:11264
  s_waitcnt lgkmcnt(6)
  v_mfma_f32_16x16x32_bf16 v[112:115], v[64:67], a[8:11], v[112:115]
  v_mfma_f32_16x16x32_bf16 v[116:119], v[68:71], a[8:11], v[116:119]
  v_mfma_f32_16x16x32_bf16 v[120:123], v[64:67], a[72:75], v[120:123]
  v_mfma_f32_16x16x32_bf16 v[124:127], v[68:71], a[72:75], v[124:127]
  ds_read_b128 v[96:99], v1 offset:12288
  ds_read_b128 v[100:103], v1 offset:13312
  s_waitcnt lgkmcnt(6)
  v_mfma_f32_16x16x32_bf16 v[112:115], v[72:75], a[12:15], v[112:115]
  v_mfma_f32_16x16x32_bf16 v[116:119], v[76:79], a[12:15], v[116:119]
  v_mfma_f32_16x16x32_bf16 v[120:123], v[72:75], a[76:79], v[120:123]
  v_mfma_f32_16x16x32_bf16 v[124:127], v[76:79], a[76:79], v[124:127]
  ds_read_b128 v[104:107], v1 offset:14336
  ds_read_b128 v[108:111], v1 offset:15360
  s_waitcnt lgkmcnt(6)
  v_mfma_f32_16x16x32_bf16 v[112:115], v[80:83], a[16:19], v[112:115]
  v_mfma_f32_16x16x32_bf16 v[116:119], v[84:87], a[16:19], v[116:119]
  v_mfma_f32_16x16x32_bf16 v[120:123], v[80:83], a[80:83], v[120:123]
  v_mfma_f32_16x16x32_bf16 v[124:127], v[84:87], a[80:83], v[124:127]
  ds_read_b128 v[48:51], v1 offset:16384
  ds_read_b128 v[52:55], v1 offset:17408
  s_waitcnt lgkmcnt(6)
  v_mfma_f32_16x16x32_bf16 v[112:115], v[88:91], a[20:23], v[112:115]
  v_mfma_f32_16x16x32_bf16 v[116:119], v[92:95], a[20:23], v[116:119]
  v_mfma_f32_16x16x32_bf16 v[120:123], v[88:91], a[84:87], v[120:123]
  v_mfma_f32_16x16x32_bf16 v[124:127], v[92:95], a[84:87], v[124:127]
  ds_read_b128 v[56:59], v1 offset:18432
  ds_read_b128 v[60:63], v1 offset:19456
  s_waitcnt lgkmcnt(6)
  v_mfma_f32_16x16x32_bf16 v[112:115], v[96:99], a[24:27], v[112:115]
  v_mfma_f32_16x16x32_bf16 v[116:119], v[100:103], a[24:27], v[116:119]
  v_mfma_f32_16x16x32_bf16 v[120:123], v[96:99], a[88:91], v[120:123]
  v_mfma_f32_16x16x32_bf16 v[124:127], v[100:103], a[88:91], v[124:127]
  ds_read_b128 v[64:67], v1 offset:20480
  ds_read_b128 v[68:71], v1 offset:21504
  s_waitcnt lgkmcnt(6)
  v_mfma_f32_16x16x32_bf16 v[112:115], v[104:107], a[28:31], v[112:115]
  v_mfma_f32_16x16x32_bf16 v[116:119], v[108:111], a[28:31], v[116:119]
  v_mfma_f32_16x16x32_bf16 v[120:123], v[104:107], a[92:95], v[120:123]
  v_mfma_f32_16x16x32_bf16 v[124:127], v[108:111], a[92:95], v[124:127]
  ds_read_b128 v[72:75], v1 offset:22528
  ds_read_b128 v[76:79], v1 offset:23552
  s_waitcnt lgkmcnt(6)
  v_mfma_f32_16x16x32_bf16 v[112:115], v[48:51], a[32:35], v[112:115]
  v_mfma_f32_16x16x32_bf16 v[116:119], v[52:55], a[32:35], v[116:119]
  v_mfma_f32_16x16x32_bf16 v[120:123], v[48:51], a[96:99], v[120:123]
  v_mfma_f32_16x16x32_bf16 v[124:127], v[52:55], a[96:99], v[124:127]
  ds_read_b128 v[80:83], v1 offset:24576
  ds_read_b128 v[84:87], v1 offset:25600
  s_waitcnt lgkmcnt(6)
  v_mfma_f32_16x16x32_bf16 v[112:115], v[56:59], a[36:39], v[112:115]
  v_mfma_f32_16x16x32_bf16 v[116:119], v[60:63], a[36:39], v[116:119]
  v_mfma_f32_16x16x32_bf16 v[120:123], v[56:59], a[100:103], v[120:123]
  v_mfma_f32_16x16x32_bf16 v[124:127], v[60:63], a[100:103], v[124:127]
  ds_read_b128 v[88:91], v1 offset:26624
  ds_read_b128 v[92:95], v1 offset:27648
  s_waitcnt lgkmcnt(6)
  v_mfma_f32_16x16x32_bf16 v[112:115], v[64:67], a[40:43], v[112:115]
  v_mfma_f32_16x16x32_bf16 v[116:119], v[68:71], a[40:43], v[116:119]
  v_mfma_f32_16x16x32_bf16 v[120:123], v[64:67], a[104:107], v[120:123]
  v_mfma_f32_16x16x32_bf16 v[124:127], v[68:71], a[104:107], v[124:127]
  ds_read_b128 v[96:99], v1 offset:28672
  ds_read_b128 v[100:103], v1 offset:29696
  s_waitcnt lgkmcnt(6)
  v_mfma_f32_16x16x32_bf16 v[112:115], v[72:75], a[44:47], v[112:115]
  v_mfma_f32_16x16x32_bf16 v[116:119], v[76:79], a[44:47], v[116:119]
  v_mfma_f32_16x16x32_bf16 v[120:123], v[72:75], a[108:111], v[120:123]
  v_mfma_f32_16x16x32_bf16 v[124:127], v[76:79], a[108:111], v[124:127]
  ds_read_b128 v[104:107], v1 offset:30720
  ds_read_b128 v[108:111], v1 offset:31744
  s_waitcnt vmcnt(3)
  ds_write_b128 v3, v[16:19] offset:32768
  ds_write_b128 v3, v[20:23] offset:33792
  ds_write_b128 v3, v[24:27] offset:34816
  ds_write_b128 v3, v[28:31] offset:35840
  ds_write_b128 v3, v[32:35] offset:36864
  ds_write_b128 v3, v[36:39] offset:37888
  ds_write_b128 v3, v[40:43] offset:38912
  ds_write_b128 v3, v[44:47] offset:39936
  s_waitcnt lgkmcnt(14)
  v_mfma_f32_16x16x32_bf16 v[112:115], v[80:83], a[48:51], v[112:115]
  v_mfma_f32_16x16x32_bf16 v[116:119], v[84:87], a[48:51], v[116:119]
  v_mfma_f32_16x16x32_bf16 v[120:123], v[80:83], a[112:115], v[120:123]
  v_mfma_f32_16x16x32_bf16 v[124:127], v[84:87], a[112:115], v[124:127]
  s_waitcnt lgkmcnt(12)
  v_mfma_f32_16x16x32_bf16 v[112:115], v[88:91], a[52:55], v[112:115]
  v_mfma_f32_16x16x32_bf16 v[116:119], v[92:95], a[52:55], v[116:119]
  v_mfma_f32_16x16x32_bf16 v[120:123], v[88:91], a[116:119], v[120:123]
  v_mfma_f32_16x16x32_bf16 v[124:127], v[92:95], a[116:119], v[124:127]
  s_waitcnt lgkmcnt(10)
  v_mfma_f32_16x16x32_bf16 v[112:115], v[96:99], a[56:59], v[112:115]
  v_mfma_f32_16x16x32_bf16 v[116:119], v[100:103], a[56:59], v[116:119]
  v_mfma_f32_16x16x32_bf16 v[120:123], v[96:99], a[120:123], v[120:123]
  v_mfma_f32_16x16x32_bf16 v[124:127], v[100:103], a[120:123], v[124:127]
  s_waitcnt lgkmcnt(8)
  v_mfma_f32_16x16x32_bf16 v[112:115], v[104:107], a[60:63], v[112:115]
  v_mfma_f32_16x16x32_bf16 v[116:119], v[108:111], a[60:63], v[116:119]
  v_mfma_f32_16x16x32_bf16 v[120:123], v[104:107], a[124:127], v[120:123]
  v_mfma_f32_16x16x32_bf16 v[124:127], v[108:111], a[124:127], v[124:127]
  s_waitcnt lgkmcnt(0)
  buffer_load_dwordx4 v[16:19], v3, s[4:7], s37 offen offset:0 sc1
  buffer_load_dwordx4 v[20:23], v3, s[4:7], s37 offen offset:1024 sc1
  buffer_load_dwordx4 v[24:27], v3, s[4:7], s37 offen offset:2048 sc1
  buffer_load_dwordx4 v[28:31], v3, s[4:7], s37 offen offset:3072 sc1
  buffer_load_dwordx4 v[32:35], v4, s[4:7], s37 offen offset:0 sc1
  buffer_load_dwordx4 v[36:39], v4, s[4:7], s37 offen offset:1024 sc1
  buffer_load_dwordx4 v[40:43], v4, s[4:7], s37 offen offset:2048 sc1
  buffer_load_dwordx4 v[44:47], v4, s[4:7], s37 offen offset:3072 sc1
  s_add_u32 s37, s37, 32768
  v_cvt_pk_bf16_f32 v128, v112, v113
  v_cvt_pk_bf16_f32 v129, v114, v115
  v_cvt_pk_bf16_f32 v130, v116, v117
  v_cvt_pk_bf16_f32 v131, v118, v119
  v_cvt_pk_bf16_f32 v132, v120, v121
  v_cvt_pk_bf16_f32 v133, v122, v123
  v_cvt_pk_bf16_f32 v134, v124, v125
  v_cvt_pk_bf16_f32 v135, v126, v127
  v_mov_b32 v10, s38
  s_waitcnt vmcnt(8)
  buffer_store_dword v10, v2, s[4:7], 0 offen sc1
  buffer_store_dwordx4 v[128:131], v6, s[4:7], s36 offen sc1
  buffer_store_dwordx4 v[132:135], v6, s[4:7], s36 offen offset:1024 sc1
  s_add_u32 s36, s36, 262144
  s_add_u32 s38, s38, 1
  s_barrier
  ds_read_b128 v[48:51], v1 offset:32768
  ds_read_b128 v[52:55], v1 offset:33792
  ds_read_b128 v[56:59], v1 offset:34816
  ds_read_b128 v[60:63], v1 offset:35840
  ds_read_b128 v[64:67], v1 offset:36864
  ds_read_b128 v[68:71], v1 offset:37888
  ds_read_b128 v[72:75], v1 offset:38912
  ds_read_b128 v[76:79], v1 offset:39936
  s_waitcnt lgkmcnt(6)
  v_mfma_f32_16x16x32_bf16 v[112:115], v[48:51], a[0:3], 0
  v_mfma_f32_16x16x32_bf16 v[116:119], v[52:55], a[0:3], 0
  v_mfma_f32_16x16x32_bf16 v[120:123], v[48:51], a[64:67], 0
  v_mfma_f32_16x16x32_bf16 v[124:127], v[52:55], a[64:67], 0
  ds_read_b128 v[80:83], v1 offset:40960
  ds_read_b128 v[84:87], v1 offset:41984
  s_waitcnt lgkmcnt(6)
  v_mfma_f32_16x16x32_bf16 v[112:115], v[56:59], a[4:7], v[112:115]
  v_mfma_f32_16x16x32_bf16 v[116:119], v[60:63], a[4:7], v[116:119]
  v_mfma_f32_16x16x32_bf16 v[120:123], v[56:59], a[68:71], v[120:123]
  v_mfma_f32_16x16x32_bf16 v[124:127], v[60:63], a[68:71], v[124:127]
  ds_read_b128 v[88:91], v1 offset:43008
  ds_read_b128 v[92:95], v1 offset:44032
  s_waitcnt lgkmcnt(6)
  v_mfma_f32_16x16x32_bf16 v[112:115], v[64:67], a[8:11], v[112:115]
  v_mfma_f32_16x16x32_bf16 v[116:119], v[68:71], a[8:11], v[116:119]
  v_mfma_f32_16x16x32_bf16 v[120:123], v[64:67], a[72:75], v[120:123]
  v_mfma_f32_16x16x32_bf16 v[124:127], v[68:71], a[72:75], v[124:127]
  ds_read_b128 v[96:99], v1 offset:45056
  ds_read_b128 v[100:103], v1 offset:46080
  s_waitcnt lgkmcnt(6)
  v_mfma_f32_16x16x32_bf16 v[112:115], v[72:75], a[12:15], v[112:115]
  v_mfma_f32_16x16x32_bf16 v[116:119], v[76:79], a[12:15], v[116:119]
  v_mfma_f32_16x16x32_bf16 v[120:123], v[72:75], a[76:79], v[120:123]
  v_mfma_f32_16x16x32_bf16 v[124:127], v[76:79], a[76:79], v[124:127]
  ds_read_b128 v[104:107], v1 offset:47104
  ds_read_b128 v[108:111], v1 offset:48128
  s_waitcnt lgkmcnt(6)
  v_mfma_f32_16x16x32_bf16 v[112:115], v[80:83], a[16:19], v[112:115]
  v_mfma_f32_16x16x32_bf16 v[116:119], v[84:87], a[16:19], v[116:119]
  v_mfma_f32_16x16x32_bf16 v[120:123], v[80:83], a[80:83], v[120:123]
  v_mfma_f32_16x16x32_bf16 v[124:127], v[84:87], a[80:83], v[124:127]
  ds_read_b128 v[48:51], v1 offset:49152
  ds_read_b128 v[52:55], v1 offset:50176
  s_waitcnt lgkmcnt(6)
  v_mfma_f32_16x16x32_bf16 v[112:115], v[88:91], a[20:23], v[112:115]
  v_mfma_f32_16x16x32_bf16 v[116:119], v[92:95], a[20:23], v[116:119]
  v_mfma_f32_16x16x32_bf16 v[120:123], v[88:91], a[84:87], v[120:123]
  v_mfma_f32_16x16x32_bf16 v[124:127], v[92:95], a[84:87], v[124:127]
  ds_read_b128 v[56:59], v1 offset:51200
  ds_read_b128 v[60:63], v1 offset:52224
  s_waitcnt lgkmcnt(6)
  v_mfma_f32_16x16x32_bf16 v[112:115], v[96:99], a[24:27], v[112:115]
  v_mfma_f32_16x16x32_bf16 v[116:119], v[100:103], a[24:27], v[116:119]
  v_mfma_f32_16x16x32_bf16 v[120:123], v[96:99], a[88:91], v[120:123]
  v_mfma_f32_16x16x32_bf16 v[124:127], v[100:103], a[88:91], v[124:127]
  ds_read_b128 v[64:67], v1 offset:53248
  ds_read_b128 v[68:71], v1 offset:54272
  s_waitcnt lgkmcnt(6)
  v_mfma_f32_16x16x32_bf16 v[112:115], v[104:107], a[28:31], v[112:115]
  v_mfma_f32_16x16x32_bf16 v[116:119], v[108:111], a[28:31], v[116:119]
  v_mfma_f32_16x16x32_bf16 v[120:123], v[104:107], a[92:95], v[120:123]
  v_mfma_f32_16x16x32_bf16 v[124:127], v[108:111], a[92:95], v[124:127]
  ds_read_b128 v[72:75], v1 offset:55296
  ds_read_b128 v[76:79], v1 offset:56320
  s_waitcnt lgkmcnt(6)
  v_mfma_f32_16x16x32_bf16 v[112:115], v[48:51], a[32:35], v[112:115]
  v_mfma_f32_16x16x32_bf16 v[116:119], v[52:55], a[32:35], v[116:119]
  v_mfma_f32_16x16x32_bf16 v[120:123], v[48:51], a[96:99], v[120:123]
  v_mfma_f32_16x16x32_bf16 v[124:127], v[52:55], a[96:99], v[124:127]
  ds_read_b128 v[80:83], v1 offset:57344
  ds_read_b128 v[84:87], v1 offset:58368
  s_waitcnt lgkmcnt(6)
  v_mfma_f32_16x16x32_bf16 v[112:115], v[56:59], a[36:39], v[112:115]
  v_mfma_f32_16x16x32_bf16 v[116:119], v[60:63], a[36:39], v[116:119]
  v_mfma_f32_16x16x32_bf16 v[120:123], v[56:59], a[100:103], v[120:123]
  v_mfma_f32_16x16x32_bf16 v[124:127], v[60:63], a[100:103], v[124:127]
  ds_read_b128 v[88:91], v1 offset:59392
  ds_read_b128 v[92:95], v1 offset:60416
  s_waitcnt lgkmcnt(6)
  v_mfma_f32_16x16x32_bf16 v[112:115], v[64:67], a[40:43], v[112:115]
  v_mfma_f32_16x16x32_bf16 v[116:119], v[68:71], a[40:43], v[116:119]
  v_mfma_f32_16x16x32_bf16 v[120:123], v[64:67], a[104:107], v[120:123]
  v_mfma_f32_16x16x32_bf16 v[124:127], v[68:71], a[104:107], v[124:127]
  ds_read_b128 v[96:99], v1 offset:61440
  ds_read_b128 v[100:103], v1 offset:62464
  s_waitcnt lgkmcnt(6)
  v_mfma_f32_16x16x32_bf16 v[112:115], v[72:75], a[44:47], v[112:115]
  v_mfma_f32_16x16x32_bf16 v[116:119], v[76:79], a[44:47], v[116:119]
  v_mfma_f32_16x16x32_bf16 v[120:123], v[72:75], a[108:111], v[120:123]
  v_mfma_f32_16x16x32_bf16 v[124:127], v[76:79], a[108:111], v[124:127]
  ds_read_b128 v[104:107], v1 offset:63488
  ds_read_b128 v[108:111], v1 offset:64512
  s_waitcnt vmcnt(3)
  ds_write_b128 v3, v[16:19] offset:0
  ds_write_b128 v3, v[20:23] offset:1024
  ds_write_b128 v3, v[24:27] offset:2048
  ds_write_b128 v3, v[28:31] offset:3072
  ds_write_b128 v3, v[32:35] offset:4096
  ds_write_b128 v3, v[36:39] offset:5120
  ds_write_b128 v3, v[40:43] offset:6144
  ds_write_b128 v3, v[44:47] offset:7168
  s_waitcnt lgkmcnt(14)
  v_mfma_f32_16x16x32_bf16 v[112:115], v[80:83], a[48:51], v[112:115]
  v_mfma_f32_16x16x32_bf16 v[116:119], v[84:87], a[48:51], v[116:119]
  v_mfma_f32_16x16x32_bf16 v[120:123], v[80:83], a[112:115], v[120:123]
  v_mfma_f32_16x16x32_bf16 v[124:127], v[84:87], a[112:115], v[124:127]
  s_waitcnt lgkmcnt(12)
  v_mfma_f32_16x16x32_bf16 v[112:115], v[88:91], a[52:55], v[112:115]
  v_mfma_f32_16x16x32_bf16 v[116:119], v[92:95], a[52:55], v[116:119]
  v_mfma_f32_16x16x32_bf16 v[120:123], v[88:91], a[116:119], v[120:123]
  v_mfma_f32_16x16x32_bf16 v[124:127], v[92:95], a[116:119], v[124:127]
  s_waitcnt lgkmcnt(10)
  v_mfma_f32_16x16x32_bf16 v[112:115], v[96:99], a[56:59], v[112:115]
  v_mfma_f32_16x16x32_bf16 v[116:119], v[100:103], a[56:59], v[116:119]
  v_mfma_f32_16x16x32_bf16 v[120:123], v[96:99], a[120:123], v[120:123]
  v_mfma_f32_16x16x32_bf16 v[124:127], v[100:103], a[120:123], v[124:127]
  s_waitcnt lgkmcnt(8)
  v_mfma_f32_16x16x32_bf16 v[112:115], v[104:107], a[60:63], v[112:115]
  v_mfma_f32_16x16x32_bf16 v[116:119], v[108:111], a[60:63], v[116:119]
  v_mfma_f32_16x16x32_bf16 v[120:123], v[104:107], a[124:127], v[120:123]
  v_mfma_f32_16x16x32_bf16 v[124:127], v[108:111], a[124:127], v[124:127]
  s_waitcnt lgkmcnt(0)
  buffer_load_dwordx4 v[16:19], v3, s[4:7], s37 offen offset:0 sc1
  buffer_load_dwordx4 v[20:23], v3, s[4:7], s37 offen offset:1024 sc1
  buffer_load_dwordx4 v[24:27], v3, s[4:7], s37 offen offset:2048 sc1
  buffer_load_dwordx4 v[28:31], v3, s[4:7], s37 offen offset:3072 sc1
  buffer_load_dwordx4 v[32:35], v4, s[4:7], s37 offen offset:0 sc1
  buffer_load_dwordx4 v[36:39], v4, s[4:7], s37 offen offset:1024 sc1
  buffer_load_dwordx4 v[40:43], v4, s[4:7], s37 offen offset:2048 sc1
  buffer_load_dwordx4 v[44:47], v4, s[4:7], s37 offen offset:3072 sc1
  s_add_u32 s37, s37, 32768
  v_cvt_pk_bf16_f32 v128, v112, v113
  v_cvt_pk_bf16_f32 v129, v114, v115
  v_cvt_pk_bf16_f32 v130, v116, v117
  v_cvt_pk_bf16_f32 v131, v118, v119
  v_cvt_pk_bf16_f32 v132, v120, v121
  v_cvt_pk_bf16_f32 v133, v122, v123
  v_cvt_pk_bf16_f32 v134, v124, v125
  v_cvt_pk_bf16_f32 v135, v126, v127
  v_mov_b32 v10, s38
  s_waitcnt vmcnt(8)
  buffer_store_dword v10, v2, s[4:7], 0 offen sc1
  buffer_store_dwordx4 v[128:131], v6, s[4:7], s36 offen sc1
  buffer_store_dwordx4 v[132:135], v6, s[4:7], s36 offen offset:1024 sc1
  s_add_u32 s36, s36, 262144
  s_add_u32 s38, s38, 1
  s_cmp_lt_u32 s38, 64
  s_cbranch_scc1 QKV_V
  v_mov_b32 v10, 0xff
  s_waitcnt vmcnt(0)
  buffer_store_dword v10, v2, s[4:7], 0 offen sc1
  s_branch KEND
XR:
  s_load_dwordx2 s[20:21], s[0:1], 0
  s_load_dwordx4 s[28:31], s[0:1], 80
  s_load_dwordx2 s[24:25], s[0:1], 96
  v_and_b32 v60, 63, v0
  v_and_b32 v61, 15, v0
  v_bfe_u32 v62, v0, 4, 2
  v_lshlrev_b32 v1, 4, v60
  s_sub_u32 s48, s19, 4
  s_lshl_b32 s49, s48, 5
  s_add_u32 s49, s49, s16
  s_lshl_b32 s36, s48, 11
  s_lshl_b32 s37, s17, 7
  s_add_u32 s36, s36, s37
  s_add_u32 s36, s36, 70598656
  v_lshlrev_b32 v63, 2, v60
  v_add_u32 v63, s36, v63
  v_mov_b32 v64, 0x80000000
  v_cmp_gt_u32 vcc, 32, v60
  s_nop 1
  v_cndmask_b32 v3, v64, v63, vcc
  v_cmp_eq_u32 vcc, s16, v60
  s_nop 1
  v_cndmask_b32 v2, v64, v63, vcc
  s_lshl_b32 s36, s49, 2
  s_add_u32 s36, s36, 70615040
  v_mov_b32 v63, s36
  v_cmp_eq_u32 vcc, 0, v0
  s_nop 1
  v_cndmask_b32 v59, v64, v63, vcc
  v_mov_b32 v63, 0
  buffer_store_dword v63, v59, s[4:7], 0 offen sc1
  buffer_store_dword v63, v2, s[4:7], 0 offen offset:0 sc1
  buffer_store_dword v63, v2, s[4:7], 0 offen offset:512 sc1
  buffer_store_dword v63, v2, s[4:7], 0 offen offset:1024 sc1
  s_waitcnt lgkmcnt(0)
  s_mov_b32 s22, 2097152
  s_mov_b32 s23, 0x00020000
  s_mov_b32 s26, 2097152
  s_mov_b32 s27, 0x00020000
  s_mov_b32 s12, s28
  s_mov_b32 s13, s29
  s_mov_b32 s14, 1024
  s_mov_b32 s15, 0x00020000
  s_mov_b32 s32, s30
  s_mov_b32 s33, s31
  s_mov_b32 s34, 3145728
  s_mov_b32 s35, 0x00020000
  v_lshrrev_b32 v63, 2, v0
  v_lshlrev_b32 v64, 4, v63
  s_mov_b32 s36, 49152
  v_mul_lo_u32 v63, v63, s36
  v_and_b32 v65, 3, v0
  v_lshl_add_u32 v63, v65, 4, v63
  s_lshl_b32 s36, s49, 6
  s_cmp_lt_u32 s49, 96
  s_cselect_b32 s36, s36, 0x80000000
  v_add_u32 v63, s36, v63
  buffer_load_dwordx4 v[68:71], v64, s[12:15], 0 offen
  s_mov_b32 s36, 0
  buffer_load_dwordx4 v[72:75], v63, s[32:35], s36 offen
  s_mov_b32 s36, 6144
  buffer_load_dwordx4 v[76:79], v63, s[32:35], s36 offen
  s_mov_b32 s36, 12288
  buffer_load_dwordx4 v[80:83], v63, s[32:35], s36 offen
  s_mov_b32 s36, 18432
  buffer_load_dwordx4 v[84:87], v63, s[32:35], s36 offen
  s_mov_b32 s36, 24576
  buffer_load_dwordx4 v[88:91], v63, s[32:35], s36 offen
  s_mov_b32 s36, 30720
  buffer_load_dwordx4 v[92:95], v63, s[32:35], s36 offen
  s_mov_b32 s36, 36864
  buffer_load_dwordx4 v[96:99], v63, s[32:35], s36 offen
  s_mov_b32 s36, 43008
  buffer_load_dwordx4 v[100:103], v63, s[32:35], s36 offen
  s_lshl_b32 s36, s49, 14
  s_lshl_b32 s37, s17, 8
  s_add_u32 s36, s36, s37
  v_lshlrev_b32 v63, 10, v61
  v_lshl_add_u32 v63, v62, 4, v63
  v_add_u32 v63, s36, v63
  buffer_load_dwordx4 v[112:115], v63, s[20:23], 0 offen offset:0
  buffer_load_dwordx4 v[116:119], v63, s[20:23], 0 offen offset:64
  buffer_load_dwordx4 v[120:123], v63, s[20:23], 0 offen offset:128
  buffer_load_dwordx4 v[124:127], v63, s[20:23], 0 offen offset:192
  s_waitcnt vmcnt(12)
  s_mov_b32 s36, 0xbfb8aa3b
  s_mov_b32 s37, 0xffff0000
  v_lshlrev_b32 v104, 16, v68
  v_and_b32 v105, s37, v68
  v_lshlrev_b32 v106, 16, v69
  v_and_b32 v107, s37, v69
  v_lshlrev_b32 v108, 16, v70
  v_and_b32 v109, s37, v70
  v_lshlrev_b32 v110, 16, v71
  v_and_b32 v111, s37, v71
  v_mul_f32 v128, s36, v104
  v_mul_f32 v129, s36, v105
  v_mul_f32 v130, s36, v106
  v_mul_f32 v131, s36, v107
  v_mul_f32 v132, s36, v108
  v_mul_f32 v133, s36, v109
  v_mul_f32 v134, s36, v110
  v_mul_f32 v135, s36, v111
  v_exp_f32 v128, v128
  v_exp_f32 v129, v129
  v_exp_f32 v130, v130
  v_exp_f32 v131, v131
  v_exp_f32 v132, v132
  v_exp_f32 v133, v133
  v_exp_f32 v134, v134
  v_exp_f32 v135, v135
  v_add_f32 v128, 1.0, v128
  v_add_f32 v129, 1.0, v129
  v_add_f32 v130, 1.0, v130
  v_add_f32 v131, 1.0, v131
  v_add_f32 v132, 1.0, v132
  v_add_f32 v133, 1.0, v133
  v_add_f32 v134, 1.0, v134
  v_add_f32 v135, 1.0, v135
  v_rcp_f32 v128, v128
  v_rcp_f32 v129, v129
  v_rcp_f32 v130, v130
  v_rcp_f32 v131, v131
  v_rcp_f32 v132, v132
  v_rcp_f32 v133, v133
  v_rcp_f32 v134, v134
  v_rcp_f32 v135, v135
  v_mul_f32 v104, v104, v128
  v_mul_f32 v105, v105, v129
  v_mul_f32 v106, v106, v130
  v_mul_f32 v107, v107, v131
  v_mul_f32 v108, v108, v132
  v_mul_f32 v109, v109, v133
  v_mul_f32 v110, v110, v134
  v_mul_f32 v111, v111, v135
  v_cvt_pk_bf16_f32 v68, v104, v105
  v_cvt_pk_bf16_f32 v69, v106, v107
  v_cvt_pk_bf16_f32 v70, v108, v109
  v_cvt_pk_bf16_f32 v71, v110, v111
  v_lshlrev_b32 v104, 16, v68
  v_and_b32 v105, s37, v68
  v_lshlrev_b32 v106, 16, v69
  v_and_b32 v107, s37, v69
  v_lshlrev_b32 v108, 16, v70
  v_and_b32 v109, s37, v70
  v_lshlrev_b32 v110, 16, v71
  v_and_b32 v111, s37, v71
  s_waitcnt vmcnt(4)
  v_lshlrev_b32 v136, 16, v72
  v_and_b32 v137, s37, v72
  v_lshlrev_b32 v138, 16, v73
  v_and_b32 v139, s37, v73
  v_lshlrev_b32 v140, 16, v74
  v_and_b32 v141, s37, v74
  v_lshlrev_b32 v142, 16, v75
  v_and_b32 v143, s37, v75
  v_mul_f32 v128, v104, v136
  v_mul_f32 v129, v104, v137
  v_mul_f32 v130, v104, v138
  v_mul_f32 v131, v104, v139
  v_mul_f32 v132, v104, v140
  v_mul_f32 v133, v104, v141
  v_mul_f32 v134, v104, v142
  v_mul_f32 v135, v104, v143
  v_lshlrev_b32 v136, 16, v76
  v_and_b32 v137, s37, v76
  v_lshlrev_b32 v138, 16, v77
  v_and_b32 v139, s37, v77
  v_lshlrev_b32 v140, 16, v78
  v_and_b32 v141, s37, v78
  v_lshlrev_b32 v142, 16, v79
  v_and_b32 v143, s37, v79
  v_fmac_f32 v128, v105, v136
  v_fmac_f32 v129, v105, v137
  v_fmac_f32 v130, v105, v138
  v_fmac_f32 v131, v105, v139
  v_fmac_f32 v132, v105, v140
  v_fmac_f32 v133, v105, v141
  v_fmac_f32 v134, v105, v142
  v_fmac_f32 v135, v105, v143
  v_lshlrev_b32 v136, 16, v80
  v_and_b32 v137, s37, v80
  v_lshlrev_b32 v138, 16, v81
  v_and_b32 v139, s37, v81
  v_lshlrev_b32 v140, 16, v82
  v_and_b32 v141, s37, v82
  v_lshlrev_b32 v142, 16, v83
  v_and_b32 v143, s37, v83
  v_fmac_f32 v128, v106, v136
  v_fmac_f32 v129, v106, v137
  v_fmac_f32 v130, v106, v138
  v_fmac_f32 v131, v106, v139
  v_fmac_f32 v132, v106, v140
  v_fmac_f32 v133, v106, v141
  v_fmac_f32 v134, v106, v142
  v_fmac_f32 v135, v106, v143
  v_lshlrev_b32 v136, 16, v84
  v_and_b32 v137, s37, v84
  v_lshlrev_b32 v138, 16, v85
  v_and_b32 v139, s37, v85
  v_lshlrev_b32 v140, 16, v86
  v_and_b32 v141, s37, v86
  v_lshlrev_b32 v142, 16, v87
  v_and_b32 v143, s37, v87
  v_fmac_f32 v128, v107, v136
  v_fmac_f32 v129, v107, v137
  v_fmac_f32 v130, v107, v138
  v_fmac_f32 v131, v107, v139
  v_fmac_f32 v132, v107, v140
  v_fmac_f32 v133, v107, v141
  v_fmac_f32 v134, v107, v142
  v_fmac_f32 v135, v107, v143
  v_lshlrev_b32 v136, 16, v88
  v_and_b32 v137, s37, v88
  v_lshlrev_b32 v138, 16, v89
  v_and_b32 v139, s37, v89
  v_lshlrev_b32 v140, 16, v90
  v_and_b32 v141, s37, v90
  v_lshlrev_b32 v142, 16, v91
  v_and_b32 v143, s37, v91
  v_fmac_f32 v128, v108, v136
  v_fmac_f32 v129, v108, v137
  v_fmac_f32 v130, v108, v138
  v_fmac_f32 v131, v108, v139
  v_fmac_f32 v132, v108, v140
  v_fmac_f32 v133, v108, v141
  v_fmac_f32 v134, v108, v142
  v_fmac_f32 v135, v108, v143
  v_lshlrev_b32 v136, 16, v92
  v_and_b32 v137, s37, v92
  v_lshlrev_b32 v138, 16, v93
  v_and_b32 v139, s37, v93
  v_lshlrev_b32 v140, 16, v94
  v_and_b32 v141, s37, v94
  v_lshlrev_b32 v142, 16, v95
  v_and_b32 v143, s37, v95
  v_fmac_f32 v128, v109, v136
  v_fmac_f32 v129, v109, v137
  v_fmac_f32 v130, v109, v138
  v_fmac_f32 v131, v109, v139
  v_fmac_f32 v132, v109, v140
  v_fmac_f32 v133, v109, v141
  v_fmac_f32 v134, v109, v142
  v_fmac_f32 v135, v109, v143
  v_lshlrev_b32 v136, 16, v96
  v_and_b32 v137, s37, v96
  v_lshlrev_b32 v138, 16, v97
  v_and_b32 v139, s37, v97
  v_lshlrev_b32 v140, 16, v98
  v_and_b32 v141, s37, v98
  v_lshlrev_b32 v142, 16, v99
  v_and_b32 v143, s37, v99
  v_fmac_f32 v128, v110, v136
  v_fmac_f32 v129, v110, v137
  v_fmac_f32 v130, v110, v138
  v_fmac_f32 v131, v110, v139
  v_fmac_f32 v132, v110, v140
  v_fmac_f32 v133, v110, v141
  v_fmac_f32 v134, v110, v142
  v_fmac_f32 v135, v110, v143
  v_lshlrev_b32 v136, 16, v100
  v_and_b32 v137, s37, v100
  v_lshlrev_b32 v138, 16, v101
  v_and_b32 v139, s37, v101
  v_lshlrev_b32 v140, 16, v102
  v_and_b32 v141, s37, v102
  v_lshlrev_b32 v142, 16, v103
  v_and_b32 v143, s37, v103
  v_fmac_f32 v128, v111, v136
  v_fmac_f32 v129, v111, v137
  v_fmac_f32 v130, v111, v138
  v_fmac_f32 v131, v111, v139
  v_fmac_f32 v132, v111, v140
  v_fmac_f32 v133, v111, v141
  v_fmac_f32 v134, v111, v142
  v_fmac_f32 v135, v111, v143
  v_add_f32_dpp v128, v128, v128 row_ror:4 row_mask:0xf bank_mask:0xf
  v_add_f32_dpp v129, v129, v129 row_ror:4 row_mask:0xf bank_mask:0xf
  v_add_f32_dpp v130, v130, v130 row_ror:4 row_mask:0xf bank_mask:0xf
  v_add_f32_dpp v131, v131, v131 row_ror:4 row_mask:0xf bank_mask:0xf
  v_add_f32_dpp v132, v132, v132 row_ror:4 row_mask:0xf bank_mask:0xf
  v_add_f32_dpp v133, v133, v133 row_ror:4 row_mask:0xf bank_mask:0xf
  v_add_f32_dpp v134, v134, v134 row_ror:4 row_mask:0xf bank_mask:0xf
  v_add_f32_dpp v135, v135, v135 row_ror:4 row_mask:0xf bank_mask:0xf
  v_add_f32_dpp v128, v128, v128 row_ror:8 row_mask:0xf bank_mask:0xf
  v_add_f32_dpp v129, v129, v129 row_ror:8 row_mask:0xf bank_mask:0xf
  v_add_f32_dpp v130, v130, v130 row_ror:8 row_mask:0xf bank_mask:0xf
  v_add_f32_dpp v131, v131, v131 row_ror:8 row_mask:0xf bank_mask:0xf
  v_add_f32_dpp v132, v132, v132 row_ror:8 row_mask:0xf bank_mask:0xf
  v_add_f32_dpp v133, v133, v133 row_ror:8 row_mask:0xf bank_mask:0xf
  v_add_f32_dpp v134, v134, v134 row_ror:8 row_mask:0xf bank_mask:0xf
  v_add_f32_dpp v135, v135, v135 row_ror:8 row_mask:0xf bank_mask:0xf
  v_lshrrev_b32 v63, 4, v0
  v_lshlrev_b32 v63, 7, v63
  v_lshl_add_u32 v63, v61, 5, v63
  v_cmp_gt_u32 vcc, 4, v61
  s_mov_b64 exec, vcc
  ds_write_b128 v63, v[128:131] offset:16384
  ds_write_b128 v63, v[132:135] offset:16400
  s_mov_b64 exec, -1
  s_waitcnt vmcnt(0)
  v_lshlrev_b32 v160, 16, v112
  v_and_b32 v161, s37, v112
  v_lshlrev_b32 v162, 16, v113
  v_and_b32 v163, s37, v113
  v_lshlrev_b32 v164, 16, v114
  v_and_b32 v165, s37, v114
  v_lshlrev_b32 v166, 16, v115
  v_and_b32 v167, s37, v115
  v_lshlrev_b32 v168, 16, v116
  v_and_b32 v169, s37, v116
  v_lshlrev_b32 v170, 16, v117
  v_and_b32 v171, s37, v117
  v_lshlrev_b32 v172, 16, v118
  v_and_b32 v173, s37, v118
  v_lshlrev_b32 v174, 16, v119
  v_and_b32 v175, s37, v119
  v_lshlrev_b32 v176, 16, v120
  v_and_b32 v177, s37, v120
  v_lshlrev_b32 v178, 16, v121
  v_and_b32 v179, s37, v121
  v_lshlrev_b32 v180, 16, v122
  v_and_b32 v181, s37, v122
  v_lshlrev_b32 v182, 16, v123
  v_and_b32 v183, s37, v123
  v_lshlrev_b32 v184, 16, v124
  v_and_b32 v185, s37, v124
  v_lshlrev_b32 v186, 16, v125
  v_and_b32 v187, s37, v125
  v_lshlrev_b32 v188, 16, v126
  v_and_b32 v189, s37, v126
  v_lshlrev_b32 v190, 16, v127
  v_and_b32 v191, s37, v127
  v_add_f32 v64, v160, v161
  v_mul_f32 v65, v160, v160
  v_mul_f32 v66, v161, v161
  v_add_f32 v64, v64, v162
  v_fmac_f32 v65, v162, v162
  v_add_f32 v64, v64, v163
  v_fmac_f32 v66, v163, v163
  v_add_f32 v64, v64, v164
  v_fmac_f32 v65, v164, v164
  v_add_f32 v64, v64, v165
  v_fmac_f32 v66, v165, v165
  v_add_f32 v64, v64, v166
  v_fmac_f32 v65, v166, v166
  v_add_f32 v64, v64, v167
  v_fmac_f32 v66, v167, v167
  v_add_f32 v64, v64, v168
  v_fmac_f32 v65, v168, v168
  v_add_f32 v64, v64, v169
  v_fmac_f32 v66, v169, v169
  v_add_f32 v64, v64, v170
  v_fmac_f32 v65, v170, v170
  v_add_f32 v64, v64, v171
  v_fmac_f32 v66, v171, v171
  v_add_f32 v64, v64, v172
  v_fmac_f32 v65, v172, v172
  v_add_f32 v64, v64, v173
  v_fmac_f32 v66, v173, v173
  v_add_f32 v64, v64, v174
  v_fmac_f32 v65, v174, v174
  v_add_f32 v64, v64, v175
  v_fmac_f32 v66, v175, v175
  v_add_f32 v64, v64, v176
  v_fmac_f32 v65, v176, v176
  v_add_f32 v64, v64, v177
  v_fmac_f32 v66, v177, v177
  v_add_f32 v64, v64, v178
  v_fmac_f32 v65, v178, v178
  v_add_f32 v64, v64, v179
  v_fmac_f32 v66, v179, v179
  v_add_f32 v64, v64, v180
  v_fmac_f32 v65, v180, v180
  v_add_f32 v64, v64, v181
  v_fmac_f32 v66, v181, v181
  v_add_f32 v64, v64, v182
  v_fmac_f32 v65, v182, v182
  v_add_f32 v64, v64, v183
  v_fmac_f32 v66, v183, v183
  v_add_f32 v64, v64, v184
  v_fmac_f32 v65, v184, v184
  v_add_f32 v64, v64, v185
  v_fmac_f32 v66, v185, v185
  v_add_f32 v64, v64, v186
  v_fmac_f32 v65, v186, v186
  v_add_f32 v64, v64, v187
  v_fmac_f32 v66, v187, v187
  v_add_f32 v64, v64, v188
  v_fmac_f32 v65, v188, v188
  v_add_f32 v64, v64, v189
  v_fmac_f32 v66, v189, v189
  v_add_f32 v64, v64, v190
  v_fmac_f32 v65, v190, v190
  v_add_f32 v64, v64, v191
  v_fmac_f32 v66, v191, v191
  v_add_f32 v65, v65, v66
  v_mov_b32 v66, v64
  v_mov_b32 v67, v65
  s_nop 0
  v_permlane16_swap_b32 v64, v66
  v_permlane16_swap_b32 v65, v67
  v_add_f32 v64, v64, v66
  v_add_f32 v65, v65, v67
  v_mov_b32 v66, v64
  v_mov_b32 v67, v65
  s_nop 0
  v_permlane32_swap_b32 v64, v66
  v_permlane32_swap_b32 v65, v67
  v_add_f32 v64, v64, v66
  v_add_f32 v65, v65, v67
  s_lshl_b32 s36, s17, 3
  v_lshlrev_b32 v63, 5, v61
  v_add_u32 v66, s36, v63
  ds_write_b64 v66, v[64:65] offset:8192
  s_waitcnt lgkmcnt(0)
  s_barrier
  ds_read_b128 v[64:67], v63 offset:8192
  ds_read_b128 v[68:71], v63 offset:8208
  s_cmp_lg_u32 s17, 0
  s_cbranch_scc1 XR_M1
  v_and_b32 v72, 31, v60
  v_lshrrev_b32 v73, 5, v60
  v_lshlrev_b32 v72, 2, v72
  v_lshl_add_u32 v73, v73, 10, v72
  ds_read_b32 v80, v73 offset:16384
  ds_read_b32 v81, v73 offset:16512
  ds_read_b32 v82, v73 offset:16640
  ds_read_b32 v83, v73 offset:16768
  ds_read_b32 v84, v73 offset:16896
  ds_read_b32 v85, v73 offset:17024
  ds_read_b32 v86, v73 offset:17152
  ds_read_b32 v87, v73 offset:17280
  s_waitcnt lgkmcnt(0)
  v_add_f32 v80, v80, v81
  v_add_f32 v80, v80, v82
  v_add_f32 v80, v80, v83
  v_add_f32 v80, v80, v84
  v_add_f32 v80, v80, v85
  v_add_f32 v80, v80, v86
  v_add_f32 v80, v80, v87
  v_mov_b32 v81, v80
  s_nop 1
  v_permlane32_swap_b32 v80, v81
  v_add_f32 v80, v80, v81
  v_cvt_pk_bf16_f32 v80, v80, v80
  v_lshlrev_b32 v80, 16, v80
  s_lshl_b32 s36, s49, 7
  s_add_u32 s36, s36, 70647808
  s_cmp_lt_u32 s49, 96
  s_cselect_b32 s36, s36, 0x80000000
  v_add_u32 v72, s36, v72
  s_mov_b32 exec_hi, 0
  buffer_store_dword v80, v72, s[4:7], 0 offen sc1
  s_mov_b64 exec, -1
  s_waitcnt vmcnt(0)
XR_M1:
  s_cmp_lg_u32 s17, 0
  s_cbranch_scc1 XR_AR
  v_mov_b32 v72, 1
  s_mov_b64 exec, 1
  s_cmp_gt_u32 s19, 4
  s_cselect_b32 s99, 8, 4
  s_lshl_b32 s98, s99, 4
  s_add_u32 s98, s98, 64
  s_cmp_eq_u32 s19, 4
  s_cselect_b32 s98, 0, s98
  s_cselect_b32 s99, 0, s99
  s_cselect_b32 s97, 31, 95
  v_mov_b32 v73, s3
  buffer_atomic_add v72, v73, s[8:11], s98 offen sc0 sc1
  s_waitcnt vmcnt(0)
  v_readfirstlane_b32 s98, v72
  v_mov_b32 v72, 32
  s_cmp_lg_u32 s98, s97
  s_cbranch_scc1 XR_ARN
  buffer_store_dword v72, v73, s[8:11], s99 offen offset:64 sc1
XR_ARN:
  s_mov_b64 exec, -1
XR_AR:
  s_waitcnt lgkmcnt(0)
  v_add_f32 v64, v64, v66
  v_add_f32 v68, v68, v70
  v_add_f32 v65, v65, v67
  v_add_f32 v69, v69, v71
  v_add_f32 v64, v64, v68
  v_add_f32 v65, v65, v69
  v_mul_f32 v64, 0x3b000000, v64
  v_mul_f32 v65, 0x3b000000, v65
  v_fma_f32 v65, -v64, v64, v65
  v_max_f32 v65, 0, v65
  v_add_f32 v65, 0x3727c5ac, v65
  v_rsq_f32 v65, v65
  v_sub_f32 v160, v160, v64
  v_sub_f32 v161, v161, v64
  v_sub_f32 v162, v162, v64
  v_sub_f32 v163, v163, v64
  v_sub_f32 v164, v164, v64
  v_sub_f32 v165, v165, v64
  v_sub_f32 v166, v166, v64
  v_sub_f32 v167, v167, v64
  v_sub_f32 v168, v168, v64
  v_sub_f32 v169, v169, v64
  v_sub_f32 v170, v170, v64
  v_sub_f32 v171, v171, v64
  v_sub_f32 v172, v172, v64
  v_sub_f32 v173, v173, v64
  v_sub_f32 v174, v174, v64
  v_sub_f32 v175, v175, v64
  v_sub_f32 v176, v176, v64
  v_sub_f32 v177, v177, v64
  v_sub_f32 v178, v178, v64
  v_sub_f32 v179, v179, v64
  v_sub_f32 v180, v180, v64
  v_sub_f32 v181, v181, v64
  v_sub_f32 v182, v182, v64
  v_sub_f32 v183, v183, v64
  v_sub_f32 v184, v184, v64
  v_sub_f32 v185, v185, v64
  v_sub_f32 v186, v186, v64
  v_sub_f32 v187, v187, v64
  v_sub_f32 v188, v188, v64
  v_sub_f32 v189, v189, v64
  v_sub_f32 v190, v190, v64
  v_sub_f32 v191, v191, v64
  v_mul_f32 v160, v160, v65
  v_mul_f32 v161, v161, v65
  v_mul_f32 v162, v162, v65
  v_mul_f32 v163, v163, v65
  v_mul_f32 v164, v164, v65
  v_mul_f32 v165, v165, v65
  v_mul_f32 v166, v166, v65
  v_mul_f32 v167, v167, v65
  v_mul_f32 v168, v168, v65
  v_mul_f32 v169, v169, v65
  v_mul_f32 v170, v170, v65
  v_mul_f32 v171, v171, v65
  v_mul_f32 v172, v172, v65
  v_mul_f32 v173, v173, v65
  v_mul_f32 v174, v174, v65
  v_mul_f32 v175, v175, v65
  v_mul_f32 v176, v176, v65
  v_mul_f32 v177, v177, v65
  v_mul_f32 v178, v178, v65
  v_mul_f32 v179, v179, v65
  v_mul_f32 v180, v180, v65
  v_mul_f32 v181, v181, v65
  v_mul_f32 v182, v182, v65
  v_mul_f32 v183, v183, v65
  v_mul_f32 v184, v184, v65
  v_mul_f32 v185, v185, v65
  v_mul_f32 v186, v186, v65
  v_mul_f32 v187, v187, v65
  v_mul_f32 v188, v188, v65
  v_mul_f32 v189, v189, v65
  v_mul_f32 v190, v190, v65
  v_mul_f32 v191, v191, v65
  s_cmp_lg_u32 s17, 0
  s_cbranch_scc1 XR_BPB
  v_mbcnt_lo_u32_b32 v73, -1, 0
  v_lshlrev_b32 v72, 2, v73
  v_add_u32 v72, s3, v72
  s_mov_b32 s99, 0
  s_mov_b64 exec, 15
XR_BP:
  buffer_load_dword v73, v72, s[8:11], 0 offen offset:64 sc1
  s_add_u32 s99, s99, 1
  s_cmp_gt_u32 s99, 0x20000
  s_cbranch_scc1 KEND
  s_waitcnt vmcnt(0)
  v_cmp_lt_u32 vcc, 0xffff, v73
  s_mov_b32 s98, 0
  s_cbranch_vccnz XR_BPX
  v_cmp_eq_u32 vcc, 32, v73
  s_and_b32 s97, vcc_lo, 1
  s_mov_b32 s98, 1
  s_cmp_eq_u32 s97, 1
  s_cbranch_scc1 XR_BPX
  s_sleep 4
  s_branch XR_BP
XR_BPX:
  s_mov_b64 exec, -1
  v_mov_b32 v72, 57344
  v_mov_b32 v73, s98
  ds_write_b32 v72, v73
  s_waitcnt lgkmcnt(0)
XR_BPB:
  s_barrier
  v_mov_b32 v72, 57344
  ds_read_b32 v73, v72
  s_waitcnt lgkmcnt(0)
  v_readfirstlane_b32 s98, v73
  s_cmp_eq_u32 s98, 0
  s_cbranch_scc1 FALLBACK
  s_lshl_b32 s36, s17, 9
  s_add_u32 s36, s36, 70647808
  v_lshlrev_b32 v63, 5, v62
  v_add_u32 v63, s36, v63
  v_and_b32 v64, 1, v62
  v_lshlrev_b32 v64, 4, v64
  v_lshl_add_u32 v64, v61, 5, v64
  v_add_u32 v58, s36, v64
  buffer_load_dwordx4 v[192:195], v63, s[4:7], 0 offen offset:0 sc1
  buffer_load_dwordx4 v[224:227], v63, s[4:7], 0 offen offset:2048 sc1
  buffer_load_dwordx4 v[196:199], v63, s[4:7], 0 offen offset:16 sc1
  buffer_load_dwordx4 v[228:231], v63, s[4:7], 0 offen offset:2064 sc1
  buffer_load_dwordx4 v[200:203], v63, s[4:7], 0 offen offset:128 sc1
  buffer_load_dwordx4 v[232:235], v63, s[4:7], 0 offen offset:2176 sc1
  buffer_load_dwordx4 v[204:207], v63, s[4:7], 0 offen offset:144 sc1
  buffer_load_dwordx4 v[236:239], v63, s[4:7], 0 offen offset:2192 sc1
  buffer_load_dwordx4 v[208:211], v63, s[4:7], 0 offen offset:256 sc1
  buffer_load_dwordx4 v[240:243], v63, s[4:7], 0 offen offset:2304 sc1
  buffer_load_dwordx4 v[212:215], v63, s[4:7], 0 offen offset:272 sc1
  buffer_load_dwordx4 v[244:247], v63, s[4:7], 0 offen offset:2320 sc1
  buffer_load_dwordx4 v[216:219], v63, s[4:7], 0 offen offset:384 sc1
  buffer_load_dwordx4 v[248:251], v63, s[4:7], 0 offen offset:2432 sc1
  buffer_load_dwordx4 v[220:223], v63, s[4:7], 0 offen offset:400 sc1
  buffer_load_dwordx4 v[252:255], v63, s[4:7], 0 offen offset:2448 sc1
  s_lshr_b32 s36, s49, 1
  s_lshl_b32 s36, s36, 15
  s_and_b32 s37, s49, 1
  s_lshl_b32 s37, s37, 10
  s_add_u32 s36, s36, s37
  s_lshl_b32 s37, s17, 13
  s_add_u32 s36, s36, s37
  v_add_u32 v63, s36, v1
  s_movk_i32 s36, 0x1000
  s_waitcnt vmcnt(12)
  v_add_f32 v224, 1.0, v224
  v_fma_f32 v160, v160, v224, v192
  v_add_f32 v225, 1.0, v225
  v_fma_f32 v161, v161, v225, v193
  v_add_f32 v226, 1.0, v226
  v_fma_f32 v162, v162, v226, v194
  v_add_f32 v227, 1.0, v227
  v_fma_f32 v163, v163, v227, v195
  v_add_f32 v228, 1.0, v228
  v_fma_f32 v164, v164, v228, v196
  v_add_f32 v229, 1.0, v229
  v_fma_f32 v165, v165, v229, v197
  v_add_f32 v230, 1.0, v230
  v_fma_f32 v166, v166, v230, v198
  v_add_f32 v231, 1.0, v231
  v_fma_f32 v167, v167, v231, v199
  v_cvt_pk_bf16_f32 v112, v160, v161
  v_cvt_pk_bf16_f32 v113, v162, v163
  v_cvt_pk_bf16_f32 v114, v164, v165
  v_cvt_pk_bf16_f32 v115, v166, v167
  buffer_store_dwordx4 v[112:115], v63, s[4:7], 0 offen offset:0 sc1
  s_waitcnt vmcnt(9)
  v_add_f32 v232, 1.0, v232
  v_fma_f32 v168, v168, v232, v200
  v_add_f32 v233, 1.0, v233
  v_fma_f32 v169, v169, v233, v201
  v_add_f32 v234, 1.0, v234
  v_fma_f32 v170, v170, v234, v202
  v_add_f32 v235, 1.0, v235
  v_fma_f32 v171, v171, v235, v203
  v_add_f32 v236, 1.0, v236
  v_fma_f32 v172, v172, v236, v204
  v_add_f32 v237, 1.0, v237
  v_fma_f32 v173, v173, v237, v205
  v_add_f32 v238, 1.0, v238
  v_fma_f32 v174, v174, v238, v206
  v_add_f32 v239, 1.0, v239
  v_fma_f32 v175, v175, v239, v207
  v_cvt_pk_bf16_f32 v116, v168, v169
  v_cvt_pk_bf16_f32 v117, v170, v171
  v_cvt_pk_bf16_f32 v118, v172, v173
  v_cvt_pk_bf16_f32 v119, v174, v175
  buffer_store_dwordx4 v[116:119], v63, s[4:7], 0 offen offset:2048 sc1
  s_waitcnt vmcnt(6)
  v_add_f32 v240, 1.0, v240
  v_fma_f32 v176, v176, v240, v208
  v_add_f32 v241, 1.0, v241
  v_fma_f32 v177, v177, v241, v209
  v_add_f32 v242, 1.0, v242
  v_fma_f32 v178, v178, v242, v210
  v_add_f32 v243, 1.0, v243
  v_fma_f32 v179, v179, v243, v211
  v_add_f32 v244, 1.0, v244
  v_fma_f32 v180, v180, v244, v212
  v_add_f32 v245, 1.0, v245
  v_fma_f32 v181, v181, v245, v213
  v_add_f32 v246, 1.0, v246
  v_fma_f32 v182, v182, v246, v214
  v_add_f32 v247, 1.0, v247
  v_fma_f32 v183, v183, v247, v215
  v_cvt_pk_bf16_f32 v120, v176, v177
  v_cvt_pk_bf16_f32 v121, v178, v179
  v_cvt_pk_bf16_f32 v122, v180, v181
  v_cvt_pk_bf16_f32 v123, v182, v183
  buffer_store_dwordx4 v[120:123], v63, s[4:7], s36 offen offset:0 sc1
  s_waitcnt vmcnt(3)
  v_add_f32 v248, 1.0, v248
  v_fma_f32 v184, v184, v248, v216
  v_add_f32 v249, 1.0, v249
  v_fma_f32 v185, v185, v249, v217
  v_add_f32 v250, 1.0, v250
  v_fma_f32 v186, v186, v250, v218
  v_add_f32 v251, 1.0, v251
  v_fma_f32 v187, v187, v251, v219
  v_add_f32 v252, 1.0, v252
  v_fma_f32 v188, v188, v252, v220
  v_add_f32 v253, 1.0, v253
  v_fma_f32 v189, v189, v253, v221
  v_add_f32 v254, 1.0, v254
  v_fma_f32 v190, v190, v254, v222
  v_add_f32 v255, 1.0, v255
  v_fma_f32 v191, v191, v255, v223
  v_cvt_pk_bf16_f32 v124, v184, v185
  v_cvt_pk_bf16_f32 v125, v186, v187
  v_cvt_pk_bf16_f32 v126, v188, v189
  v_cvt_pk_bf16_f32 v127, v190, v191
  buffer_store_dwordx4 v[124:127], v63, s[4:7], s36 offen offset:2048 sc1
  s_load_dwordx2 s[12:13], s[0:1], 40
  s_load_dwordx4 s[28:31], s[0:1], 64
  s_waitcnt vmcnt(0)
  s_barrier
  v_mov_b32 v72, 1
  buffer_store_dword v72, v59, s[4:7], 0 offen sc1
  s_waitcnt lgkmcnt(0)
  s_mov_b32 s14, 0x400000
  s_mov_b32 s32, s30
  s_mov_b32 s33, s31
  s_mov_b32 s34, 1409024
  s_mov_b32 s30, 1409024
  s_mov_b32 s31, 0x00020000
  s_lshl_b32 s36, s17, 8
  v_lshlrev_b32 v63, 4, v61
  v_add_u32 v63, s36, v63
  s_lshl_b32 s36, s16, 17
  v_lshl_add_u32 v64, v62, 12, v63
  v_add_u32 v64, s36, v64
  s_lshl_b32 s36, s16, 16
  v_lshl_add_u32 v65, v62, 14, v63
  v_add_u32 v65, s36, v65
  s_mul_i32 s36, s17, 352256
  s_lshl_b32 s37, s16, 7
  v_lshl_add_u32 v66, v61, 3, s37
  v_cmp_gt_u32 vcc, 2752, v66
  v_mul_u32_u24 v67, 22016, v62
  v_add3_u32 v66, v66, v67, s36
  v_mov_b32 v67, 0x80000000
  v_cndmask_b32 v66, v67, v66, vcc
  s_mov_b32 s50, 0x05040100
  s_mov_b32 s51, 0x07060302
  s_mov_b32 s36, 0
  buffer_load_dwordx4 v[128:131], v64, s[12:15], s36 offen offset:0
  buffer_load_dwordx4 v[132:135], v64, s[12:15], s36 offen offset:1024
  buffer_load_dwordx4 v[136:139], v64, s[12:15], s36 offen offset:2048
  buffer_load_dwordx4 v[140:143], v64, s[12:15], s36 offen offset:3072
  s_mov_b32 s36, 16384
  buffer_load_dwordx4 v[144:147], v64, s[12:15], s36 offen offset:0
  buffer_load_dwordx4 v[148:151], v64, s[12:15], s36 offen offset:1024
  buffer_load_dwordx4 v[152:155], v64, s[12:15], s36 offen offset:2048
  buffer_load_dwordx4 v[156:159], v64, s[12:15], s36 offen offset:3072
  s_mov_b32 s36, 32768
  buffer_load_dwordx4 v[160:163], v64, s[12:15], s36 offen offset:0
  buffer_load_dwordx4 v[164:167], v64, s[12:15], s36 offen offset:1024
  buffer_load_dwordx4 v[168:171], v64, s[12:15], s36 offen offset:2048
  buffer_load_dwordx4 v[172:175], v64, s[12:15], s36 offen offset:3072
  s_mov_b32 s36, 49152
  buffer_load_dwordx4 v[176:179], v64, s[12:15], s36 offen offset:0
  buffer_load_dwordx4 v[180:183], v64, s[12:15], s36 offen offset:1024
  buffer_load_dwordx4 v[184:187], v64, s[12:15], s36 offen offset:2048
  buffer_load_dwordx4 v[188:191], v64, s[12:15], s36 offen offset:3072
  s_mov_b32 s36, 65536
  buffer_load_dwordx4 v[192:195], v64, s[12:15], s36 offen offset:0
  buffer_load_dwordx4 v[196:199], v64, s[12:15], s36 offen offset:1024
  buffer_load_dwordx4 v[200:203], v64, s[12:15], s36 offen offset:2048
  buffer_load_dwordx4 v[204:207], v64, s[12:15], s36 offen offset:3072
  s_mov_b32 s36, 81920
  buffer_load_dwordx4 v[208:211], v64, s[12:15], s36 offen offset:0
  buffer_load_dwordx4 v[212:215], v64, s[12:15], s36 offen offset:1024
  buffer_load_dwordx4 v[216:219], v64, s[12:15], s36 offen offset:2048
  buffer_load_dwordx4 v[220:223], v64, s[12:15], s36 offen offset:3072
  s_mov_b32 s36, 98304
  buffer_load_dwordx4 v[224:227], v64, s[12:15], s36 offen offset:0
  buffer_load_dwordx4 v[228:231], v64, s[12:15], s36 offen offset:1024
  buffer_load_dwordx4 v[232:235], v64, s[12:15], s36 offen offset:2048
  buffer_load_dwordx4 v[236:239], v64, s[12:15], s36 offen offset:3072
  s_mov_b32 s36, 114688
  buffer_load_dwordx4 v[240:243], v64, s[12:15], s36 offen offset:0
  buffer_load_dwordx4 v[244:247], v64, s[12:15], s36 offen offset:1024
  buffer_load_dwordx4 v[248:251], v64, s[12:15], s36 offen offset:2048
  buffer_load_dwordx4 v[252:255], v64, s[12:15], s36 offen offset:3072
  s_waitcnt vmcnt(24)
  v_perm_b32 v68, v132, v128, s50
  v_accvgpr_write_b32 a0, v68
  v_perm_b32 v69, v140, v136, s50
  v_accvgpr_write_b32 a1, v69
  v_perm_b32 v70, v148, v144, s50
  v_accvgpr_write_b32 a2, v70
  v_perm_b32 v71, v156, v152, s50
  v_accvgpr_write_b32 a3, v71
  v_perm_b32 v68, v132, v128, s51
  v_accvgpr_write_b32 a4, v68
  v_perm_b32 v69, v140, v136, s51
  v_accvgpr_write_b32 a5, v69
  v_perm_b32 v70, v148, v144, s51
  v_accvgpr_write_b32 a6, v70
  v_perm_b32 v71, v156, v152, s51
  v_accvgpr_write_b32 a7, v71
  v_perm_b32 v68, v133, v129, s50
  v_accvgpr_write_b32 a8, v68
  v_perm_b32 v69, v141, v137, s50
  v_accvgpr_write_b32 a9, v69
  v_perm_b32 v70, v149, v145, s50
  v_accvgpr_write_b32 a10, v70
  v_perm_b32 v71, v157, v153, s50
  v_accvgpr_write_b32 a11, v71
  v_perm_b32 v68, v133, v129, s51
  v_accvgpr_write_b32 a12, v68
  v_perm_b32 v69, v141, v137, s51
  v_accvgpr_write_b32 a13, v69
  v_perm_b32 v70, v149, v145, s51
  v_accvgpr_write_b32 a14, v70
  v_perm_b32 v71, v157, v153, s51
  v_accvgpr_write_b32 a15, v71
  v_perm_b32 v68, v134, v130, s50
  v_accvgpr_write_b32 a16, v68
  v_perm_b32 v69, v142, v138, s50
  v_accvgpr_write_b32 a17, v69
  v_perm_b32 v70, v150, v146, s50
  v_accvgpr_write_b32 a18, v70
  v_perm_b32 v71, v158, v154, s50
  v_accvgpr_write_b32 a19, v71
  v_perm_b32 v68, v134, v130, s51
  v_accvgpr_write_b32 a20, v68
  v_perm_b32 v69, v142, v138, s51
  v_accvgpr_write_b32 a21, v69
  v_perm_b32 v70, v150, v146, s51
  v_accvgpr_write_b32 a22, v70
  v_perm_b32 v71, v158, v154, s51
  v_accvgpr_write_b32 a23, v71
  v_perm_b32 v68, v135, v131, s50
  v_accvgpr_write_b32 a24, v68
  v_perm_b32 v69, v143, v139, s50
  v_accvgpr_write_b32 a25, v69
  v_perm_b32 v70, v151, v147, s50
  v_accvgpr_write_b32 a26, v70
  v_perm_b32 v71, v159, v155, s50
  v_accvgpr_write_b32 a27, v71
  v_perm_b32 v68, v135, v131, s51
  v_accvgpr_write_b32 a28, v68
  v_perm_b32 v69, v143, v139, s51
  v_accvgpr_write_b32 a29, v69
  v_perm_b32 v70, v151, v147, s51
  v_accvgpr_write_b32 a30, v70
  v_perm_b32 v71, v159, v155, s51
  v_accvgpr_write_b32 a31, v71
  s_waitcnt vmcnt(16)
  v_perm_b32 v68, v164, v160, s50
  v_accvgpr_write_b32 a32, v68
  v_perm_b32 v69, v172, v168, s50
  v_accvgpr_write_b32 a33, v69
  v_perm_b32 v70, v180, v176, s50
  v_accvgpr_write_b32 a34, v70
  v_perm_b32 v71, v188, v184, s50
  v_accvgpr_write_b32 a35, v71
  v_perm_b32 v68, v164, v160, s51
  v_accvgpr_write_b32 a36, v68
  v_perm_b32 v69, v172, v168, s51
  v_accvgpr_write_b32 a37, v69
  v_perm_b32 v70, v180, v176, s51
  v_accvgpr_write_b32 a38, v70
  v_perm_b32 v71, v188, v184, s51
  v_accvgpr_write_b32 a39, v71
  v_perm_b32 v68, v165, v161, s50
  v_accvgpr_write_b32 a40, v68
  v_perm_b32 v69, v173, v169, s50
  v_accvgpr_write_b32 a41, v69
  v_perm_b32 v70, v181, v177, s50
  v_accvgpr_write_b32 a42, v70
  v_perm_b32 v71, v189, v185, s50
  v_accvgpr_write_b32 a43, v71
  v_perm_b32 v68, v165, v161, s51
  v_accvgpr_write_b32 a44, v68
  v_perm_b32 v69, v173, v169, s51
  v_accvgpr_write_b32 a45, v69
  v_perm_b32 v70, v181, v177, s51
  v_accvgpr_write_b32 a46, v70
  v_perm_b32 v71, v189, v185, s51
  v_accvgpr_write_b32 a47, v71
  v_perm_b32 v68, v166, v162, s50
  v_accvgpr_write_b32 a48, v68
  v_perm_b32 v69, v174, v170, s50
  v_accvgpr_write_b32 a49, v69
  v_perm_b32 v70, v182, v178, s50
  v_accvgpr_write_b32 a50, v70
  v_perm_b32 v71, v190, v186, s50
  v_accvgpr_write_b32 a51, v71
  v_perm_b32 v68, v166, v162, s51
  v_accvgpr_write_b32 a52, v68
  v_perm_b32 v69, v174, v170, s51
  v_accvgpr_write_b32 a53, v69
  v_perm_b32 v70, v182, v178, s51
  v_accvgpr_write_b32 a54, v70
  v_perm_b32 v71, v190, v186, s51
  v_accvgpr_write_b32 a55, v71
  v_perm_b32 v68, v167, v163, s50
  v_accvgpr_write_b32 a56, v68
  v_perm_b32 v69, v175, v171, s50
  v_accvgpr_write_b32 a57, v69
  v_perm_b32 v70, v183, v179, s50
  v_accvgpr_write_b32 a58, v70
  v_perm_b32 v71, v191, v187, s50
  v_accvgpr_write_b32 a59, v71
  v_perm_b32 v68, v167, v163, s51
  v_accvgpr_write_b32 a60, v68
  v_perm_b32 v69, v175, v171, s51
  v_accvgpr_write_b32 a61, v69
  v_perm_b32 v70, v183, v179, s51
  v_accvgpr_write_b32 a62, v70
  v_perm_b32 v71, v191, v187, s51
  v_accvgpr_write_b32 a63, v71
  s_waitcnt vmcnt(8)
  v_perm_b32 v68, v196, v192, s50
  v_accvgpr_write_b32 a64, v68
  v_perm_b32 v69, v204, v200, s50
  v_accvgpr_write_b32 a65, v69
  v_perm_b32 v70, v212, v208, s50
  v_accvgpr_write_b32 a66, v70
  v_perm_b32 v71, v220, v216, s50
  v_accvgpr_write_b32 a67, v71
  v_perm_b32 v68, v196, v192, s51
  v_accvgpr_write_b32 a68, v68
  v_perm_b32 v69, v204, v200, s51
  v_accvgpr_write_b32 a69, v69
  v_perm_b32 v70, v212, v208, s51
  v_accvgpr_write_b32 a70, v70
  v_perm_b32 v71, v220, v216, s51
  v_accvgpr_write_b32 a71, v71
  v_perm_b32 v68, v197, v193, s50
  v_accvgpr_write_b32 a72, v68
  v_perm_b32 v69, v205, v201, s50
  v_accvgpr_write_b32 a73, v69
  v_perm_b32 v70, v213, v209, s50
  v_accvgpr_write_b32 a74, v70
  v_perm_b32 v71, v221, v217, s50
  v_accvgpr_write_b32 a75, v71
  v_perm_b32 v68, v197, v193, s51
  v_accvgpr_write_b32 a76, v68
  v_perm_b32 v69, v205, v201, s51
  v_accvgpr_write_b32 a77, v69
  v_perm_b32 v70, v213, v209, s51
  v_accvgpr_write_b32 a78, v70
  v_perm_b32 v71, v221, v217, s51
  v_accvgpr_write_b32 a79, v71
  v_perm_b32 v68, v198, v194, s50
  v_accvgpr_write_b32 a80, v68
  v_perm_b32 v69, v206, v202, s50
  v_accvgpr_write_b32 a81, v69
  v_perm_b32 v70, v214, v210, s50
  v_accvgpr_write_b32 a82, v70
  v_perm_b32 v71, v222, v218, s50
  v_accvgpr_write_b32 a83, v71
  v_perm_b32 v68, v198, v194, s51
  v_accvgpr_write_b32 a84, v68
  v_perm_b32 v69, v206, v202, s51
  v_accvgpr_write_b32 a85, v69
  v_perm_b32 v70, v214, v210, s51
  v_accvgpr_write_b32 a86, v70
  v_perm_b32 v71, v222, v218, s51
  v_accvgpr_write_b32 a87, v71
  v_perm_b32 v68, v199, v195, s50
  v_accvgpr_write_b32 a88, v68
  v_perm_b32 v69, v207, v203, s50
  v_accvgpr_write_b32 a89, v69
  v_perm_b32 v70, v215, v211, s50
  v_accvgpr_write_b32 a90, v70
  v_perm_b32 v71, v223, v219, s50
  v_accvgpr_write_b32 a91, v71
  v_perm_b32 v68, v199, v195, s51
  v_accvgpr_write_b32 a92, v68
  v_perm_b32 v69, v207, v203, s51
  v_accvgpr_write_b32 a93, v69
  v_perm_b32 v70, v215, v211, s51
  v_accvgpr_write_b32 a94, v70
  v_perm_b32 v71, v223, v219, s51
  v_accvgpr_write_b32 a95, v71
  s_waitcnt vmcnt(0)
  v_perm_b32 v68, v228, v224, s50
  v_accvgpr_write_b32 a96, v68
  v_perm_b32 v69, v236, v232, s50
  v_accvgpr_write_b32 a97, v69
  v_perm_b32 v70, v244, v240, s50
  v_accvgpr_write_b32 a98, v70
  v_perm_b32 v71, v252, v248, s50
  v_accvgpr_write_b32 a99, v71
  v_perm_b32 v68, v228, v224, s51
  v_accvgpr_write_b32 a100, v68
  v_perm_b32 v69, v236, v232, s51
  v_accvgpr_write_b32 a101, v69
  v_perm_b32 v70, v244, v240, s51
  v_accvgpr_write_b32 a102, v70
  v_perm_b32 v71, v252, v248, s51
  v_accvgpr_write_b32 a103, v71
  v_perm_b32 v68, v229, v225, s50
  v_accvgpr_write_b32 a104, v68
  v_perm_b32 v69, v237, v233, s50
  v_accvgpr_write_b32 a105, v69
  v_perm_b32 v70, v245, v241, s50
  v_accvgpr_write_b32 a106, v70
  v_perm_b32 v71, v253, v249, s50
  v_accvgpr_write_b32 a107, v71
  v_perm_b32 v68, v229, v225, s51
  v_accvgpr_write_b32 a108, v68
  v_perm_b32 v69, v237, v233, s51
  v_accvgpr_write_b32 a109, v69
  v_perm_b32 v70, v245, v241, s51
  v_accvgpr_write_b32 a110, v70
  v_perm_b32 v71, v253, v249, s51
  v_accvgpr_write_b32 a111, v71
  v_perm_b32 v68, v230, v226, s50
  v_accvgpr_write_b32 a112, v68
  v_perm_b32 v69, v238, v234, s50
  v_accvgpr_write_b32 a113, v69
  v_perm_b32 v70, v246, v242, s50
  v_accvgpr_write_b32 a114, v70
  v_perm_b32 v71, v254, v250, s50
  v_accvgpr_write_b32 a115, v71
  v_perm_b32 v68, v230, v226, s51
  v_accvgpr_write_b32 a116, v68
  v_perm_b32 v69, v238, v234, s51
  v_accvgpr_write_b32 a117, v69
  v_perm_b32 v70, v246, v242, s51
  v_accvgpr_write_b32 a118, v70
  v_perm_b32 v71, v254, v250, s51
  v_accvgpr_write_b32 a119, v71
  v_perm_b32 v68, v231, v227, s50
  v_accvgpr_write_b32 a120, v68
  v_perm_b32 v69, v239, v235, s50
  v_accvgpr_write_b32 a121, v69
  v_perm_b32 v70, v247, v243, s50
  v_accvgpr_write_b32 a122, v70
  v_perm_b32 v71, v255, v251, s50
  v_accvgpr_write_b32 a123, v71
  v_perm_b32 v68, v231, v227, s51
  v_accvgpr_write_b32 a124, v68
  v_perm_b32 v69, v239, v235, s51
  v_accvgpr_write_b32 a125, v69
  v_perm_b32 v70, v247, v243, s51
  v_accvgpr_write_b32 a126, v70
  v_perm_b32 v71, v255, v251, s51
  v_accvgpr_write_b32 a127, v71
  s_mov_b32 s36, 0
  buffer_load_dwordx2 v[128:129], v66, s[28:31], s36 offen
  s_mov_b32 s36, 2752
  buffer_load_dwordx2 v[130:131], v66, s[28:31], s36 offen
  s_mov_b32 s36, 5504
  buffer_load_dwordx2 v[132:133], v66, s[28:31], s36 offen
  s_mov_b32 s36, 8256
  buffer_load_dwordx2 v[134:135], v66, s[28:31], s36 offen
  s_mov_b32 s36, 11008
  buffer_load_dwordx2 v[136:137], v66, s[28:31], s36 offen
  s_mov_b32 s36, 13760
  buffer_load_dwordx2 v[138:139], v66, s[28:31], s36 offen
  s_mov_b32 s36, 16512
  buffer_load_dwordx2 v[140:141], v66, s[28:31], s36 offen
  s_mov_b32 s36, 19264
  buffer_load_dwordx2 v[142:143], v66, s[28:31], s36 offen
  s_mov_b32 s36, 88064
  buffer_load_dwordx2 v[144:145], v66, s[28:31], s36 offen
  s_mov_b32 s36, 90816
  buffer_load_dwordx2 v[146:147], v66, s[28:31], s36 offen
  s_mov_b32 s36, 93568
  buffer_load_dwordx2 v[148:149], v66, s[28:31], s36 offen
  s_mov_b32 s36, 96320
  buffer_load_dwordx2 v[150:151], v66, s[28:31], s36 offen
  s_mov_b32 s36, 99072
  buffer_load_dwordx2 v[152:153], v66, s[28:31], s36 offen
  s_mov_b32 s36, 101824
  buffer_load_dwordx2 v[154:155], v66, s[28:31], s36 offen
  s_mov_b32 s36, 104576
  buffer_load_dwordx2 v[156:157], v66, s[28:31], s36 offen
  s_mov_b32 s36, 107328
  buffer_load_dwordx2 v[158:159], v66, s[28:31], s36 offen
  s_mov_b32 s36, 176128
  buffer_load_dwordx2 v[160:161], v66, s[28:31], s36 offen
  s_mov_b32 s36, 178880
  buffer_load_dwordx2 v[162:163], v66, s[28:31], s36 offen
  s_mov_b32 s36, 181632
  buffer_load_dwordx2 v[164:165], v66, s[28:31], s36 offen
  s_mov_b32 s36, 184384
  buffer_load_dwordx2 v[166:167], v66, s[28:31], s36 offen
  s_mov_b32 s36, 187136
  buffer_load_dwordx2 v[168:169], v66, s[28:31], s36 offen
  s_mov_b32 s36, 189888
  buffer_load_dwordx2 v[170:171], v66, s[28:31], s36 offen
  s_mov_b32 s36, 192640
  buffer_load_dwordx2 v[172:173], v66, s[28:31], s36 offen
  s_mov_b32 s36, 195392
  buffer_load_dwordx2 v[174:175], v66, s[28:31], s36 offen
  s_mov_b32 s36, 264192
  buffer_load_dwordx2 v[176:177], v66, s[28:31], s36 offen
  s_mov_b32 s36, 266944
  buffer_load_dwordx2 v[178:179], v66, s[28:31], s36 offen
  s_mov_b32 s36, 269696
  buffer_load_dwordx2 v[180:181], v66, s[28:31], s36 offen
  s_mov_b32 s36, 272448
  buffer_load_dwordx2 v[182:183], v66, s[28:31], s36 offen
  s_mov_b32 s36, 275200
  buffer_load_dwordx2 v[184:185], v66, s[28:31], s36 offen
  s_mov_b32 s36, 277952
  buffer_load_dwordx2 v[186:187], v66, s[28:31], s36 offen
  s_mov_b32 s36, 280704
  buffer_load_dwordx2 v[188:189], v66, s[28:31], s36 offen
  s_mov_b32 s36, 283456
  buffer_load_dwordx2 v[190:191], v66, s[28:31], s36 offen
  s_mov_b32 s36, 0
  buffer_load_dwordx4 v[192:195], v65, s[32:35], s36 offen offset:0
  buffer_load_dwordx4 v[196:199], v65, s[32:35], s36 offen offset:1024
  buffer_load_dwordx4 v[200:203], v65, s[32:35], s36 offen offset:2048
  buffer_load_dwordx4 v[204:207], v65, s[32:35], s36 offen offset:3072
  s_mov_b32 s36, 4096
  buffer_load_dwordx4 v[208:211], v65, s[32:35], s36 offen offset:0
  buffer_load_dwordx4 v[212:215], v65, s[32:35], s36 offen offset:1024
  buffer_load_dwordx4 v[216:219], v65, s[32:35], s36 offen offset:2048
  buffer_load_dwordx4 v[220:223], v65, s[32:35], s36 offen offset:3072
  s_mov_b32 s36, 8192
  buffer_load_dwordx4 v[224:227], v65, s[32:35], s36 offen offset:0
  buffer_load_dwordx4 v[228:231], v65, s[32:35], s36 offen offset:1024
  buffer_load_dwordx4 v[232:235], v65, s[32:35], s36 offen offset:2048
  buffer_load_dwordx4 v[236:239], v65, s[32:35], s36 offen offset:3072
  s_mov_b32 s36, 12288
  buffer_load_dwordx4 v[240:243], v65, s[32:35], s36 offen offset:0
  buffer_load_dwordx4 v[244:247], v65, s[32:35], s36 offen offset:1024
  buffer_load_dwordx4 v[248:251], v65, s[32:35], s36 offen offset:2048
  buffer_load_dwordx4 v[252:255], v65, s[32:35], s36 offen offset:3072
  v_lshrrev_b32 v64, 2, v60
  v_and_b32 v65, 3, v60
  v_cmp_lt_u32 vcc, 3, v60
  s_nop 1
  v_cndmask_b32 v65, 0, v65, vcc
  v_lshlrev_b32 v65, 2, v65
  v_lshl_add_u32 v65, v64, 12, v65
  s_lshl_b32 s36, s16, 7
  s_add_u32 s36, s36, 70582272
  v_add_u32 v65, s36, v65
  v_mov_b32 v67, 0x80000000
  v_cmp_gt_u32 vcc, 16, v60
  s_nop 1
  v_cndmask_b32 v4, v67, v65, vcc
  s_lshl_b32 s36, s17, 13
  s_lshl_b32 s37, s16, 8
  s_add_u32 s37, s36, s37
  v_lshlrev_b32 v64, 17, v62
  v_lshl_add_u32 v64, v61, 4, v64
  v_add_u32 v6, s37, v64
  s_lshl_b32 s37, s16, 15
  s_add_u32 s37, s36, s37
  v_add_u32 v7, s37, v1
  v_add_u32 v13, s36, v1
  v_lshrrev_b32 v64, 2, v61
  v_lshlrev_b32 v64, 11, v64
  v_and_b32 v65, 3, v61
  v_lshl_add_u32 v64, v65, 8, v64
  v_lshl_add_u32 v64, v62, 3, v64
  s_lshr_b32 s37, s16, 4
  s_lshl_b32 s37, s37, 10
  s_add_u32 s36, s36, s37
  s_and_b32 s37, s16, 15
  s_lshl_b32 s37, s37, 4
  s_add_u32 s36, s36, s37
  v_add_u32 v64, s36, v64
  v_cmp_gt_u32 vcc, 32, v60
  s_nop 1
  v_cndmask_b32 v8, v67, v64, vcc
  v_and_b32 v64, 1, v62
  v_lshl_add_u32 v64, v64, 3, v63
  s_lshl_b32 s36, s16, 10
  v_add_u32 v9, s36, v64
  s_and_b32 s36, s17, 1
  s_lshr_b32 s37, s17, 1
  s_lshl_b32 s38, s36, 10
  v_add_u32 v10, s38, v1
  s_lshl_b32 s38, s37, 12
  v_add_u32 v11, s38, v1
  s_lshl_b32 s38, s36, 12
  s_lshl_b32 s39, s37, 11
  s_add_u32 s38, s38, s39
  v_add_u32 v12, s38, v1
  v_and_b32 v64, 1, v61
  v_lshlrev_b32 v64, 4, v64
  v_mov_b32 v65, 0x3f80
  v_lshlrev_b32 v64, v64, v65
  v_bfe_u32 v65, v61, 1, 2
  v_cmp_eq_u32 vcc, 0, v65
  s_nop 1
  v_cndmask_b32 v16, 0, v64, vcc
  v_cmp_eq_u32 vcc, 1, v65
  s_nop 1
  v_cndmask_b32 v17, 0, v64, vcc
  v_cmp_eq_u32 vcc, 2, v65
  s_nop 1
  v_cndmask_b32 v18, 0, v64, vcc
  v_cmp_eq_u32 vcc, 3, v65
  s_nop 1
  v_cndmask_b32 v19, 0, v64, vcc
  s_lshl_b32 s36, s36, 4
  v_lshlrev_b32 v64, 2, v62
  v_sub_u32 v64, v61, v64
  v_add_u32 v64, s36, v64
  v_mov_b32 v65, 0xf149f2ca
  v_cmp_gt_i32 vcc, 0, v64
  s_nop 1
  v_cndmask_b32 v20, 0, v65, vcc
  v_cmp_gt_i32 vcc, 1, v64
  s_nop 1
  v_cndmask_b32 v21, 0, v65, vcc
  v_cmp_gt_i32 vcc, 2, v64
  s_nop 1
  v_cndmask_b32 v22, 0, v65, vcc
  v_cmp_gt_i32 vcc, 3, v64
  s_nop 1
  v_cndmask_b32 v23, 0, v65, vcc
  v_cmp_gt_i32 vcc, 16, v64
  s_nop 1
  v_cndmask_b32 v24, 0, v65, vcc
  v_cmp_gt_i32 vcc, 17, v64
  s_nop 1
  v_cndmask_b32 v25, 0, v65, vcc
  v_cmp_gt_i32 vcc, 18, v64
  s_nop 1
  v_cndmask_b32 v26, 0, v65, vcc
  v_cmp_gt_i32 vcc, 19, v64
  s_nop 1
  v_cndmask_b32 v27, 0, v65, vcc
  s_add_u32 s36, s48, 1
  v_mov_b32 v64, s36
  v_cmp_lt_u32 vcc, 3, v60
  s_nop 1
  v_cndmask_b32 v5, 0, v64, vcc
  s_lshl_b32 s36, s48, 18
  s_lshl_b32 s37, s16, 13
  s_add_u32 s36, s36, s37
  s_add_u32 s40, s36, 52690944
  s_add_u32 s39, s36, 18874368
  s_add_u32 s38, s36, 2097152
  s_add_u32 s37, s36, 35651584
  s_lshl_b32 s41, s48, 15
  s_add_u32 s46, s41, 71303168
  s_lshl_b32 s44, s48, 21
  s_add_u32 s44, s44, 72351744
  s_add_u32 s45, s44, 1048576
  s_mov_b32 s42, 0x3e0293ee
  s_mov_b32 s36, 0
  s_waitcnt vmcnt(16)
  v_perm_b32 v68, v130, v128, s50
  v_accvgpr_write_b32 a128, v68
  v_perm_b32 v69, v134, v132, s50
  v_accvgpr_write_b32 a129, v69
  v_perm_b32 v70, v138, v136, s50
  v_accvgpr_write_b32 a130, v70
  v_perm_b32 v71, v142, v140, s50
  v_accvgpr_write_b32 a131, v71
  v_perm_b32 v68, v130, v128, s51
  v_accvgpr_write_b32 a132, v68
  v_perm_b32 v69, v134, v132, s51
  v_accvgpr_write_b32 a133, v69
  v_perm_b32 v70, v138, v136, s51
  v_accvgpr_write_b32 a134, v70
  v_perm_b32 v71, v142, v140, s51
  v_accvgpr_write_b32 a135, v71
  v_perm_b32 v68, v131, v129, s50
  v_accvgpr_write_b32 a136, v68
  v_perm_b32 v69, v135, v133, s50
  v_accvgpr_write_b32 a137, v69
  v_perm_b32 v70, v139, v137, s50
  v_accvgpr_write_b32 a138, v70
  v_perm_b32 v71, v143, v141, s50
  v_accvgpr_write_b32 a139, v71
  v_perm_b32 v68, v131, v129, s51
  v_accvgpr_write_b32 a140, v68
  v_perm_b32 v69, v135, v133, s51
  v_accvgpr_write_b32 a141, v69
  v_perm_b32 v70, v139, v137, s51
  v_accvgpr_write_b32 a142, v70
  v_perm_b32 v71, v143, v141, s51
  v_accvgpr_write_b32 a143, v71
  v_perm_b32 v68, v146, v144, s50
  v_accvgpr_write_b32 a144, v68
  v_perm_b32 v69, v150, v148, s50
  v_accvgpr_write_b32 a145, v69
  v_perm_b32 v70, v154, v152, s50
  v_accvgpr_write_b32 a146, v70
  v_perm_b32 v71, v158, v156, s50
  v_accvgpr_write_b32 a147, v71
  v_perm_b32 v68, v146, v144, s51
  v_accvgpr_write_b32 a148, v68
  v_perm_b32 v69, v150, v148, s51
  v_accvgpr_write_b32 a149, v69
  v_perm_b32 v70, v154, v152, s51
  v_accvgpr_write_b32 a150, v70
  v_perm_b32 v71, v158, v156, s51
  v_accvgpr_write_b32 a151, v71
  v_perm_b32 v68, v147, v145, s50
  v_accvgpr_write_b32 a152, v68
  v_perm_b32 v69, v151, v149, s50
  v_accvgpr_write_b32 a153, v69
  v_perm_b32 v70, v155, v153, s50
  v_accvgpr_write_b32 a154, v70
  v_perm_b32 v71, v159, v157, s50
  v_accvgpr_write_b32 a155, v71
  v_perm_b32 v68, v147, v145, s51
  v_accvgpr_write_b32 a156, v68
  v_perm_b32 v69, v151, v149, s51
  v_accvgpr_write_b32 a157, v69
  v_perm_b32 v70, v155, v153, s51
  v_accvgpr_write_b32 a158, v70
  v_perm_b32 v71, v159, v157, s51
  v_accvgpr_write_b32 a159, v71
  v_perm_b32 v68, v162, v160, s50
  v_accvgpr_write_b32 a160, v68
  v_perm_b32 v69, v166, v164, s50
  v_accvgpr_write_b32 a161, v69
  v_perm_b32 v70, v170, v168, s50
  v_accvgpr_write_b32 a162, v70
  v_perm_b32 v71, v174, v172, s50
  v_accvgpr_write_b32 a163, v71
  v_perm_b32 v68, v162, v160, s51
  v_accvgpr_write_b32 a164, v68
  v_perm_b32 v69, v166, v164, s51
  v_accvgpr_write_b32 a165, v69
  v_perm_b32 v70, v170, v168, s51
  v_accvgpr_write_b32 a166, v70
  v_perm_b32 v71, v174, v172, s51
  v_accvgpr_write_b32 a167, v71
  v_perm_b32 v68, v163, v161, s50
  v_accvgpr_write_b32 a168, v68
  v_perm_b32 v69, v167, v165, s50
  v_accvgpr_write_b32 a169, v69
  v_perm_b32 v70, v171, v169, s50
  v_accvgpr_write_b32 a170, v70
  v_perm_b32 v71, v175, v173, s50
  v_accvgpr_write_b32 a171, v71
  v_perm_b32 v68, v163, v161, s51
  v_accvgpr_write_b32 a172, v68
  v_perm_b32 v69, v167, v165, s51
  v_accvgpr_write_b32 a173, v69
  v_perm_b32 v70, v171, v169, s51
  v_accvgpr_write_b32 a174, v70
  v_perm_b32 v71, v175, v173, s51
  v_accvgpr_write_b32 a175, v71
  v_perm_b32 v68, v178, v176, s50
  v_accvgpr_write_b32 a176, v68
  v_perm_b32 v69, v182, v180, s50
  v_accvgpr_write_b32 a177, v69
  v_perm_b32 v70, v186, v184, s50
  v_accvgpr_write_b32 a178, v70
  v_perm_b32 v71, v190, v188, s50
  v_accvgpr_write_b32 a179, v71
  v_perm_b32 v68, v178, v176, s51
  v_accvgpr_write_b32 a180, v68
  v_perm_b32 v69, v182, v180, s51
  v_accvgpr_write_b32 a181, v69
  v_perm_b32 v70, v186, v184, s51
  v_accvgpr_write_b32 a182, v70
  v_perm_b32 v71, v190, v188, s51
  v_accvgpr_write_b32 a183, v71
  v_perm_b32 v68, v179, v177, s50
  v_accvgpr_write_b32 a184, v68
  v_perm_b32 v69, v183, v181, s50
  v_accvgpr_write_b32 a185, v69
  v_perm_b32 v70, v187, v185, s50
  v_accvgpr_write_b32 a186, v70
  v_perm_b32 v71, v191, v189, s50
  v_accvgpr_write_b32 a187, v71
  v_perm_b32 v68, v179, v177, s51
  v_accvgpr_write_b32 a188, v68
  v_perm_b32 v69, v183, v181, s51
  v_accvgpr_write_b32 a189, v69
  v_perm_b32 v70, v187, v185, s51
  v_accvgpr_write_b32 a190, v70
  v_perm_b32 v71, v191, v189, s51
  v_accvgpr_write_b32 a191, v71
  s_waitcnt vmcnt(0)
  v_perm_b32 v68, v208, v192, s50
  v_accvgpr_write_b32 a192, v68
  v_perm_b32 v69, v240, v224, s50
  v_accvgpr_write_b32 a193, v69
  v_perm_b32 v70, v212, v196, s50
  v_accvgpr_write_b32 a194, v70
  v_perm_b32 v71, v244, v228, s50
  v_accvgpr_write_b32 a195, v71
  v_perm_b32 v68, v208, v192, s51
  v_accvgpr_write_b32 a196, v68
  v_perm_b32 v69, v240, v224, s51
  v_accvgpr_write_b32 a197, v69
  v_perm_b32 v70, v212, v196, s51
  v_accvgpr_write_b32 a198, v70
  v_perm_b32 v71, v244, v228, s51
  v_accvgpr_write_b32 a199, v71
  v_perm_b32 v68, v209, v193, s50
  v_accvgpr_write_b32 a200, v68
  v_perm_b32 v69, v241, v225, s50
  v_accvgpr_write_b32 a201, v69
  v_perm_b32 v70, v213, v197, s50
  v_accvgpr_write_b32 a202, v70
  v_perm_b32 v71, v245, v229, s50
  v_accvgpr_write_b32 a203, v71
  v_perm_b32 v68, v209, v193, s51
  v_accvgpr_write_b32 a204, v68
  v_perm_b32 v69, v241, v225, s51
  v_accvgpr_write_b32 a205, v69
  v_perm_b32 v70, v213, v197, s51
  v_accvgpr_write_b32 a206, v70
  v_perm_b32 v71, v245, v229, s51
  v_accvgpr_write_b32 a207, v71
  v_perm_b32 v68, v210, v194, s50
  v_accvgpr_write_b32 a208, v68
  v_perm_b32 v69, v242, v226, s50
  v_accvgpr_write_b32 a209, v69
  v_perm_b32 v70, v214, v198, s50
  v_accvgpr_write_b32 a210, v70
  v_perm_b32 v71, v246, v230, s50
  v_accvgpr_write_b32 a211, v71
  v_perm_b32 v68, v210, v194, s51
  v_accvgpr_write_b32 a212, v68
  v_perm_b32 v69, v242, v226, s51
  v_accvgpr_write_b32 a213, v69
  v_perm_b32 v70, v214, v198, s51
  v_accvgpr_write_b32 a214, v70
  v_perm_b32 v71, v246, v230, s51
  v_accvgpr_write_b32 a215, v71
  v_perm_b32 v68, v211, v195, s50
  v_accvgpr_write_b32 a216, v68
  v_perm_b32 v69, v243, v227, s50
  v_accvgpr_write_b32 a217, v69
  v_perm_b32 v70, v215, v199, s50
  v_accvgpr_write_b32 a218, v70
  v_perm_b32 v71, v247, v231, s50
  v_accvgpr_write_b32 a219, v71
  v_perm_b32 v68, v211, v195, s51
  v_accvgpr_write_b32 a220, v68
  v_perm_b32 v69, v243, v227, s51
  v_accvgpr_write_b32 a221, v69
  v_perm_b32 v70, v215, v199, s51
  v_accvgpr_write_b32 a222, v70
  v_perm_b32 v71, v247, v231, s51
  v_accvgpr_write_b32 a223, v71
  v_perm_b32 v68, v216, v200, s50
  v_accvgpr_write_b32 a224, v68
  v_perm_b32 v69, v248, v232, s50
  v_accvgpr_write_b32 a225, v69
  v_perm_b32 v70, v220, v204, s50
  v_accvgpr_write_b32 a226, v70
  v_perm_b32 v71, v252, v236, s50
  v_accvgpr_write_b32 a227, v71
  v_perm_b32 v68, v216, v200, s51
  v_accvgpr_write_b32 a228, v68
  v_perm_b32 v69, v248, v232, s51
  v_accvgpr_write_b32 a229, v69
  v_perm_b32 v70, v220, v204, s51
  v_accvgpr_write_b32 a230, v70
  v_perm_b32 v71, v252, v236, s51
  v_accvgpr_write_b32 a231, v71
  v_perm_b32 v68, v217, v201, s50
  v_accvgpr_write_b32 a232, v68
  v_perm_b32 v69, v249, v233, s50
  v_accvgpr_write_b32 a233, v69
  v_perm_b32 v70, v221, v205, s50
  v_accvgpr_write_b32 a234, v70
  v_perm_b32 v71, v253, v237, s50
  v_accvgpr_write_b32 a235, v71
  v_perm_b32 v68, v217, v201, s51
  v_accvgpr_write_b32 a236, v68
  v_perm_b32 v69, v249, v233, s51
  v_accvgpr_write_b32 a237, v69
  v_perm_b32 v70, v221, v205, s51
  v_accvgpr_write_b32 a238, v70
  v_perm_b32 v71, v253, v237, s51
  v_accvgpr_write_b32 a239, v71
  v_perm_b32 v68, v218, v202, s50
  v_accvgpr_write_b32 a240, v68
  v_perm_b32 v69, v250, v234, s50
  v_accvgpr_write_b32 a241, v69
  v_perm_b32 v70, v222, v206, s50
  v_accvgpr_write_b32 a242, v70
  v_perm_b32 v71, v254, v238, s50
  v_accvgpr_write_b32 a243, v71
  v_perm_b32 v68, v218, v202, s51
  v_accvgpr_write_b32 a244, v68
  v_perm_b32 v69, v250, v234, s51
  v_accvgpr_write_b32 a245, v69
  v_perm_b32 v70, v222, v206, s51
  v_accvgpr_write_b32 a246, v70
  v_perm_b32 v71, v254, v238, s51
  v_accvgpr_write_b32 a247, v71
  v_perm_b32 v68, v219, v203, s50
  v_accvgpr_write_b32 a248, v68
  v_perm_b32 v69, v251, v235, s50
  v_accvgpr_write_b32 a249, v69
  v_perm_b32 v70, v223, v207, s50
  v_accvgpr_write_b32 a250, v70
  v_perm_b32 v71, v255, v239, s50
  v_accvgpr_write_b32 a251, v71
  v_perm_b32 v68, v219, v203, s51
  v_accvgpr_write_b32 a252, v68
  v_perm_b32 v69, v251, v235, s51
  v_accvgpr_write_b32 a253, v69
  v_perm_b32 v70, v223, v207, s51
  v_accvgpr_write_b32 a254, v70
  v_perm_b32 v71, v255, v239, s51
  v_accvgpr_write_b32 a255, v71
  v_mov_b32 v149, 0
  v_mov_b32 v150, 0
  s_cmp_lg_u32 s17, 0
  s_cbranch_scc1 XR_BQB
  v_mbcnt_lo_u32_b32 v73, -1, 0
  v_lshlrev_b32 v72, 2, v73
  v_add_u32 v72, s3, v72
  s_mov_b32 s99, 0
  s_mov_b64 exec, 15
XR_BQ:
  buffer_load_dword v73, v72, s[8:11], 0 offen offset:64 sc1
  s_add_u32 s99, s99, 1
  s_cmp_gt_u32 s99, 0x20000
  s_cbranch_scc1 KEND
  s_waitcnt vmcnt(0)
  v_cmp_lt_u32 vcc, 0xffff, v73
  s_mov_b32 s98, 0
  s_cbranch_vccnz XR_BQX
  v_cmp_eq_u32 vcc, 32, v73
  s_and_b32 s97, vcc_lo, 15
  s_mov_b32 s98, 1
  s_cmp_eq_u32 s97, 15
  s_cbranch_scc1 XR_BQX
  s_sleep 4
  s_branch XR_BQ
XR_BQX:
  s_mov_b64 exec, -1
  v_mov_b32 v72, 57344
  v_mov_b32 v73, s98
  ds_write_b32 v72, v73
  s_waitcnt lgkmcnt(0)
XR_BQB:
  s_barrier
  v_mov_b32 v72, 57344
  ds_read_b32 v73, v72
  s_waitcnt lgkmcnt(0)
  v_readfirstlane_b32 s98, v73
  s_cmp_eq_u32 s98, 0
  s_cbranch_scc1 FALLBACK
  s_movk_i32 s97, 0x1000
  s_movk_i32 s98, 0x2000
  buffer_load_dwordx4 v[28:31], v58, s[4:7], s97 offen sc1
  buffer_load_dwordx4 v[32:35], v58, s[4:7], s97 offen offset:2048 sc1
  buffer_load_dwordx4 v[36:39], v58, s[4:7], s98 offen sc1
  buffer_load_dwordx4 v[40:43], v58, s[4:7], s98 offen offset:2048 sc1
  s_waitcnt vmcnt(0)
  v_add_f32 v36, 1.0, v36
  v_add_f32 v37, 1.0, v37
  v_add_f32 v38, 1.0, v38
  v_add_f32 v39, 1.0, v39
  s_mov_b32 s43, 0
  s_mov_b64 exec, 0xffff
  s_branch XR_K0E
XR_K0:
  s_sleep 8
XR_K0E:
  buffer_load_dword v14, v4, s[4:7], 0 offen sc1
  s_add_u32 s43, s43, 1
  s_cmp_gt_u32 s43, 0x20000
  s_cbranch_scc1 KEND
  s_waitcnt vmcnt(0)
  v_cmpx_lt_u32 vcc, v14, v5
  s_cbranch_vccnz XR_K0
  s_mov_b64 exec, -1
  buffer_load_dwordx4 v[48:51], v10, s[4:7], s37 offen offset:0 sc1
  buffer_load_dwordx4 v[52:55], v10, s[4:7], s37 offen offset:2048 sc1
  s_add_u32 s47, s37, 4096
  buffer_load_dwordx4 v[56:59], v10, s[4:7], s47 offen offset:0 sc1
  buffer_load_dwordx4 v[60:63], v10, s[4:7], s47 offen offset:2048 sc1
  buffer_load_dwordx4 v[64:67], v1, s[4:7], s38 offen offset:0 sc1
  buffer_load_dwordx4 v[68:71], v1, s[4:7], s38 offen offset:1024 sc1
  buffer_load_dwordx4 v[72:75], v1, s[4:7], s38 offen offset:2048 sc1
  buffer_load_dwordx4 v[76:79], v1, s[4:7], s38 offen offset:3072 sc1
  s_add_u32 s47, s38, 4096
  buffer_load_dwordx4 v[80:83], v1, s[4:7], s47 offen offset:0 sc1
  buffer_load_dwordx4 v[84:87], v1, s[4:7], s47 offen offset:1024 sc1
  buffer_load_dwordx4 v[88:91], v1, s[4:7], s47 offen offset:2048 sc1
  buffer_load_dwordx4 v[92:95], v1, s[4:7], s47 offen offset:3072 sc1
  buffer_load_dwordx4 v[96:99], v11, s[4:7], s39 offen offset:0 sc1
  buffer_load_dwordx4 v[100:103], v11, s[4:7], s39 offen offset:1024 sc1
  buffer_load_dwordx4 v[104:107], v11, s[4:7], s39 offen offset:2048 sc1
  buffer_load_dwordx4 v[108:111], v11, s[4:7], s39 offen offset:3072 sc1
  s_add_u32 s37, s37, 1048576
  s_add_u32 s38, s38, 1048576
  s_add_u32 s39, s39, 1048576
  s_add_u32 s47, s48, 2
  v_mov_b32 v14, s47
  v_add_u32 v5, 4, v5
  v_cmp_gt_u32 vcc, 64, v1
  s_nop 1
  v_cndmask_b32 v5, v5, v14, vcc
  s_cmp_eq_u32 s18, 0
  s_cbranch_scc1 XS_LOOP
XP_LOOP:
  s_add_u32 s36, s36, 1
  s_waitcnt vmcnt(0)
  v_mfma_f32_16x16x32_bf16 v[132:135], v[64:67], v[48:51], v[20:23]
  v_mfma_f32_16x16x32_bf16 v[136:139], v[68:71], v[48:51], v[24:27]
  v_mfma_f32_16x16x32_bf16 v[132:135], v[72:75], v[52:55], v[132:135]
  v_mfma_f32_16x16x32_bf16 v[136:139], v[76:79], v[52:55], v[136:139]
  v_mfma_f32_16x16x32_bf16 v[132:135], v[80:83], v[56:59], v[132:135]
  v_mfma_f32_16x16x32_bf16 v[136:139], v[84:87], v[56:59], v[136:139]
  v_mfma_f32_16x16x32_bf16 v[132:135], v[88:91], v[60:63], v[132:135]
  v_mfma_f32_16x16x32_bf16 v[136:139], v[92:95], v[60:63], v[136:139]
  s_mov_b32 s43, 0
  s_mov_b64 exec, 0xffff
  s_branch XP_KE
XP_K:
  s_sleep 8
XP_KE:
  buffer_load_dword v14, v4, s[4:7], 0 offen sc1
  s_add_u32 s43, s43, 1
  s_cmp_gt_u32 s43, 0x20000
  s_cbranch_scc1 KEND
  s_waitcnt vmcnt(0)
  v_cmpx_lt_u32 vcc, v14, v5
  s_cbranch_vccnz XP_K
  s_mov_b64 exec, -1
  s_add_u32 s47, s40, 4096
  buffer_load_dwordx4 v[112:115], v1, s[4:7], s40 offen offset:0 sc1
  buffer_load_dwordx4 v[116:119], v1, s[4:7], s40 offen offset:2048 sc1
  buffer_load_dwordx4 v[120:123], v1, s[4:7], s47 offen offset:0 sc1
  buffer_load_dwordx4 v[124:127], v1, s[4:7], s47 offen offset:2048 sc1
  buffer_load_dwordx2 v[128:129], v11, s[4:7], s40 offen offset:1024 sc1
  buffer_load_dwordx2 v[130:131], v11, s[4:7], s40 offen offset:3072 sc1
  buffer_load_dwordx2 v[152:153], v9, s[20:23], s41 offen
  s_add_u32 s40, s40, 1048576
  v_add_u32 v5, 4, v5
  v_max3_f32 v14, v132, v133, v134
  v_max3_f32 v15, v135, v136, v137
  v_max3_f32 v14, v14, v138, v139
  v_max_f32 v14, v14, v15
  s_waitcnt vmcnt(6)
  v_mfma_f32_16x16x32_bf16 v[140:143], v[112:115], v[48:51], 0
  s_waitcnt vmcnt(5)
  v_mfma_f32_16x16x32_bf16 v[140:143], v[116:119], v[52:55], v[140:143]
  s_waitcnt vmcnt(4)
  v_mfma_f32_16x16x32_bf16 v[140:143], v[120:123], v[56:59], v[140:143]
  s_waitcnt vmcnt(3)
  v_mfma_f32_16x16x32_bf16 v[140:143], v[124:127], v[60:63], v[140:143]
  s_nop 7
  v_max3_f32 v14, v14, v140, v142
  v_mov_b32 v15, v14
  s_nop 1
  v_permlane16_swap_b32 v14, v15
  v_max_f32 v14, v14, v15
  v_mov_b32 v15, v14
  s_nop 1
  v_permlane32_swap_b32 v14, v15
  v_max_f32 v14, v14, v15
  v_mul_f32 v14, s42, v14
  v_fma_f32 v132, v132, s42, -v14
  v_fma_f32 v133, v133, s42, -v14
  v_fma_f32 v134, v134, s42, -v14
  v_fma_f32 v135, v135, s42, -v14
  v_fma_f32 v136, v136, s42, -v14
  v_fma_f32 v137, v137, s42, -v14
  v_fma_f32 v138, v138, s42, -v14
  v_fma_f32 v139, v139, s42, -v14
  v_fma_f32 v140, v140, s42, -v14
  v_fma_f32 v142, v142, s42, -v14
  v_exp_f32 v132, v132
  v_exp_f32 v133, v133
  v_exp_f32 v134, v134
  v_exp_f32 v135, v135
  v_exp_f32 v136, v136
  v_exp_f32 v137, v137
  v_exp_f32 v138, v138
  v_exp_f32 v139, v139
  v_exp_f32 v140, v140
  v_exp_f32 v142, v142
  v_cvt_pk_bf16_f32 v144, v132, v133
  v_cvt_pk_bf16_f32 v145, v134, v135
  v_cvt_pk_bf16_f32 v146, v136, v137
  v_cvt_pk_bf16_f32 v147, v138, v139
  v_cvt_pk_bf16_f32 v148, v140, v142
  v_mov_b32 v151, v148
  v_mfma_f32_16x16x32_bf16 v[192:195], v[96:99], v[144:147], 0
  v_mfma_f32_16x16x32_bf16 v[196:199], v[100:103], v[144:147], 0
  v_mfma_f32_16x16x32_bf16 v[200:203], v[104:107], v[144:147], 0
  v_mfma_f32_16x16x32_bf16 v[204:207], v[108:111], v[144:147], 0
  s_waitcnt vmcnt(1)
  v_mfma_f32_16x16x16_bf16 v[192:195], v[128:129], v[148:149], v[192:195]
  v_mfma_f32_16x16x16_bf16 v[196:199], v[128:129], v[150:151], v[196:199]
  v_mfma_f32_16x16x16_bf16 v[200:203], v[130:131], v[148:149], v[200:203]
  v_mfma_f32_16x16x16_bf16 v[204:207], v[130:131], v[150:151], v[204:207]
  v_add_f32 v14, v132, v133
  v_add_f32 v15, v134, v135
  v_add_f32 v14, v14, v136
  v_add_f32 v14, v14, v137
  v_add_f32 v14, v14, v138
  v_add_f32 v15, v15, v139
  v_add_f32 v15, v15, v140
  v_add_f32 v15, v15, v142
  v_add_f32 v14, v14, v15
  v_mov_b32 v15, v14
  s_nop 1
  v_permlane16_swap_b32 v14, v15
  v_add_f32 v14, v14, v15
  v_mov_b32 v15, v14
  s_nop 1
  v_permlane32_swap_b32 v14, v15
  v_add_f32 v14, v14, v15
  v_rcp_f32 v14, v14
  s_nop 0
  v_mul_f32 v192, v192, v14
  v_mul_f32 v193, v193, v14
  v_mul_f32 v194, v194, v14
  v_mul_f32 v195, v195, v14
  v_mul_f32 v196, v196, v14
  v_mul_f32 v197, v197, v14
  v_mul_f32 v198, v198, v14
  v_mul_f32 v199, v199, v14
  v_mul_f32 v200, v200, v14
  v_mul_f32 v201, v201, v14
  v_mul_f32 v202, v202, v14
  v_mul_f32 v203, v203, v14
  v_mul_f32 v204, v204, v14
  v_mul_f32 v205, v205, v14
  v_mul_f32 v206, v206, v14
  v_mul_f32 v207, v207, v14
  v_cvt_pk_bf16_f32 v208, v192, v193
  v_cvt_pk_bf16_f32 v209, v194, v195
  v_cvt_pk_bf16_f32 v210, v196, v197
  v_cvt_pk_bf16_f32 v211, v198, v199
  v_cvt_pk_bf16_f32 v212, v200, v201
  v_cvt_pk_bf16_f32 v213, v202, v203
  v_cvt_pk_bf16_f32 v214, v204, v205
  v_cvt_pk_bf16_f32 v215, v206, v207
  ds_write_b128 v12, v[208:211] offset:0
  ds_write_b128 v12, v[212:215] offset:1024
  s_waitcnt lgkmcnt(0)
  s_barrier
  ds_read_b128 v[160:163], v1 offset:0
  ds_read_b128 v[164:167], v1 offset:1024
  ds_read_b128 v[168:171], v1 offset:2048
  ds_read_b128 v[172:175], v1 offset:3072
  ds_read_b128 v[176:179], v1 offset:4096
  ds_read_b128 v[180:183], v1 offset:5120
  ds_read_b128 v[184:187], v1 offset:6144
  ds_read_b128 v[188:191], v1 offset:7168
  buffer_load_dwordx4 v[48:51], v10, s[4:7], s37 offen offset:0 sc1
  buffer_load_dwordx4 v[52:55], v10, s[4:7], s37 offen offset:2048 sc1
  s_add_u32 s47, s37, 4096
  buffer_load_dwordx4 v[56:59], v10, s[4:7], s47 offen offset:0 sc1
  buffer_load_dwordx4 v[60:63], v10, s[4:7], s47 offen offset:2048 sc1
  buffer_load_dwordx4 v[64:67], v1, s[4:7], s38 offen offset:0 sc1
  buffer_load_dwordx4 v[68:71], v1, s[4:7], s38 offen offset:1024 sc1
  buffer_load_dwordx4 v[72:75], v1, s[4:7], s38 offen offset:2048 sc1
  buffer_load_dwordx4 v[76:79], v1, s[4:7], s38 offen offset:3072 sc1
  s_add_u32 s47, s38, 4096
  buffer_load_dwordx4 v[80:83], v1, s[4:7], s47 offen offset:0 sc1
  buffer_load_dwordx4 v[84:87], v1, s[4:7], s47 offen offset:1024 sc1
  buffer_load_dwordx4 v[88:91], v1, s[4:7], s47 offen offset:2048 sc1
  buffer_load_dwordx4 v[92:95], v1, s[4:7], s47 offen offset:3072 sc1
  buffer_load_dwordx4 v[96:99], v11, s[4:7], s39 offen offset:0 sc1
  buffer_load_dwordx4 v[100:103], v11, s[4:7], s39 offen offset:1024 sc1
  buffer_load_dwordx4 v[104:107], v11, s[4:7], s39 offen offset:2048 sc1
  buffer_load_dwordx4 v[108:111], v11, s[4:7], s39 offen offset:3072 sc1
  s_add_u32 s37, s37, 1048576
  s_add_u32 s38, s38, 1048576
  s_add_u32 s39, s39, 1048576
  s_waitcnt lgkmcnt(7)
  v_mfma_f32_16x16x32_bf16 v[192:195], v[160:163], a[0:3], 0
  v_mfma_f32_16x16x32_bf16 v[196:199], v[160:163], a[4:7], 0
  v_mfma_f32_16x16x32_bf16 v[200:203], v[160:163], a[8:11], 0
  v_mfma_f32_16x16x32_bf16 v[204:207], v[160:163], a[12:15], 0
  v_mfma_f32_16x16x32_bf16 v[208:211], v[160:163], a[16:19], 0
  v_mfma_f32_16x16x32_bf16 v[212:215], v[160:163], a[20:23], 0
  v_mfma_f32_16x16x32_bf16 v[216:219], v[160:163], a[24:27], 0
  v_mfma_f32_16x16x32_bf16 v[220:223], v[160:163], a[28:31], 0
  s_waitcnt lgkmcnt(6)
  v_mfma_f32_16x16x32_bf16 v[192:195], v[164:167], a[32:35], v[192:195]
  v_mfma_f32_16x16x32_bf16 v[196:199], v[164:167], a[36:39], v[196:199]
  v_mfma_f32_16x16x32_bf16 v[200:203], v[164:167], a[40:43], v[200:203]
  v_mfma_f32_16x16x32_bf16 v[204:207], v[164:167], a[44:47], v[204:207]
  v_mfma_f32_16x16x32_bf16 v[208:211], v[164:167], a[48:51], v[208:211]
  v_mfma_f32_16x16x32_bf16 v[212:215], v[164:167], a[52:55], v[212:215]
  v_mfma_f32_16x16x32_bf16 v[216:219], v[164:167], a[56:59], v[216:219]
  v_mfma_f32_16x16x32_bf16 v[220:223], v[164:167], a[60:63], v[220:223]
  s_waitcnt lgkmcnt(5)
  v_mfma_f32_16x16x32_bf16 v[192:195], v[168:171], a[64:67], v[192:195]
  v_mfma_f32_16x16x32_bf16 v[196:199], v[168:171], a[68:71], v[196:199]
  v_mfma_f32_16x16x32_bf16 v[200:203], v[168:171], a[72:75], v[200:203]
  v_mfma_f32_16x16x32_bf16 v[204:207], v[168:171], a[76:79], v[204:207]
  v_mfma_f32_16x16x32_bf16 v[208:211], v[168:171], a[80:83], v[208:211]
  v_mfma_f32_16x16x32_bf16 v[212:215], v[168:171], a[84:87], v[212:215]
  v_mfma_f32_16x16x32_bf16 v[216:219], v[168:171], a[88:91], v[216:219]
  v_mfma_f32_16x16x32_bf16 v[220:223], v[168:171], a[92:95], v[220:223]
  s_waitcnt lgkmcnt(4)
  v_mfma_f32_16x16x32_bf16 v[192:195], v[172:175], a[96:99], v[192:195]
  v_mfma_f32_16x16x32_bf16 v[196:199], v[172:175], a[100:103], v[196:199]
  v_mfma_f32_16x16x32_bf16 v[200:203], v[172:175], a[104:107], v[200:203]
  v_mfma_f32_16x16x32_bf16 v[204:207], v[172:175], a[108:111], v[204:207]
  v_mfma_f32_16x16x32_bf16 v[208:211], v[172:175], a[112:115], v[208:211]
  v_mfma_f32_16x16x32_bf16 v[212:215], v[172:175], a[116:119], v[212:215]
  v_mfma_f32_16x16x32_bf16 v[216:219], v[172:175], a[120:123], v[216:219]
  v_mfma_f32_16x16x32_bf16 v[220:223], v[172:175], a[124:127], v[220:223]
  s_waitcnt lgkmcnt(3)
  v_mfma_f32_16x16x32_bf16 v[224:227], v[176:179], a[0:3], 0
  v_mfma_f32_16x16x32_bf16 v[228:231], v[176:179], a[4:7], 0
  v_mfma_f32_16x16x32_bf16 v[232:235], v[176:179], a[8:11], 0
  v_mfma_f32_16x16x32_bf16 v[236:239], v[176:179], a[12:15], 0
  v_mfma_f32_16x16x32_bf16 v[240:243], v[176:179], a[16:19], 0
  v_cvt_pk_bf16_f32 v112, v192, v196
  v_cvt_pk_bf16_f32 v113, v200, v204
  v_mfma_f32_16x16x32_bf16 v[244:247], v[176:179], a[20:23], 0
  v_cvt_pk_bf16_f32 v114, v208, v212
  v_cvt_pk_bf16_f32 v115, v216, v220
  s_add_u32 s47, s44, 0
  buffer_store_dwordx4 v[112:115], v6, s[4:7], s47 offen
  v_mfma_f32_16x16x32_bf16 v[248:251], v[176:179], a[24:27], 0
  v_cvt_pk_bf16_f32 v116, v193, v197
  v_cvt_pk_bf16_f32 v117, v201, v205
  v_mfma_f32_16x16x32_bf16 v[252:255], v[176:179], a[28:31], 0
  v_cvt_pk_bf16_f32 v118, v209, v213
  v_cvt_pk_bf16_f32 v119, v217, v221
  s_add_u32 s47, s44, 32768
  buffer_store_dwordx4 v[116:119], v6, s[4:7], s47 offen
  s_waitcnt lgkmcnt(2)
  v_mfma_f32_16x16x32_bf16 v[224:227], v[180:183], a[32:35], v[224:227]
  v_cvt_pk_bf16_f32 v120, v194, v198
  v_cvt_pk_bf16_f32 v121, v202, v206
  v_mfma_f32_16x16x32_bf16 v[228:231], v[180:183], a[36:39], v[228:231]
  v_cvt_pk_bf16_f32 v122, v210, v214
  v_cvt_pk_bf16_f32 v123, v218, v222
  s_add_u32 s47, s44, 65536
  buffer_store_dwordx4 v[120:123], v6, s[4:7], s47 offen
  v_mfma_f32_16x16x32_bf16 v[232:235], v[180:183], a[40:43], v[232:235]
  v_cvt_pk_bf16_f32 v124, v195, v199
  v_cvt_pk_bf16_f32 v125, v203, v207
  v_mfma_f32_16x16x32_bf16 v[236:239], v[180:183], a[44:47], v[236:239]
  v_cvt_pk_bf16_f32 v126, v211, v215
  v_cvt_pk_bf16_f32 v127, v219, v223
  s_add_u32 s47, s44, 98304
  buffer_store_dwordx4 v[124:127], v6, s[4:7], s47 offen
  v_mfma_f32_16x16x32_bf16 v[240:243], v[180:183], a[48:51], v[240:243]
  v_mfma_f32_16x16x32_bf16 v[244:247], v[180:183], a[52:55], v[244:247]
  v_mfma_f32_16x16x32_bf16 v[248:251], v[180:183], a[56:59], v[248:251]
  v_mfma_f32_16x16x32_bf16 v[252:255], v[180:183], a[60:63], v[252:255]
  s_waitcnt lgkmcnt(1)
  v_mfma_f32_16x16x32_bf16 v[224:227], v[184:187], a[64:67], v[224:227]
  v_mfma_f32_16x16x32_bf16 v[228:231], v[184:187], a[68:71], v[228:231]
  v_mfma_f32_16x16x32_bf16 v[232:235], v[184:187], a[72:75], v[232:235]
  v_mfma_f32_16x16x32_bf16 v[236:239], v[184:187], a[76:79], v[236:239]
  v_mfma_f32_16x16x32_bf16 v[240:243], v[184:187], a[80:83], v[240:243]
  v_mfma_f32_16x16x32_bf16 v[244:247], v[184:187], a[84:87], v[244:247]
  v_mfma_f32_16x16x32_bf16 v[248:251], v[184:187], a[88:91], v[248:251]
  v_mfma_f32_16x16x32_bf16 v[252:255], v[184:187], a[92:95], v[252:255]
  s_waitcnt lgkmcnt(0)
  v_mfma_f32_16x16x32_bf16 v[224:227], v[188:191], a[96:99], v[224:227]
  v_mfma_f32_16x16x32_bf16 v[228:231], v[188:191], a[100:103], v[228:231]
  v_mfma_f32_16x16x32_bf16 v[232:235], v[188:191], a[104:107], v[232:235]
  v_mfma_f32_16x16x32_bf16 v[236:239], v[188:191], a[108:111], v[236:239]
  v_mfma_f32_16x16x32_bf16 v[240:243], v[188:191], a[112:115], v[240:243]
  v_mfma_f32_16x16x32_bf16 v[244:247], v[188:191], a[116:119], v[244:247]
  v_mfma_f32_16x16x32_bf16 v[248:251], v[188:191], a[120:123], v[248:251]
  v_mfma_f32_16x16x32_bf16 v[252:255], v[188:191], a[124:127], v[252:255]
  v_cvt_pk_bf16_f32 v192, v224, v228
  v_cvt_pk_bf16_f32 v193, v232, v236
  s_nop 1
  v_cvt_pk_bf16_f32 v194, v240, v244
  s_nop 2
  v_cvt_pk_bf16_f32 v195, v248, v252
  s_add_u32 s47, s44, 524288
  buffer_store_dwordx4 v[192:195], v6, s[4:7], s47 offen
  v_cvt_pk_bf16_f32 v196, v225, v229
  v_cvt_pk_bf16_f32 v197, v233, v237
  v_cvt_pk_bf16_f32 v198, v241, v245
  v_cvt_pk_bf16_f32 v199, v249, v253
  s_add_u32 s47, s44, 557056
  buffer_store_dwordx4 v[196:199], v6, s[4:7], s47 offen
  v_cvt_pk_bf16_f32 v200, v226, v230
  v_cvt_pk_bf16_f32 v201, v234, v238
  v_cvt_pk_bf16_f32 v202, v242, v246
  v_cvt_pk_bf16_f32 v203, v250, v254
  s_add_u32 s47, s44, 589824
  buffer_store_dwordx4 v[200:203], v6, s[4:7], s47 offen
  v_cvt_pk_bf16_f32 v204, v227, v231
  v_cvt_pk_bf16_f32 v205, v235, v239
  v_cvt_pk_bf16_f32 v206, v243, v247
  v_cvt_pk_bf16_f32 v207, v251, v255
  s_add_u32 s47, s44, 622592
  buffer_store_dwordx4 v[204:207], v6, s[4:7], s47 offen
  v_mov_b32 v15, s36
  s_waitcnt vmcnt(0)
  buffer_store_dword v15, v2, s[4:7], 0 offen offset:0
  v_lshlrev_b32 v44, 16, v152
  v_and_b32 v45, 0xffff0000, v152
  v_lshlrev_b32 v46, 16, v153
  v_and_b32 v47, 0xffff0000, v153
  s_mov_b32 s43, 0
  s_mov_b32 exec_hi, 0
XP_A:
  buffer_load_dword v14, v3, s[4:7], 0 offen offset:0 sc1
  s_add_u32 s43, s43, 1
  s_cmp_gt_u32 s43, 0x20000
  s_cbranch_scc1 KEND
  s_waitcnt vmcnt(0)
  v_cmp_gt_u32 vcc, s36, v14
  s_cbranch_vccnz XP_A
  s_mov_b64 exec, -1
  s_add_u32 s47, s44, 4096
  buffer_load_dwordx4 v[160:163], v7, s[4:7], s44 offen offset:0 sc1
  buffer_load_dwordx4 v[164:167], v7, s[4:7], s44 offen offset:1024 sc1
  buffer_load_dwordx4 v[168:171], v7, s[4:7], s44 offen offset:2048 sc1
  buffer_load_dwordx4 v[172:175], v7, s[4:7], s44 offen offset:3072 sc1
  buffer_load_dwordx4 v[176:179], v7, s[4:7], s47 offen offset:0 sc1
  buffer_load_dwordx4 v[180:183], v7, s[4:7], s47 offen offset:1024 sc1
  buffer_load_dwordx4 v[184:187], v7, s[4:7], s47 offen offset:2048 sc1
  buffer_load_dwordx4 v[188:191], v7, s[4:7], s47 offen offset:3072 sc1
  s_waitcnt vmcnt(7)
  v_mfma_f32_16x16x32_bf16 v[132:135], v[16:19], v[160:163], 0
  s_waitcnt vmcnt(6)
  v_mfma_f32_16x16x32_bf16 v[136:139], v[16:19], v[164:167], 0
  s_waitcnt vmcnt(5)
  v_mfma_f32_16x16x32_bf16 v[132:135], v[16:19], v[168:171], v[132:135]
  s_waitcnt vmcnt(4)
  v_mfma_f32_16x16x32_bf16 v[136:139], v[16:19], v[172:175], v[136:139]
  s_waitcnt vmcnt(3)
  v_mfma_f32_16x16x32_bf16 v[132:135], v[16:19], v[176:179], v[132:135]
  s_waitcnt vmcnt(2)
  v_mfma_f32_16x16x32_bf16 v[136:139], v[16:19], v[180:183], v[136:139]
  s_waitcnt vmcnt(1)
  v_mfma_f32_16x16x32_bf16 v[132:135], v[16:19], v[184:187], v[132:135]
  s_waitcnt vmcnt(0)
  v_mfma_f32_16x16x32_bf16 v[136:139], v[16:19], v[188:191], v[136:139]
  s_nop 7
  v_add_f32 v132, v132, v136
  v_add_f32 v133, v133, v137
  v_add_f32 v134, v134, v138
  v_add_f32 v135, v135, v139
  v_fmac_f32 v44, v28, v132
  v_fmac_f32 v45, v29, v133
  v_fmac_f32 v46, v30, v134
  v_fmac_f32 v47, v31, v135
  v_add_f32 v132, v44, v45
  v_mul_f32 v133, v44, v44
  v_add_f32 v132, v132, v46
  v_fmac_f32 v133, v45, v45
  v_add_f32 v132, v132, v47
  v_fmac_f32 v133, v46, v46
  v_fmac_f32 v133, v47, v47
  v_add_f32_dpp v132, v132, v132 row_ror:8 row_mask:0xf bank_mask:0xf
  s_nop 0
  v_add_f32_dpp v133, v133, v133 row_ror:8 row_mask:0xf bank_mask:0xf
  v_add_f32_dpp v132, v132, v132 row_ror:4 row_mask:0xf bank_mask:0xf
  s_nop 0
  v_add_f32_dpp v133, v133, v133 row_ror:4 row_mask:0xf bank_mask:0xf
  v_add_f32_dpp v132, v132, v132 row_ror:2 row_mask:0xf bank_mask:0xf
  s_nop 0
  v_add_f32_dpp v133, v133, v133 row_ror:2 row_mask:0xf bank_mask:0xf
  v_add_f32_dpp v132, v132, v132 row_ror:1 row_mask:0xf bank_mask:0xf
  s_nop 0
  v_add_f32_dpp v133, v133, v133 row_ror:1 row_mask:0xf bank_mask:0xf
  v_lshrrev_b32 v15, 4, v0
  v_lshlrev_b32 v15, 3, v15
  v_mov_b32 v14, 0
  ds_write_b64 v15, v[132:133] offset:8192
  s_waitcnt lgkmcnt(0)
  s_barrier
  ds_read_b128 v[160:163], v14 offset:8192
  ds_read_b128 v[164:167], v14 offset:8224
  ds_read_b128 v[168:171], v14 offset:8256
  ds_read_b128 v[172:175], v14 offset:8288
  s_waitcnt lgkmcnt(0)
  v_add_f32 v160, v160, v162
  v_add_f32 v164, v164, v166
  v_add_f32 v168, v168, v170
  v_add_f32 v172, v172, v174
  v_add_f32 v161, v161, v163
  v_add_f32 v165, v165, v167
  v_add_f32 v169, v169, v171
  v_add_f32 v173, v173, v175
  v_add_f32 v160, v160, v164
  v_add_f32 v168, v168, v172
  v_add_f32 v161, v161, v165
  v_add_f32 v169, v169, v173
  v_add_f32 v132, v160, v168
  v_add_f32 v133, v161, v169
  v_mul_f32 v132, 0x3b000000, v132
  v_mul_f32 v133, 0x3b000000, v133
  v_fma_f32 v133, -v132, v132, v133
  v_max_f32 v133, 0, v133
  v_add_f32 v133, 0x3727c5ac, v133
  v_rsq_f32 v133, v133
  v_sub_f32 v136, v44, v132
  v_sub_f32 v137, v45, v132
  v_sub_f32 v138, v46, v132
  v_sub_f32 v139, v47, v132
  v_mul_f32 v136, v136, v133
  v_mul_f32 v137, v137, v133
  v_mul_f32 v138, v138, v133
  v_mul_f32 v139, v139, v133
  v_fma_f32 v136, v136, v36, v32
  v_fma_f32 v137, v137, v37, v33
  v_fma_f32 v138, v138, v38, v34
  v_fma_f32 v139, v139, v39, v35
  v_cvt_pk_bf16_f32 v132, v136, v137
  v_cvt_pk_bf16_f32 v133, v138, v139
  buffer_store_dwordx2 v[132:133], v8, s[4:7], s46 offen
  v_mov_b32 v15, s36
  s_waitcnt vmcnt(0)
  buffer_store_dword v15, v2, s[4:7], 0 offen offset:512
  s_cmp_ge_u32 s16, 24
  s_cbranch_scc1 XP_NOF
  s_mov_b32 s43, 0
  s_mov_b32 exec_hi, 0
XP_B:
  buffer_load_dword v14, v3, s[4:7], 0 offen offset:512 sc1
  s_add_u32 s43, s43, 1
  s_cmp_gt_u32 s43, 0x20000
  s_cbranch_scc1 KEND
  s_waitcnt vmcnt(0)
  v_cmp_gt_u32 vcc, s36, v14
  s_cbranch_vccnz XP_B
  s_mov_b64 exec, -1
  s_add_u32 s47, s46, 4096
  buffer_load_dwordx4 v[160:163], v13, s[4:7], s46 offen offset:0 sc1
  buffer_load_dwordx4 v[164:167], v13, s[4:7], s46 offen offset:1024 sc1
  buffer_load_dwordx4 v[168:171], v13, s[4:7], s46 offen offset:2048 sc1
  buffer_load_dwordx4 v[172:175], v13, s[4:7], s46 offen offset:3072 sc1
  buffer_load_dwordx4 v[176:179], v13, s[4:7], s47 offen offset:0 sc1
  buffer_load_dwordx4 v[180:183], v13, s[4:7], s47 offen offset:1024 sc1
  buffer_load_dwordx4 v[184:187], v13, s[4:7], s47 offen offset:2048 sc1
  buffer_load_dwordx4 v[188:191], v13, s[4:7], s47 offen offset:3072 sc1
  s_waitcnt vmcnt(7)
  v_mfma_f32_16x16x32_bf16 v[192:195], a[128:131], v[160:163], 0
  v_mfma_f32_16x16x32_bf16 v[196:199], a[132:135], v[160:163], 0
  v_mfma_f32_16x16x32_bf16 v[200:203], a[136:139], v[160:163], 0
  v_mfma_f32_16x16x32_bf16 v[204:207], a[140:143], v[160:163], 0
  s_waitcnt vmcnt(6)
  v_mfma_f32_16x16x32_bf16 v[208:211], a[128:131], v[164:167], 0
  v_mfma_f32_16x16x32_bf16 v[212:215], a[132:135], v[164:167], 0
  v_mfma_f32_16x16x32_bf16 v[216:219], a[136:139], v[164:167], 0
  v_mfma_f32_16x16x32_bf16 v[220:223], a[140:143], v[164:167], 0
  s_waitcnt vmcnt(5)
  v_mfma_f32_16x16x32_bf16 v[192:195], a[144:147], v[168:171], v[192:195]
  v_mfma_f32_16x16x32_bf16 v[196:199], a[148:151], v[168:171], v[196:199]
  v_mfma_f32_16x16x32_bf16 v[200:203], a[152:155], v[168:171], v[200:203]
  v_mfma_f32_16x16x32_bf16 v[204:207], a[156:159], v[168:171], v[204:207]
  s_waitcnt vmcnt(4)
  v_mfma_f32_16x16x32_bf16 v[208:211], a[144:147], v[172:175], v[208:211]
  v_mfma_f32_16x16x32_bf16 v[212:215], a[148:151], v[172:175], v[212:215]
  v_mfma_f32_16x16x32_bf16 v[216:219], a[152:155], v[172:175], v[216:219]
  v_mfma_f32_16x16x32_bf16 v[220:223], a[156:159], v[172:175], v[220:223]
  s_waitcnt vmcnt(3)
  v_mfma_f32_16x16x32_bf16 v[192:195], a[160:163], v[176:179], v[192:195]
  v_mfma_f32_16x16x32_bf16 v[196:199], a[164:167], v[176:179], v[196:199]
  v_mfma_f32_16x16x32_bf16 v[200:203], a[168:171], v[176:179], v[200:203]
  v_mfma_f32_16x16x32_bf16 v[204:207], a[172:175], v[176:179], v[204:207]
  s_waitcnt vmcnt(2)
  v_mfma_f32_16x16x32_bf16 v[208:211], a[160:163], v[180:183], v[208:211]
  v_mfma_f32_16x16x32_bf16 v[212:215], a[164:167], v[180:183], v[212:215]
  v_mfma_f32_16x16x32_bf16 v[216:219], a[168:171], v[180:183], v[216:219]
  v_mfma_f32_16x16x32_bf16 v[220:223], a[172:175], v[180:183], v[220:223]
  s_waitcnt vmcnt(1)
  v_mfma_f32_16x16x32_bf16 v[192:195], a[176:179], v[184:187], v[192:195]
  v_mfma_f32_16x16x32_bf16 v[196:199], a[180:183], v[184:187], v[196:199]
  v_mfma_f32_16x16x32_bf16 v[200:203], a[184:187], v[184:187], v[200:203]
  v_mfma_f32_16x16x32_bf16 v[204:207], a[188:191], v[184:187], v[204:207]
  s_waitcnt vmcnt(0)
  v_mfma_f32_16x16x32_bf16 v[208:211], a[176:179], v[188:191], v[208:211]
  v_mfma_f32_16x16x32_bf16 v[212:215], a[180:183], v[188:191], v[212:215]
  v_mfma_f32_16x16x32_bf16 v[216:219], a[184:187], v[188:191], v[216:219]
  v_mfma_f32_16x16x32_bf16 v[220:223], a[188:191], v[188:191], v[220:223]
  ds_write_b128 v13, v[192:195] offset:16384
  ds_write_b128 v13, v[196:199] offset:17408
  ds_write_b128 v13, v[200:203] offset:18432
  ds_write_b128 v13, v[204:207] offset:19456
  ds_write_b128 v13, v[208:211] offset:20480
  ds_write_b128 v13, v[212:215] offset:21504
  ds_write_b128 v13, v[216:219] offset:22528
  s_nop 0
  ds_write_b128 v13, v[220:223] offset:23552
  s_waitcnt lgkmcnt(0)
  s_barrier
  ds_read_b128 v[160:163], v12 offset:16384
  ds_read_b128 v[164:167], v12 offset:17408
  ds_read_b128 v[168:171], v12 offset:24576
  ds_read_b128 v[172:175], v12 offset:25600
  ds_read_b128 v[176:179], v12 offset:32768
  ds_read_b128 v[180:183], v12 offset:33792
  ds_read_b128 v[184:187], v12 offset:40960
  ds_read_b128 v[188:191], v12 offset:41984
  s_mov_b32 s47, 0xbfb8aa3b
  s_waitcnt lgkmcnt(4)
  v_add_f32 v160, v160, v168
  v_add_f32 v161, v161, v169
  v_add_f32 v162, v162, v170
  v_add_f32 v163, v163, v171
  v_add_f32 v164, v164, v172
  v_add_f32 v165, v165, v173
  v_add_f32 v166, v166, v174
  v_add_f32 v167, v167, v175
  s_waitcnt lgkmcnt(0)
  v_add_f32 v176, v176, v184
  v_add_f32 v177, v177, v185
  v_add_f32 v178, v178, v186
  v_add_f32 v179, v179, v187
  v_add_f32 v180, v180, v188
  v_add_f32 v181, v181, v189
  v_add_f32 v182, v182, v190
  v_add_f32 v183, v183, v191
  v_add_f32 v160, v160, v176
  v_add_f32 v161, v161, v177
  v_add_f32 v162, v162, v178
  v_add_f32 v163, v163, v179
  v_add_f32 v164, v164, v180
  v_add_f32 v165, v165, v181
  v_add_f32 v166, v166, v182
  v_add_f32 v167, v167, v183
  v_mul_f32 v168, s47, v160
  v_mul_f32 v169, s47, v161
  v_mul_f32 v170, s47, v162
  v_mul_f32 v171, s47, v163
  v_mul_f32 v172, s47, v164
  v_mul_f32 v173, s47, v165
  v_mul_f32 v174, s47, v166
  v_mul_f32 v175, s47, v167
  v_exp_f32 v168, v168
  v_exp_f32 v169, v169
  v_exp_f32 v170, v170
  v_exp_f32 v171, v171
  v_exp_f32 v172, v172
  v_exp_f32 v173, v173
  v_exp_f32 v174, v174
  v_exp_f32 v175, v175
  v_add_f32 v168, 1.0, v168
  v_add_f32 v169, 1.0, v169
  v_add_f32 v170, 1.0, v170
  v_add_f32 v171, 1.0, v171
  v_add_f32 v172, 1.0, v172
  v_add_f32 v173, 1.0, v173
  v_add_f32 v174, 1.0, v174
  v_add_f32 v175, 1.0, v175
  v_rcp_f32 v168, v168
  v_rcp_f32 v169, v169
  v_rcp_f32 v170, v170
  v_rcp_f32 v171, v171
  v_rcp_f32 v172, v172
  v_rcp_f32 v173, v173
  v_rcp_f32 v174, v174
  v_rcp_f32 v175, v175
  v_mul_f32 v160, v160, v168
  v_mul_f32 v161, v161, v169
  v_mul_f32 v162, v162, v170
  v_mul_f32 v163, v163, v171
  v_mul_f32 v164, v164, v172
  v_mul_f32 v165, v165, v173
  v_mul_f32 v166, v166, v174
  v_mul_f32 v167, v167, v175
  v_cvt_pk_bf16_f32 v176, v160, v161
  v_cvt_pk_bf16_f32 v177, v162, v163
  v_cvt_pk_bf16_f32 v178, v164, v165
  v_cvt_pk_bf16_f32 v179, v166, v167
  ds_write_b128 v12, v[176:179] offset:49152
  s_waitcnt lgkmcnt(0)
  s_barrier
  ds_read_b128 v[160:163], v1 offset:49152
  ds_read_b128 v[164:167], v1 offset:51200
  ds_read_b128 v[168:171], v1 offset:53248
  ds_read_b128 v[172:175], v1 offset:55296
  s_waitcnt lgkmcnt(3)
  v_mfma_f32_16x16x32_bf16 v[192:195], v[160:163], a[192:195], 0
  v_mfma_f32_16x16x32_bf16 v[196:199], v[160:163], a[196:199], 0
  v_mfma_f32_16x16x32_bf16 v[200:203], v[160:163], a[200:203], 0
  v_mfma_f32_16x16x32_bf16 v[204:207], v[160:163], a[204:207], 0
  v_mfma_f32_16x16x32_bf16 v[208:211], v[160:163], a[208:211], 0
  v_mfma_f32_16x16x32_bf16 v[212:215], v[160:163], a[212:215], 0
  v_mfma_f32_16x16x32_bf16 v[216:219], v[160:163], a[216:219], 0
  v_mfma_f32_16x16x32_bf16 v[220:223], v[160:163], a[220:223], 0
  s_waitcnt lgkmcnt(2)
  v_mfma_f32_16x16x32_bf16 v[192:195], v[164:167], a[224:227], v[192:195]
  v_mfma_f32_16x16x32_bf16 v[196:199], v[164:167], a[228:231], v[196:199]
  v_mfma_f32_16x16x32_bf16 v[200:203], v[164:167], a[232:235], v[200:203]
  v_mfma_f32_16x16x32_bf16 v[204:207], v[164:167], a[236:239], v[204:207]
  v_mfma_f32_16x16x32_bf16 v[208:211], v[164:167], a[240:243], v[208:211]
  v_mfma_f32_16x16x32_bf16 v[212:215], v[164:167], a[244:247], v[212:215]
  v_mfma_f32_16x16x32_bf16 v[216:219], v[164:167], a[248:251], v[216:219]
  v_mfma_f32_16x16x32_bf16 v[220:223], v[164:167], a[252:255], v[220:223]
  s_waitcnt lgkmcnt(1)
  v_mfma_f32_16x16x32_bf16 v[224:227], v[168:171], a[192:195], 0
  v_mfma_f32_16x16x32_bf16 v[228:231], v[168:171], a[196:199], 0
  v_mfma_f32_16x16x32_bf16 v[232:235], v[168:171], a[200:203], 0
  v_mfma_f32_16x16x32_bf16 v[236:239], v[168:171], a[204:207], 0
  v_mfma_f32_16x16x32_bf16 v[240:243], v[168:171], a[208:211], 0
  v_cvt_pk_bf16_f32 v112, v192, v196
  v_cvt_pk_bf16_f32 v113, v200, v204
  v_mfma_f32_16x16x32_bf16 v[244:247], v[168:171], a[212:215], 0
  v_cvt_pk_bf16_f32 v114, v208, v212
  v_cvt_pk_bf16_f32 v115, v216, v220
  s_add_u32 s47, s45, 0
  buffer_store_dwordx4 v[112:115], v6, s[4:7], s47 offen
  v_mfma_f32_16x16x32_bf16 v[248:251], v[168:171], a[216:219], 0
  v_cvt_pk_bf16_f32 v116, v193, v197
  v_cvt_pk_bf16_f32 v117, v201, v205
  v_mfma_f32_16x16x32_bf16 v[252:255], v[168:171], a[220:223], 0
  v_cvt_pk_bf16_f32 v118, v209, v213
  v_cvt_pk_bf16_f32 v119, v217, v221
  s_add_u32 s47, s45, 32768
  buffer_store_dwordx4 v[116:119], v6, s[4:7], s47 offen
  s_waitcnt lgkmcnt(0)
  v_mfma_f32_16x16x32_bf16 v[224:227], v[172:175], a[224:227], v[224:227]
  v_cvt_pk_bf16_f32 v120, v194, v198
  v_cvt_pk_bf16_f32 v121, v202, v206
  v_mfma_f32_16x16x32_bf16 v[228:231], v[172:175], a[228:231], v[228:231]
  v_cvt_pk_bf16_f32 v122, v210, v214
  v_cvt_pk_bf16_f32 v123, v218, v222
  s_add_u32 s47, s45, 65536
  buffer_store_dwordx4 v[120:123], v6, s[4:7], s47 offen
  v_mfma_f32_16x16x32_bf16 v[232:235], v[172:175], a[232:235], v[232:235]
  v_cvt_pk_bf16_f32 v124, v195, v199
  v_cvt_pk_bf16_f32 v125, v203, v207
  v_mfma_f32_16x16x32_bf16 v[236:239], v[172:175], a[236:239], v[236:239]
  v_cvt_pk_bf16_f32 v126, v211, v215
  v_cvt_pk_bf16_f32 v127, v219, v223
  s_add_u32 s47, s45, 98304
  buffer_store_dwordx4 v[124:127], v6, s[4:7], s47 offen
  v_mfma_f32_16x16x32_bf16 v[240:243], v[172:175], a[240:243], v[240:243]
  v_mfma_f32_16x16x32_bf16 v[244:247], v[172:175], a[244:247], v[244:247]
  v_mfma_f32_16x16x32_bf16 v[248:251], v[172:175], a[248:251], v[248:251]
  v_mfma_f32_16x16x32_bf16 v[252:255], v[172:175], a[252:255], v[252:255]
  v_cvt_pk_bf16_f32 v192, v224, v228
  v_cvt_pk_bf16_f32 v193, v232, v236
  s_nop 1
  v_cvt_pk_bf16_f32 v194, v240, v244
  s_nop 2
  v_cvt_pk_bf16_f32 v195, v248, v252
  s_add_u32 s47, s45, 524288
  buffer_store_dwordx4 v[192:195], v6, s[4:7], s47 offen
  v_cvt_pk_bf16_f32 v196, v225, v229
  v_cvt_pk_bf16_f32 v197, v233, v237
  v_cvt_pk_bf16_f32 v198, v241, v245
  v_cvt_pk_bf16_f32 v199, v249, v253
  s_add_u32 s47, s45, 557056
  buffer_store_dwordx4 v[196:199], v6, s[4:7], s47 offen
  v_cvt_pk_bf16_f32 v200, v226, v230
  v_cvt_pk_bf16_f32 v201, v234, v238
  v_cvt_pk_bf16_f32 v202, v242, v246
  v_cvt_pk_bf16_f32 v203, v250, v254
  s_add_u32 s47, s45, 589824
  buffer_store_dwordx4 v[200:203], v6, s[4:7], s47 offen
  v_cvt_pk_bf16_f32 v204, v227, v231
  v_cvt_pk_bf16_f32 v205, v235, v239
  v_cvt_pk_bf16_f32 v206, v243, v247
  v_cvt_pk_bf16_f32 v207, v251, v255
  s_add_u32 s47, s45, 622592
  buffer_store_dwordx4 v[204:207], v6, s[4:7], s47 offen
  v_mov_b32 v15, s36
  s_waitcnt vmcnt(0)
  buffer_store_dword v15, v2, s[4:7], 0 offen offset:1024
XP_NOF:
  s_mov_b32 s43, 0
  s_mov_b64 exec, 0xffffff
XP_C:
  buffer_load_dword v14, v3, s[4:7], 0 offen offset:1024 sc1
  s_add_u32 s43, s43, 1
  s_cmp_gt_u32 s43, 0x20000
  s_cbranch_scc1 KEND
  s_waitcnt vmcnt(0)
  v_cmp_gt_u32 vcc, s36, v14
  s_cbranch_vccnz XP_C
  s_mov_b64 exec, -1
  s_add_u32 s47, s45, 4096
  buffer_load_dwordx4 v[160:163], v7, s[4:7], s45 offen offset:0 sc1
  buffer_load_dwordx4 v[164:167], v7, s[4:7], s45 offen offset:1024 sc1
  buffer_load_dwordx4 v[168:171], v7, s[4:7], s45 offen offset:2048 sc1
  buffer_load_dwordx4 v[172:175], v7, s[4:7], s45 offen offset:3072 sc1
  buffer_load_dwordx4 v[176:179], v7, s[4:7], s47 offen offset:0 sc1
  buffer_load_dwordx4 v[180:183], v7, s[4:7], s47 offen offset:1024 sc1
  s_waitcnt vmcnt(5)
  v_mfma_f32_16x16x32_bf16 v[132:135], v[16:19], v[160:163], 0
  s_waitcnt vmcnt(4)
  v_mfma_f32_16x16x32_bf16 v[136:139], v[16:19], v[164:167], 0
  s_waitcnt vmcnt(3)
  v_mfma_f32_16x16x32_bf16 v[132:135], v[16:19], v[168:171], v[132:135]
  s_waitcnt vmcnt(2)
  v_mfma_f32_16x16x32_bf16 v[136:139], v[16:19], v[172:175], v[136:139]
  s_waitcnt vmcnt(1)
  v_mfma_f32_16x16x32_bf16 v[132:135], v[16:19], v[176:179], v[132:135]
  s_waitcnt vmcnt(0)
  v_mfma_f32_16x16x32_bf16 v[136:139], v[16:19], v[180:183], v[136:139]
  s_nop 7
  v_add_f32 v132, v132, v136
  v_add_f32 v133, v133, v137
  v_add_f32 v134, v134, v138
  v_add_f32 v135, v135, v139
  v_fmac_f32 v44, v40, v132
  v_fmac_f32 v45, v41, v133
  v_fmac_f32 v46, v42, v134
  v_fmac_f32 v47, v43, v135
  v_cvt_pk_bf16_f32 v132, v44, v45
  v_cvt_pk_bf16_f32 v133, v46, v47
  s_mov_b32 exec_hi, 0
  buffer_store_dwordx2 v[132:133], v9, s[24:27], s41 offen
  s_mov_b64 exec, -1
  s_add_u32 s41, s41, 0x20000
  s_cmp_lt_u32 s36, 16
  s_cbranch_scc1 XP_LOOP
  s_branch KEND
XS_LOOP:
  s_add_u32 s36, s36, 1
  s_waitcnt vmcnt(0)
  v_mfma_f32_16x16x32_bf16 v[132:135], v[64:67], v[48:51], v[20:23]
  v_mfma_f32_16x16x32_bf16 v[136:139], v[68:71], v[48:51], v[24:27]
  v_mfma_f32_16x16x32_bf16 v[132:135], v[72:75], v[52:55], v[132:135]
  v_mfma_f32_16x16x32_bf16 v[136:139], v[76:79], v[52:55], v[136:139]
  v_mfma_f32_16x16x32_bf16 v[132:135], v[80:83], v[56:59], v[132:135]
  v_mfma_f32_16x16x32_bf16 v[136:139], v[84:87], v[56:59], v[136:139]
  v_mfma_f32_16x16x32_bf16 v[132:135], v[88:91], v[60:63], v[132:135]
  v_mfma_f32_16x16x32_bf16 v[136:139], v[92:95], v[60:63], v[136:139]
  s_mov_b32 s43, 0
  s_mov_b64 exec, 0xffff
  s_branch XS_KE
XS_K:
  s_sleep 8
XS_KE:
  buffer_load_dword v14, v4, s[4:7], 0 offen sc1
  s_add_u32 s43, s43, 1
  s_cmp_gt_u32 s43, 0x20000
  s_cbranch_scc1 KEND
  s_waitcnt vmcnt(0)
  v_cmpx_lt_u32 vcc, v14, v5
  s_cbranch_vccnz XS_K
  s_mov_b64 exec, -1
  s_add_u32 s47, s40, 4096
  buffer_load_dwordx4 v[112:115], v1, s[4:7], s40 offen offset:0 sc1
  buffer_load_dwordx4 v[116:119], v1, s[4:7], s40 offen offset:2048 sc1
  buffer_load_dwordx4 v[120:123], v1, s[4:7], s47 offen offset:0 sc1
  buffer_load_dwordx4 v[124:127], v1, s[4:7], s47 offen offset:2048 sc1
  buffer_load_dwordx2 v[128:129], v11, s[4:7], s40 offen offset:1024 sc1
  buffer_load_dwordx2 v[130:131], v11, s[4:7], s40 offen offset:3072 sc1
  buffer_load_dwordx2 v[152:153], v9, s[20:23], s41 offen
  s_add_u32 s40, s40, 1048576
  v_add_u32 v5, 4, v5
  v_max3_f32 v14, v132, v133, v134
  v_max3_f32 v15, v135, v136, v137
  v_max3_f32 v14, v14, v138, v139
  v_max_f32 v14, v14, v15
  s_waitcnt vmcnt(6)
  v_mfma_f32_16x16x32_bf16 v[140:143], v[112:115], v[48:51], 0
  s_waitcnt vmcnt(5)
  v_mfma_f32_16x16x32_bf16 v[140:143], v[116:119], v[52:55], v[140:143]
  s_waitcnt vmcnt(4)
  v_mfma_f32_16x16x32_bf16 v[140:143], v[120:123], v[56:59], v[140:143]
  s_waitcnt vmcnt(3)
  v_mfma_f32_16x16x32_bf16 v[140:143], v[124:127], v[60:63], v[140:143]
  s_nop 7
  v_max3_f32 v14, v14, v140, v142
  v_mov_b32 v15, v14
  s_nop 1
  v_permlane16_swap_b32 v14, v15
  v_max_f32 v14, v14, v15
  v_mov_b32 v15, v14
  s_nop 1
  v_permlane32_swap_b32 v14, v15
  v_max_f32 v14, v14, v15
  v_mul_f32 v14, s42, v14
  v_fma_f32 v132, v132, s42, -v14
  v_fma_f32 v133, v133, s42, -v14
  v_fma_f32 v134, v134, s42, -v14
  v_fma_f32 v135, v135, s42, -v14
  v_fma_f32 v136, v136, s42, -v14
  v_fma_f32 v137, v137, s42, -v14
  v_fma_f32 v138, v138, s42, -v14
  v_fma_f32 v139, v139, s42, -v14
  v_fma_f32 v140, v140, s42, -v14
  v_fma_f32 v142, v142, s42, -v14
  v_exp_f32 v132, v132
  v_exp_f32 v133, v133
  v_exp_f32 v134, v134
  v_exp_f32 v135, v135
  v_exp_f32 v136, v136
  v_exp_f32 v137, v137
  v_exp_f32 v138, v138
  v_exp_f32 v139, v139
  v_exp_f32 v140, v140
  v_exp_f32 v142, v142
  v_cvt_pk_bf16_f32 v144, v132, v133
  v_cvt_pk_bf16_f32 v145, v134, v135
  v_cvt_pk_bf16_f32 v146, v136, v137
  v_cvt_pk_bf16_f32 v147, v138, v139
  v_cvt_pk_bf16_f32 v148, v140, v142
  v_mov_b32 v151, v148
  v_mfma_f32_16x16x32_bf16 v[192:195], v[96:99], v[144:147], 0
  v_mfma_f32_16x16x32_bf16 v[196:199], v[100:103], v[144:147], 0
  v_mfma_f32_16x16x32_bf16 v[200:203], v[104:107], v[144:147], 0
  v_mfma_f32_16x16x32_bf16 v[204:207], v[108:111], v[144:147], 0
  s_waitcnt vmcnt(1)
  v_mfma_f32_16x16x16_bf16 v[192:195], v[128:129], v[148:149], v[192:195]
  v_mfma_f32_16x16x16_bf16 v[196:199], v[128:129], v[150:151], v[196:199]
  v_mfma_f32_16x16x16_bf16 v[200:203], v[130:131], v[148:149], v[200:203]
  v_mfma_f32_16x16x16_bf16 v[204:207], v[130:131], v[150:151], v[204:207]
  v_add_f32 v14, v132, v133
  v_add_f32 v15, v134, v135
  v_add_f32 v14, v14, v136
  v_add_f32 v14, v14, v137
  v_add_f32 v14, v14, v138
  v_add_f32 v15, v15, v139
  v_add_f32 v15, v15, v140
  v_add_f32 v15, v15, v142
  v_add_f32 v14, v14, v15
  v_mov_b32 v15, v14
  s_nop 1
  v_permlane16_swap_b32 v14, v15
  v_add_f32 v14, v14, v15
  v_mov_b32 v15, v14
  s_nop 1
  v_permlane32_swap_b32 v14, v15
  v_add_f32 v14, v14, v15
  v_rcp_f32 v14, v14
  s_nop 0
  v_mul_f32 v192, v192, v14
  v_mul_f32 v193, v193, v14
  v_mul_f32 v194, v194, v14
  v_mul_f32 v195, v195, v14
  v_mul_f32 v196, v196, v14
  v_mul_f32 v197, v197, v14
  v_mul_f32 v198, v198, v14
  v_mul_f32 v199, v199, v14
  v_mul_f32 v200, v200, v14
  v_mul_f32 v201, v201, v14
  v_mul_f32 v202, v202, v14
  v_mul_f32 v203, v203, v14
  v_mul_f32 v204, v204, v14
  v_mul_f32 v205, v205, v14
  v_mul_f32 v206, v206, v14
  v_mul_f32 v207, v207, v14
  v_cvt_pk_bf16_f32 v208, v192, v193
  v_cvt_pk_bf16_f32 v209, v194, v195
  v_cvt_pk_bf16_f32 v210, v196, v197
  v_cvt_pk_bf16_f32 v211, v198, v199
  v_cvt_pk_bf16_f32 v212, v200, v201
  v_cvt_pk_bf16_f32 v213, v202, v203
  v_cvt_pk_bf16_f32 v214, v204, v205
  v_cvt_pk_bf16_f32 v215, v206, v207
  ds_write_b128 v12, v[208:211] offset:0
  ds_write_b128 v12, v[212:215] offset:1024
  s_waitcnt lgkmcnt(0)
  s_barrier
  ds_read_b128 v[160:163], v1 offset:0
  ds_read_b128 v[164:167], v1 offset:1024
  ds_read_b128 v[168:171], v1 offset:2048
  ds_read_b128 v[172:175], v1 offset:3072
  ds_read_b128 v[176:179], v1 offset:4096
  ds_read_b128 v[180:183], v1 offset:5120
  ds_read_b128 v[184:187], v1 offset:6144
  ds_read_b128 v[188:191], v1 offset:7168
  buffer_load_dwordx4 v[48:51], v10, s[4:7], s37 offen offset:0 sc1
  buffer_load_dwordx4 v[52:55], v10, s[4:7], s37 offen offset:2048 sc1
  s_add_u32 s47, s37, 4096
  buffer_load_dwordx4 v[56:59], v10, s[4:7], s47 offen offset:0 sc1
  buffer_load_dwordx4 v[60:63], v10, s[4:7], s47 offen offset:2048 sc1
  buffer_load_dwordx4 v[64:67], v1, s[4:7], s38 offen offset:0 sc1
  buffer_load_dwordx4 v[68:71], v1, s[4:7], s38 offen offset:1024 sc1
  buffer_load_dwordx4 v[72:75], v1, s[4:7], s38 offen offset:2048 sc1
  buffer_load_dwordx4 v[76:79], v1, s[4:7], s38 offen offset:3072 sc1
  s_add_u32 s47, s38, 4096
  buffer_load_dwordx4 v[80:83], v1, s[4:7], s47 offen offset:0 sc1
  buffer_load_dwordx4 v[84:87], v1, s[4:7], s47 offen offset:1024 sc1
  buffer_load_dwordx4 v[88:91], v1, s[4:7], s47 offen offset:2048 sc1
  buffer_load_dwordx4 v[92:95], v1, s[4:7], s47 offen offset:3072 sc1
  buffer_load_dwordx4 v[96:99], v11, s[4:7], s39 offen offset:0 sc1
  buffer_load_dwordx4 v[100:103], v11, s[4:7], s39 offen offset:1024 sc1
  buffer_load_dwordx4 v[104:107], v11, s[4:7], s39 offen offset:2048 sc1
  buffer_load_dwordx4 v[108:111], v11, s[4:7], s39 offen offset:3072 sc1
  s_add_u32 s37, s37, 1048576
  s_add_u32 s38, s38, 1048576
  s_add_u32 s39, s39, 1048576
  s_waitcnt lgkmcnt(7)
  v_mfma_f32_16x16x32_bf16 v[192:195], v[160:163], a[0:3], 0
  v_mfma_f32_16x16x32_bf16 v[196:199], v[160:163], a[4:7], 0
  v_mfma_f32_16x16x32_bf16 v[200:203], v[160:163], a[8:11], 0
  v_mfma_f32_16x16x32_bf16 v[204:207], v[160:163], a[12:15], 0
  v_mfma_f32_16x16x32_bf16 v[208:211], v[160:163], a[16:19], 0
  v_mfma_f32_16x16x32_bf16 v[212:215], v[160:163], a[20:23], 0
  v_mfma_f32_16x16x32_bf16 v[216:219], v[160:163], a[24:27], 0
  v_mfma_f32_16x16x32_bf16 v[220:223], v[160:163], a[28:31], 0
  s_waitcnt lgkmcnt(6)
  v_mfma_f32_16x16x32_bf16 v[192:195], v[164:167], a[32:35], v[192:195]
  v_mfma_f32_16x16x32_bf16 v[196:199], v[164:167], a[36:39], v[196:199]
  v_mfma_f32_16x16x32_bf16 v[200:203], v[164:167], a[40:43], v[200:203]
  v_mfma_f32_16x16x32_bf16 v[204:207], v[164:167], a[44:47], v[204:207]
  v_mfma_f32_16x16x32_bf16 v[208:211], v[164:167], a[48:51], v[208:211]
  v_mfma_f32_16x16x32_bf16 v[212:215], v[164:167], a[52:55], v[212:215]
  v_mfma_f32_16x16x32_bf16 v[216:219], v[164:167], a[56:59], v[216:219]
  v_mfma_f32_16x16x32_bf16 v[220:223], v[164:167], a[60:63], v[220:223]
  s_waitcnt lgkmcnt(5)
  v_mfma_f32_16x16x32_bf16 v[192:195], v[168:171], a[64:67], v[192:195]
  v_mfma_f32_16x16x32_bf16 v[196:199], v[168:171], a[68:71], v[196:199]
  v_mfma_f32_16x16x32_bf16 v[200:203], v[168:171], a[72:75], v[200:203]
  v_mfma_f32_16x16x32_bf16 v[204:207], v[168:171], a[76:79], v[204:207]
  v_mfma_f32_16x16x32_bf16 v[208:211], v[168:171], a[80:83], v[208:211]
  v_mfma_f32_16x16x32_bf16 v[212:215], v[168:171], a[84:87], v[212:215]
  v_mfma_f32_16x16x32_bf16 v[216:219], v[168:171], a[88:91], v[216:219]
  v_mfma_f32_16x16x32_bf16 v[220:223], v[168:171], a[92:95], v[220:223]
  s_waitcnt lgkmcnt(4)
  v_mfma_f32_16x16x32_bf16 v[192:195], v[172:175], a[96:99], v[192:195]
  v_mfma_f32_16x16x32_bf16 v[196:199], v[172:175], a[100:103], v[196:199]
  v_mfma_f32_16x16x32_bf16 v[200:203], v[172:175], a[104:107], v[200:203]
  v_mfma_f32_16x16x32_bf16 v[204:207], v[172:175], a[108:111], v[204:207]
  v_mfma_f32_16x16x32_bf16 v[208:211], v[172:175], a[112:115], v[208:211]
  v_mfma_f32_16x16x32_bf16 v[212:215], v[172:175], a[116:119], v[212:215]
  v_mfma_f32_16x16x32_bf16 v[216:219], v[172:175], a[120:123], v[216:219]
  v_mfma_f32_16x16x32_bf16 v[220:223], v[172:175], a[124:127], v[220:223]
  s_waitcnt lgkmcnt(3)
  v_mfma_f32_16x16x32_bf16 v[224:227], v[176:179], a[0:3], 0
  v_mfma_f32_16x16x32_bf16 v[228:231], v[176:179], a[4:7], 0
  v_mfma_f32_16x16x32_bf16 v[232:235], v[176:179], a[8:11], 0
  v_mfma_f32_16x16x32_bf16 v[236:239], v[176:179], a[12:15], 0
  v_mfma_f32_16x16x32_bf16 v[240:243], v[176:179], a[16:19], 0
  v_cvt_pk_bf16_f32 v112, v192, v196
  v_cvt_pk_bf16_f32 v113, v200, v204
  v_mfma_f32_16x16x32_bf16 v[244:247], v[176:179], a[20:23], 0
  v_cvt_pk_bf16_f32 v114, v208, v212
  v_cvt_pk_bf16_f32 v115, v216, v220
  s_add_u32 s47, s44, 0
  buffer_store_dwordx4 v[112:115], v6, s[4:7], s47 offen sc1
  v_mfma_f32_16x16x32_bf16 v[248:251], v[176:179], a[24:27], 0
  v_cvt_pk_bf16_f32 v116, v193, v197
  v_cvt_pk_bf16_f32 v117, v201, v205
  v_mfma_f32_16x16x32_bf16 v[252:255], v[176:179], a[28:31], 0
  v_cvt_pk_bf16_f32 v118, v209, v213
  v_cvt_pk_bf16_f32 v119, v217, v221
  s_add_u32 s47, s44, 32768
  buffer_store_dwordx4 v[116:119], v6, s[4:7], s47 offen sc1
  s_waitcnt lgkmcnt(2)
  v_mfma_f32_16x16x32_bf16 v[224:227], v[180:183], a[32:35], v[224:227]
  v_cvt_pk_bf16_f32 v120, v194, v198
  v_cvt_pk_bf16_f32 v121, v202, v206
  v_mfma_f32_16x16x32_bf16 v[228:231], v[180:183], a[36:39], v[228:231]
  v_cvt_pk_bf16_f32 v122, v210, v214
  v_cvt_pk_bf16_f32 v123, v218, v222
  s_add_u32 s47, s44, 65536
  buffer_store_dwordx4 v[120:123], v6, s[4:7], s47 offen sc1
  v_mfma_f32_16x16x32_bf16 v[232:235], v[180:183], a[40:43], v[232:235]
  v_cvt_pk_bf16_f32 v124, v195, v199
  v_cvt_pk_bf16_f32 v125, v203, v207
  v_mfma_f32_16x16x32_bf16 v[236:239], v[180:183], a[44:47], v[236:239]
  v_cvt_pk_bf16_f32 v126, v211, v215
  v_cvt_pk_bf16_f32 v127, v219, v223
  s_add_u32 s47, s44, 98304
  buffer_store_dwordx4 v[124:127], v6, s[4:7], s47 offen sc1
  v_mfma_f32_16x16x32_bf16 v[240:243], v[180:183], a[48:51], v[240:243]
  v_mfma_f32_16x16x32_bf16 v[244:247], v[180:183], a[52:55], v[244:247]
  v_mfma_f32_16x16x32_bf16 v[248:251], v[180:183], a[56:59], v[248:251]
  v_mfma_f32_16x16x32_bf16 v[252:255], v[180:183], a[60:63], v[252:255]
  s_waitcnt lgkmcnt(1)
  v_mfma_f32_16x16x32_bf16 v[224:227], v[184:187], a[64:67], v[224:227]
  v_mfma_f32_16x16x32_bf16 v[228:231], v[184:187], a[68:71], v[228:231]
  v_mfma_f32_16x16x32_bf16 v[232:235], v[184:187], a[72:75], v[232:235]
  v_mfma_f32_16x16x32_bf16 v[236:239], v[184:187], a[76:79], v[236:239]
  v_mfma_f32_16x16x32_bf16 v[240:243], v[184:187], a[80:83], v[240:243]
  v_mfma_f32_16x16x32_bf16 v[244:247], v[184:187], a[84:87], v[244:247]
  v_mfma_f32_16x16x32_bf16 v[248:251], v[184:187], a[88:91], v[248:251]
  v_mfma_f32_16x16x32_bf16 v[252:255], v[184:187], a[92:95], v[252:255]
  s_waitcnt lgkmcnt(0)
  v_mfma_f32_16x16x32_bf16 v[224:227], v[188:191], a[96:99], v[224:227]
  v_mfma_f32_16x16x32_bf16 v[228:231], v[188:191], a[100:103], v[228:231]
  v_mfma_f32_16x16x32_bf16 v[232:235], v[188:191], a[104:107], v[232:235]
  v_mfma_f32_16x16x32_bf16 v[236:239], v[188:191], a[108:111], v[236:239]
  v_mfma_f32_16x16x32_bf16 v[240:243], v[188:191], a[112:115], v[240:243]
  v_mfma_f32_16x16x32_bf16 v[244:247], v[188:191], a[116:119], v[244:247]
  v_mfma_f32_16x16x32_bf16 v[248:251], v[188:191], a[120:123], v[248:251]
  v_mfma_f32_16x16x32_bf16 v[252:255], v[188:191], a[124:127], v[252:255]
  v_cvt_pk_bf16_f32 v192, v224, v228
  v_cvt_pk_bf16_f32 v193, v232, v236
  s_nop 1
  v_cvt_pk_bf16_f32 v194, v240, v244
  s_nop 2
  v_cvt_pk_bf16_f32 v195, v248, v252
  s_add_u32 s47, s44, 524288
  buffer_store_dwordx4 v[192:195], v6, s[4:7], s47 offen sc1
  v_cvt_pk_bf16_f32 v196, v225, v229
  v_cvt_pk_bf16_f32 v197, v233, v237
  v_cvt_pk_bf16_f32 v198, v241, v245
  v_cvt_pk_bf16_f32 v199, v249, v253
  s_add_u32 s47, s44, 557056
  buffer_store_dwordx4 v[196:199], v6, s[4:7], s47 offen sc1
  v_cvt_pk_bf16_f32 v200, v226, v230
  v_cvt_pk_bf16_f32 v201, v234, v238
  v_cvt_pk_bf16_f32 v202, v242, v246
  v_cvt_pk_bf16_f32 v203, v250, v254
  s_add_u32 s47, s44, 589824
  buffer_store_dwordx4 v[200:203], v6, s[4:7], s47 offen sc1
  v_cvt_pk_bf16_f32 v204, v227, v231
  v_cvt_pk_bf16_f32 v205, v235, v239
  v_cvt_pk_bf16_f32 v206, v243, v247
  v_cvt_pk_bf16_f32 v207, v251, v255
  s_add_u32 s47, s44, 622592
  buffer_store_dwordx4 v[204:207], v6, s[4:7], s47 offen sc1
  v_mov_b32 v15, s36
  s_waitcnt vmcnt(0)
  buffer_store_dword v15, v2, s[4:7], 0 offen offset:0 sc1
  v_lshlrev_b32 v44, 16, v152
  v_and_b32 v45, 0xffff0000, v152
  v_lshlrev_b32 v46, 16, v153
  v_and_b32 v47, 0xffff0000, v153
  s_mov_b32 s43, 0
  s_mov_b32 exec_hi, 0
XS_A:
  buffer_load_dword v14, v3, s[4:7], 0 offen offset:0 sc1
  s_add_u32 s43, s43, 1
  s_cmp_gt_u32 s43, 0x20000
  s_cbranch_scc1 KEND
  s_waitcnt vmcnt(0)
  v_cmp_gt_u32 vcc, s36, v14
  s_cbranch_vccnz XS_A
  s_mov_b64 exec, -1
  s_add_u32 s47, s44, 4096
  buffer_load_dwordx4 v[160:163], v7, s[4:7], s44 offen offset:0 sc1
  buffer_load_dwordx4 v[164:167], v7, s[4:7], s44 offen offset:1024 sc1
  buffer_load_dwordx4 v[168:171], v7, s[4:7], s44 offen offset:2048 sc1
  buffer_load_dwordx4 v[172:175], v7, s[4:7], s44 offen offset:3072 sc1
  buffer_load_dwordx4 v[176:179], v7, s[4:7], s47 offen offset:0 sc1
  buffer_load_dwordx4 v[180:183], v7, s[4:7], s47 offen offset:1024 sc1
  buffer_load_dwordx4 v[184:187], v7, s[4:7], s47 offen offset:2048 sc1
  buffer_load_dwordx4 v[188:191], v7, s[4:7], s47 offen offset:3072 sc1
  s_waitcnt vmcnt(7)
  v_mfma_f32_16x16x32_bf16 v[132:135], v[16:19], v[160:163], 0
  s_waitcnt vmcnt(6)
  v_mfma_f32_16x16x32_bf16 v[136:139], v[16:19], v[164:167], 0
  s_waitcnt vmcnt(5)
  v_mfma_f32_16x16x32_bf16 v[132:135], v[16:19], v[168:171], v[132:135]
  s_waitcnt vmcnt(4)
  v_mfma_f32_16x16x32_bf16 v[136:139], v[16:19], v[172:175], v[136:139]
  s_waitcnt vmcnt(3)
  v_mfma_f32_16x16x32_bf16 v[132:135], v[16:19], v[176:179], v[132:135]
  s_waitcnt vmcnt(2)
  v_mfma_f32_16x16x32_bf16 v[136:139], v[16:19], v[180:183], v[136:139]
  s_waitcnt vmcnt(1)
  v_mfma_f32_16x16x32_bf16 v[132:135], v[16:19], v[184:187], v[132:135]
  s_waitcnt vmcnt(0)
  v_mfma_f32_16x16x32_bf16 v[136:139], v[16:19], v[188:191], v[136:139]
  s_nop 7
  v_add_f32 v132, v132, v136
  v_add_f32 v133, v133, v137
  v_add_f32 v134, v134, v138
  v_add_f32 v135, v135, v139
  v_fmac_f32 v44, v28, v132
  v_fmac_f32 v45, v29, v133
  v_fmac_f32 v46, v30, v134
  v_fmac_f32 v47, v31, v135
  v_add_f32 v132, v44, v45
  v_mul_f32 v133, v44, v44
  v_add_f32 v132, v132, v46
  v_fmac_f32 v133, v45, v45
  v_add_f32 v132, v132, v47
  v_fmac_f32 v133, v46, v46
  v_fmac_f32 v133, v47, v47
  v_add_f32_dpp v132, v132, v132 row_ror:8 row_mask:0xf bank_mask:0xf
  s_nop 0
  v_add_f32_dpp v133, v133, v133 row_ror:8 row_mask:0xf bank_mask:0xf
  v_add_f32_dpp v132, v132, v132 row_ror:4 row_mask:0xf bank_mask:0xf
  s_nop 0
  v_add_f32_dpp v133, v133, v133 row_ror:4 row_mask:0xf bank_mask:0xf
  v_add_f32_dpp v132, v132, v132 row_ror:2 row_mask:0xf bank_mask:0xf
  s_nop 0
  v_add_f32_dpp v133, v133, v133 row_ror:2 row_mask:0xf bank_mask:0xf
  v_add_f32_dpp v132, v132, v132 row_ror:1 row_mask:0xf bank_mask:0xf
  s_nop 0
  v_add_f32_dpp v133, v133, v133 row_ror:1 row_mask:0xf bank_mask:0xf
  v_lshrrev_b32 v15, 4, v0
  v_lshlrev_b32 v15, 3, v15
  v_mov_b32 v14, 0
  ds_write_b64 v15, v[132:133] offset:8192
  s_waitcnt lgkmcnt(0)
  s_barrier
  ds_read_b128 v[160:163], v14 offset:8192
  ds_read_b128 v[164:167], v14 offset:8224
  ds_read_b128 v[168:171], v14 offset:8256
  ds_read_b128 v[172:175], v14 offset:8288
  s_waitcnt lgkmcnt(0)
  v_add_f32 v160, v160, v162
  v_add_f32 v164, v164, v166
  v_add_f32 v168, v168, v170
  v_add_f32 v172, v172, v174
  v_add_f32 v161, v161, v163
  v_add_f32 v165, v165, v167
  v_add_f32 v169, v169, v171
  v_add_f32 v173, v173, v175
  v_add_f32 v160, v160, v164
  v_add_f32 v168, v168, v172
  v_add_f32 v161, v161, v165
  v_add_f32 v169, v169, v173
  v_add_f32 v132, v160, v168
  v_add_f32 v133, v161, v169
  v_mul_f32 v132, 0x3b000000, v132
  v_mul_f32 v133, 0x3b000000, v133
  v_fma_f32 v133, -v132, v132, v133
  v_max_f32 v133, 0, v133
  v_add_f32 v133, 0x3727c5ac, v133
  v_rsq_f32 v133, v133
  v_sub_f32 v136, v44, v132
  v_sub_f32 v137, v45, v132
  v_sub_f32 v138, v46, v132
  v_sub_f32 v139, v47, v132
  v_mul_f32 v136, v136, v133
  v_mul_f32 v137, v137, v133
  v_mul_f32 v138, v138, v133
  v_mul_f32 v139, v139, v133
  v_fma_f32 v136, v136, v36, v32
  v_fma_f32 v137, v137, v37, v33
  v_fma_f32 v138, v138, v38, v34
  v_fma_f32 v139, v139, v39, v35
  v_cvt_pk_bf16_f32 v132, v136, v137
  v_cvt_pk_bf16_f32 v133, v138, v139
  buffer_store_dwordx2 v[132:133], v8, s[4:7], s46 offen sc1
  v_mov_b32 v15, s36
  s_waitcnt vmcnt(0)
  buffer_store_dword v15, v2, s[4:7], 0 offen offset:512 sc1
  s_cmp_ge_u32 s16, 24
  s_cbranch_scc1 XS_NOF
  s_mov_b32 s43, 0
  s_mov_b32 exec_hi, 0
XS_B:
  buffer_load_dword v14, v3, s[4:7], 0 offen offset:512 sc1
  s_add_u32 s43, s43, 1
  s_cmp_gt_u32 s43, 0x20000
  s_cbranch_scc1 KEND
  s_waitcnt vmcnt(0)
  v_cmp_gt_u32 vcc, s36, v14
  s_cbranch_vccnz XS_B
  s_mov_b64 exec, -1
  s_add_u32 s47, s46, 4096
  buffer_load_dwordx4 v[160:163], v13, s[4:7], s46 offen offset:0 sc1
  buffer_load_dwordx4 v[164:167], v13, s[4:7], s46 offen offset:1024 sc1
  buffer_load_dwordx4 v[168:171], v13, s[4:7], s46 offen offset:2048 sc1
  buffer_load_dwordx4 v[172:175], v13, s[4:7], s46 offen offset:3072 sc1
  buffer_load_dwordx4 v[176:179], v13, s[4:7], s47 offen offset:0 sc1
  buffer_load_dwordx4 v[180:183], v13, s[4:7], s47 offen offset:1024 sc1
  buffer_load_dwordx4 v[184:187], v13, s[4:7], s47 offen offset:2048 sc1
  buffer_load_dwordx4 v[188:191], v13, s[4:7], s47 offen offset:3072 sc1
  s_waitcnt vmcnt(7)
  v_mfma_f32_16x16x32_bf16 v[192:195], a[128:131], v[160:163], 0
  v_mfma_f32_16x16x32_bf16 v[196:199], a[132:135], v[160:163], 0
  v_mfma_f32_16x16x32_bf16 v[200:203], a[136:139], v[160:163], 0
  v_mfma_f32_16x16x32_bf16 v[204:207], a[140:143], v[160:163], 0
  s_waitcnt vmcnt(6)
  v_mfma_f32_16x16x32_bf16 v[208:211], a[128:131], v[164:167], 0
  v_mfma_f32_16x16x32_bf16 v[212:215], a[132:135], v[164:167], 0
  v_mfma_f32_16x16x32_bf16 v[216:219], a[136:139], v[164:167], 0
  v_mfma_f32_16x16x32_bf16 v[220:223], a[140:143], v[164:167], 0
  s_waitcnt vmcnt(5)
  v_mfma_f32_16x16x32_bf16 v[192:195], a[144:147], v[168:171], v[192:195]
  v_mfma_f32_16x16x32_bf16 v[196:199], a[148:151], v[168:171], v[196:199]
  v_mfma_f32_16x16x32_bf16 v[200:203], a[152:155], v[168:171], v[200:203]
  v_mfma_f32_16x16x32_bf16 v[204:207], a[156:159], v[168:171], v[204:207]
  s_waitcnt vmcnt(4)
  v_mfma_f32_16x16x32_bf16 v[208:211], a[144:147], v[172:175], v[208:211]
  v_mfma_f32_16x16x32_bf16 v[212:215], a[148:151], v[172:175], v[212:215]
  v_mfma_f32_16x16x32_bf16 v[216:219], a[152:155], v[172:175], v[216:219]
  v_mfma_f32_16x16x32_bf16 v[220:223], a[156:159], v[172:175], v[220:223]
  s_waitcnt vmcnt(3)
  v_mfma_f32_16x16x32_bf16 v[192:195], a[160:163], v[176:179], v[192:195]
  v_mfma_f32_16x16x32_bf16 v[196:199], a[164:167], v[176:179], v[196:199]
  v_mfma_f32_16x16x32_bf16 v[200:203], a[168:171], v[176:179], v[200:203]
  v_mfma_f32_16x16x32_bf16 v[204:207], a[172:175], v[176:179], v[204:207]
  s_waitcnt vmcnt(2)
  v_mfma_f32_16x16x32_bf16 v[208:211], a[160:163], v[180:183], v[208:211]
  v_mfma_f32_16x16x32_bf16 v[212:215], a[164:167], v[180:183], v[212:215]
  v_mfma_f32_16x16x32_bf16 v[216:219], a[168:171], v[180:183], v[216:219]
  v_mfma_f32_16x16x32_bf16 v[220:223], a[172:175], v[180:183], v[220:223]
  s_waitcnt vmcnt(1)
  v_mfma_f32_16x16x32_bf16 v[192:195], a[176:179], v[184:187], v[192:195]
  v_mfma_f32_16x16x32_bf16 v[196:199], a[180:183], v[184:187], v[196:199]
  v_mfma_f32_16x16x32_bf16 v[200:203], a[184:187], v[184:187], v[200:203]
  v_mfma_f32_16x16x32_bf16 v[204:207], a[188:191], v[184:187], v[204:207]
  s_waitcnt vmcnt(0)
  v_mfma_f32_16x16x32_bf16 v[208:211], a[176:179], v[188:191], v[208:211]
  v_mfma_f32_16x16x32_bf16 v[212:215], a[180:183], v[188:191], v[212:215]
  v_mfma_f32_16x16x32_bf16 v[216:219], a[184:187], v[188:191], v[216:219]
  v_mfma_f32_16x16x32_bf16 v[220:223], a[188:191], v[188:191], v[220:223]
  ds_write_b128 v13, v[192:195] offset:16384
  ds_write_b128 v13, v[196:199] offset:17408
  ds_write_b128 v13, v[200:203] offset:18432
  ds_write_b128 v13, v[204:207] offset:19456
  ds_write_b128 v13, v[208:211] offset:20480
  ds_write_b128 v13, v[212:215] offset:21504
  ds_write_b128 v13, v[216:219] offset:22528
  s_nop 0
  ds_write_b128 v13, v[220:223] offset:23552
  s_waitcnt lgkmcnt(0)
  s_barrier
  ds_read_b128 v[160:163], v12 offset:16384
  ds_read_b128 v[164:167], v12 offset:17408
  ds_read_b128 v[168:171], v12 offset:24576
  ds_read_b128 v[172:175], v12 offset:25600
  ds_read_b128 v[176:179], v12 offset:32768
  ds_read_b128 v[180:183], v12 offset:33792
  ds_read_b128 v[184:187], v12 offset:40960
  ds_read_b128 v[188:191], v12 offset:41984
  s_mov_b32 s47, 0xbfb8aa3b
  s_waitcnt lgkmcnt(4)
  v_add_f32 v160, v160, v168
  v_add_f32 v161, v161, v169
  v_add_f32 v162, v162, v170
  v_add_f32 v163, v163, v171
  v_add_f32 v164, v164, v172
  v_add_f32 v165, v165, v173
  v_add_f32 v166, v166, v174
  v_add_f32 v167, v167, v175
  s_waitcnt lgkmcnt(0)
  v_add_f32 v176, v176, v184
  v_add_f32 v177, v177, v185
  v_add_f32 v178, v178, v186
  v_add_f32 v179, v179, v187
  v_add_f32 v180, v180, v188
  v_add_f32 v181, v181, v189
  v_add_f32 v182, v182, v190
  v_add_f32 v183, v183, v191
  v_add_f32 v160, v160, v176
  v_add_f32 v161, v161, v177
  v_add_f32 v162, v162, v178
  v_add_f32 v163, v163, v179
  v_add_f32 v164, v164, v180
  v_add_f32 v165, v165, v181
  v_add_f32 v166, v166, v182
  v_add_f32 v167, v167, v183
  v_mul_f32 v168, s47, v160
  v_mul_f32 v169, s47, v161
  v_mul_f32 v170, s47, v162
  v_mul_f32 v171, s47, v163
  v_mul_f32 v172, s47, v164
  v_mul_f32 v173, s47, v165
  v_mul_f32 v174, s47, v166
  v_mul_f32 v175, s47, v167
  v_exp_f32 v168, v168
  v_exp_f32 v169, v169
  v_exp_f32 v170, v170
  v_exp_f32 v171, v171
  v_exp_f32 v172, v172
  v_exp_f32 v173, v173
  v_exp_f32 v174, v174
  v_exp_f32 v175, v175
  v_add_f32 v168, 1.0, v168
  v_add_f32 v169, 1.0, v169
  v_add_f32 v170, 1.0, v170
  v_add_f32 v171, 1.0, v171
  v_add_f32 v172, 1.0, v172
  v_add_f32 v173, 1.0, v173
  v_add_f32 v174, 1.0, v174
  v_add_f32 v175, 1.0, v175
  v_rcp_f32 v168, v168
  v_rcp_f32 v169, v169
  v_rcp_f32 v170, v170
  v_rcp_f32 v171, v171
  v_rcp_f32 v172, v172
  v_rcp_f32 v173, v173
  v_rcp_f32 v174, v174
  v_rcp_f32 v175, v175
  v_mul_f32 v160, v160, v168
  v_mul_f32 v161, v161, v169
  v_mul_f32 v162, v162, v170
  v_mul_f32 v163, v163, v171
  v_mul_f32 v164, v164, v172
  v_mul_f32 v165, v165, v173
  v_mul_f32 v166, v166, v174
  v_mul_f32 v167, v167, v175
  v_cvt_pk_bf16_f32 v176, v160, v161
  v_cvt_pk_bf16_f32 v177, v162, v163
  v_cvt_pk_bf16_f32 v178, v164, v165
  v_cvt_pk_bf16_f32 v179, v166, v167
  ds_write_b128 v12, v[176:179] offset:49152
  s_waitcnt lgkmcnt(0)
  s_barrier
  ds_read_b128 v[160:163], v1 offset:49152
  ds_read_b128 v[164:167], v1 offset:51200
  ds_read_b128 v[168:171], v1 offset:53248
  ds_read_b128 v[172:175], v1 offset:55296
  s_waitcnt lgkmcnt(3)
  v_mfma_f32_16x16x32_bf16 v[192:195], v[160:163], a[192:195], 0
  v_mfma_f32_16x16x32_bf16 v[196:199], v[160:163], a[196:199], 0
  v_mfma_f32_16x16x32_bf16 v[200:203], v[160:163], a[200:203], 0
  v_mfma_f32_16x16x32_bf16 v[204:207], v[160:163], a[204:207], 0
  v_mfma_f32_16x16x32_bf16 v[208:211], v[160:163], a[208:211], 0
  v_mfma_f32_16x16x32_bf16 v[212:215], v[160:163], a[212:215], 0
  v_mfma_f32_16x16x32_bf16 v[216:219], v[160:163], a[216:219], 0
  v_mfma_f32_16x16x32_bf16 v[220:223], v[160:163], a[220:223], 0
  s_waitcnt lgkmcnt(2)
  v_mfma_f32_16x16x32_bf16 v[192:195], v[164:167], a[224:227], v[192:195]
  v_mfma_f32_16x16x32_bf16 v[196:199], v[164:167], a[228:231], v[196:199]
  v_mfma_f32_16x16x32_bf16 v[200:203], v[164:167], a[232:235], v[200:203]
  v_mfma_f32_16x16x32_bf16 v[204:207], v[164:167], a[236:239], v[204:207]
  v_mfma_f32_16x16x32_bf16 v[208:211], v[164:167], a[240:243], v[208:211]
  v_mfma_f32_16x16x32_bf16 v[212:215], v[164:167], a[244:247], v[212:215]
  v_mfma_f32_16x16x32_bf16 v[216:219], v[164:167], a[248:251], v[216:219]
  v_mfma_f32_16x16x32_bf16 v[220:223], v[164:167], a[252:255], v[220:223]
  s_waitcnt lgkmcnt(1)
  v_mfma_f32_16x16x32_bf16 v[224:227], v[168:171], a[192:195], 0
  v_mfma_f32_16x16x32_bf16 v[228:231], v[168:171], a[196:199], 0
  v_mfma_f32_16x16x32_bf16 v[232:235], v[168:171], a[200:203], 0
  v_mfma_f32_16x16x32_bf16 v[236:239], v[168:171], a[204:207], 0
  v_mfma_f32_16x16x32_bf16 v[240:243], v[168:171], a[208:211], 0
  v_cvt_pk_bf16_f32 v112, v192, v196
  v_cvt_pk_bf16_f32 v113, v200, v204
  v_mfma_f32_16x16x32_bf16 v[244:247], v[168:171], a[212:215], 0
  v_cvt_pk_bf16_f32 v114, v208, v212
  v_cvt_pk_bf16_f32 v115, v216, v220
  s_add_u32 s47, s45, 0
  buffer_store_dwordx4 v[112:115], v6, s[4:7], s47 offen sc1
  v_mfma_f32_16x16x32_bf16 v[248:251], v[168:171], a[216:219], 0
  v_cvt_pk_bf16_f32 v116, v193, v197
  v_cvt_pk_bf16_f32 v117, v201, v205
  v_mfma_f32_16x16x32_bf16 v[252:255], v[168:171], a[220:223], 0
  v_cvt_pk_bf16_f32 v118, v209, v213
  v_cvt_pk_bf16_f32 v119, v217, v221
  s_add_u32 s47, s45, 32768
  buffer_store_dwordx4 v[116:119], v6, s[4:7], s47 offen sc1
  s_waitcnt lgkmcnt(0)
  v_mfma_f32_16x16x32_bf16 v[224:227], v[172:175], a[224:227], v[224:227]
  v_cvt_pk_bf16_f32 v120, v194, v198
  v_cvt_pk_bf16_f32 v121, v202, v206
  v_mfma_f32_16x16x32_bf16 v[228:231], v[172:175], a[228:231], v[228:231]
  v_cvt_pk_bf16_f32 v122, v210, v214
  v_cvt_pk_bf16_f32 v123, v218, v222
  s_add_u32 s47, s45, 65536
  buffer_store_dwordx4 v[120:123], v6, s[4:7], s47 offen sc1
  v_mfma_f32_16x16x32_bf16 v[232:235], v[172:175], a[232:235], v[232:235]
  v_cvt_pk_bf16_f32 v124, v195, v199
  v_cvt_pk_bf16_f32 v125, v203, v207
  v_mfma_f32_16x16x32_bf16 v[236:239], v[172:175], a[236:239], v[236:239]
  v_cvt_pk_bf16_f32 v126, v211, v215
  v_cvt_pk_bf16_f32 v127, v219, v223
  s_add_u32 s47, s45, 98304
  buffer_store_dwordx4 v[124:127], v6, s[4:7], s47 offen sc1
  v_mfma_f32_16x16x32_bf16 v[240:243], v[172:175], a[240:243], v[240:243]
  v_mfma_f32_16x16x32_bf16 v[244:247], v[172:175], a[244:247], v[244:247]
  v_mfma_f32_16x16x32_bf16 v[248:251], v[172:175], a[248:251], v[248:251]
  v_mfma_f32_16x16x32_bf16 v[252:255], v[172:175], a[252:255], v[252:255]
  v_cvt_pk_bf16_f32 v192, v224, v228
  v_cvt_pk_bf16_f32 v193, v232, v236
  s_nop 1
  v_cvt_pk_bf16_f32 v194, v240, v244
  s_nop 2
  v_cvt_pk_bf16_f32 v195, v248, v252
  s_add_u32 s47, s45, 524288
  buffer_store_dwordx4 v[192:195], v6, s[4:7], s47 offen sc1
  v_cvt_pk_bf16_f32 v196, v225, v229
  v_cvt_pk_bf16_f32 v197, v233, v237
  v_cvt_pk_bf16_f32 v198, v241, v245
  v_cvt_pk_bf16_f32 v199, v249, v253
  s_add_u32 s47, s45, 557056
  buffer_store_dwordx4 v[196:199], v6, s[4:7], s47 offen sc1
  v_cvt_pk_bf16_f32 v200, v226, v230
  v_cvt_pk_bf16_f32 v201, v234, v238
  v_cvt_pk_bf16_f32 v202, v242, v246
  v_cvt_pk_bf16_f32 v203, v250, v254
  s_add_u32 s47, s45, 589824
  buffer_store_dwordx4 v[200:203], v6, s[4:7], s47 offen sc1
  v_cvt_pk_bf16_f32 v204, v227, v231
  v_cvt_pk_bf16_f32 v205, v235, v239
  v_cvt_pk_bf16_f32 v206, v243, v247
  v_cvt_pk_bf16_f32 v207, v251, v255
  s_add_u32 s47, s45, 622592
  buffer_store_dwordx4 v[204:207], v6, s[4:7], s47 offen sc1
  v_mov_b32 v15, s36
  s_waitcnt vmcnt(0)
  buffer_store_dword v15, v2, s[4:7], 0 offen offset:1024 sc1
XS_NOF:
  s_mov_b32 s43, 0
  s_mov_b64 exec, 0xffffff
XS_C:
  buffer_load_dword v14, v3, s[4:7], 0 offen offset:1024 sc1
  s_add_u32 s43, s43, 1
  s_cmp_gt_u32 s43, 0x20000
  s_cbranch_scc1 KEND
  s_waitcnt vmcnt(0)
  v_cmp_gt_u32 vcc, s36, v14
  s_cbranch_vccnz XS_C
  s_mov_b64 exec, -1
  s_add_u32 s47, s45, 4096
  buffer_load_dwordx4 v[160:163], v7, s[4:7], s45 offen offset:0 sc1
  buffer_load_dwordx4 v[164:167], v7, s[4:7], s45 offen offset:1024 sc1
  buffer_load_dwordx4 v[168:171], v7, s[4:7], s45 offen offset:2048 sc1
  buffer_load_dwordx4 v[172:175], v7, s[4:7], s45 offen offset:3072 sc1
  buffer_load_dwordx4 v[176:179], v7, s[4:7], s47 offen offset:0 sc1
  buffer_load_dwordx4 v[180:183], v7, s[4:7], s47 offen offset:1024 sc1
  s_waitcnt vmcnt(5)
  v_mfma_f32_16x16x32_bf16 v[132:135], v[16:19], v[160:163], 0
  s_waitcnt vmcnt(4)
  v_mfma_f32_16x16x32_bf16 v[136:139], v[16:19], v[164:167], 0
  s_waitcnt vmcnt(3)
  v_mfma_f32_16x16x32_bf16 v[132:135], v[16:19], v[168:171], v[132:135]
  s_waitcnt vmcnt(2)
  v_mfma_f32_16x16x32_bf16 v[136:139], v[16:19], v[172:175], v[136:139]
  s_waitcnt vmcnt(1)
  v_mfma_f32_16x16x32_bf16 v[132:135], v[16:19], v[176:179], v[132:135]
  s_waitcnt vmcnt(0)
  v_mfma_f32_16x16x32_bf16 v[136:139], v[16:19], v[180:183], v[136:139]
  s_nop 7
  v_add_f32 v132, v132, v136
  v_add_f32 v133, v133, v137
  v_add_f32 v134, v134, v138
  v_add_f32 v135, v135, v139
  v_fmac_f32 v44, v40, v132
  v_fmac_f32 v45, v41, v133
  v_fmac_f32 v46, v42, v134
  v_fmac_f32 v47, v43, v135
  v_cvt_pk_bf16_f32 v132, v44, v45
  v_cvt_pk_bf16_f32 v133, v46, v47
  s_mov_b32 exec_hi, 0
  buffer_store_dwordx2 v[132:133], v9, s[24:27], s41 offen
  s_mov_b64 exec, -1
  s_add_u32 s41, s41, 0x20000
  s_cmp_lt_u32 s36, 16
  s_cbranch_scc1 XS_LOOP
  s_branch KEND
s_endpgm
.section .rodata,"a"
.p2align 6
.amdhsa_kernel adaLN_cond__memory_aug_recurrent_mem_tr__dense_activation_silu__prompt_kernel
  .amdhsa_next_free_vgpr 512
  .amdhsa_next_free_sgpr 102
  .amdhsa_accum_offset 256
  .amdhsa_group_segment_fixed_size 0
  .amdhsa_kernarg_size 120
  .amdhsa_user_sgpr_count 2
  .amdhsa_user_sgpr_kernarg_segment_ptr 1
  .amdhsa_system_sgpr_workgroup_id_x 1
.end_amdhsa_kernel
```
